```python
import torch

def _softmax(x, axis=-1):
    return torch.softmax(x, dim=axis)
def _gelu(x):
    return torch.nn.functional.gelu(x, approximate="tanh")
def _silu(x):
    return torch.nn.functional.silu(x)
def _sigmoid(x):
    return torch.sigmoid(x)
def _layernorm(x, axis=-1, eps=1e-5):
    m = x.mean(dim=axis, keepdim=True)
    v = x.var(dim=axis, keepdim=True, unbiased=False)
    return (x - m) / torch.sqrt(v + eps)
def _scatter_add(tgt, idx, src, axis=0):
    return tgt.clone().index_add_(axis, idx, src)
def _segment_sum(src, seg, n):
    out = torch.zeros((n,) + src.shape[1:], dtype=src.dtype)
    return out.index_add_(0, seg, src)
def _pad(x, pw):
    flat = tuple(v for pair in reversed(pw) for v in pair)
    return torch.nn.functional.pad(x, flat)

kernel_name = 'sequential_preLN__mha_block__glu_gated_geglu__prompt'

def setup_inputs():

    _w = (lambda a: (lambda t: t.to(torch.bfloat16) if t.is_floating_point() else t)(torch.as_tensor(a)))
    def _A_setup():
        B, S, D, H = 1, 2048, 576, 32
        return {
            "x": _w((lambda *s: torch.randn(*s, dtype=torch.bfloat16) * 0.05)(B, S, D)),
            "wqkv": _w((lambda *s: torch.randn(*s, dtype=torch.bfloat16) * 0.05)(D, 3 * D)),
            "wo": _w((lambda *s: torch.randn(*s, dtype=torch.bfloat16) * 0.05)(D, D)),
        }
    _A_in = _A_setup()

    def _B_setup():
        B, S, Dm, Df = 1, 2048, 576, 4608
        return {
            "x": _w((lambda *s: torch.randn(*s, dtype=torch.bfloat16) * 0.05)(B, S, Dm)),
            "w_gate": _w((lambda *s: torch.randn(*s, dtype=torch.bfloat16) * 0.8)(Dm, Df) * (Dm ** -0.5)),
            "w_up": _w((lambda *s: torch.randn(*s, dtype=torch.bfloat16) * 0.8)(Dm, Df) * (Dm ** -0.5)),
            "w_down": _w((lambda *s: torch.randn(*s, dtype=torch.bfloat16) * 0.8)(Df, Dm) * (Df ** -0.5)),
        }
    _B_in = _B_setup()

    return {
        "A_x": _A_in["x"],
        "A_wqkv": _A_in["wqkv"],
        "A_wo": _A_in["wo"],
        "B_x": _B_in["x"],
        "B_w_gate": _B_in["w_gate"],
        "B_w_up": _B_in["w_up"],
        "B_w_down": _B_in["w_down"],
    }

def reference(A_x, A_wqkv, A_wo, B_x, B_w_gate, B_w_up, B_w_down):
    def _A_ref(x, wqkv, wo):
        B, S, D = x.shape
        H = 32
        Dh = D // H
        qkv = (lambda x, *d: x.permute(*d))((x @ wqkv).reshape(B, S, 3, H, Dh), 2, 0, 3, 1, 4)
        q, k, v = qkv[0], qkv[1], qkv[2]
        scores = torch.einsum("bhqd,bhkd->bhqk", q, k) * (Dh ** -0.5)
        p = _softmax(scores, axis=-1)
        o = torch.einsum("bhqk,bhkd->bhqd", p, v)
        return (lambda x, *d: x.permute(*d))(o, 0, 2, 1, 3).reshape(B, S, D) @ wo

    def _B_ref(x, w_gate, w_up, w_down):
        g = torch.einsum("bsd,df->bsf", x, w_gate)
        u = torch.einsum("bsd,df->bsf", x, w_up)
        h = _gelu(g) * u
        return torch.einsum("bsf,fd->bsd", h, w_down)

    x = A_x
    h = x + _A_ref(_layernorm(x, axis=-1), A_wqkv, A_wo)
    h2 = h + _B_ref(_layernorm(h, axis=-1), B_w_gate, B_w_up, B_w_down)
    return h2
```

```asm
; @launch kernel=k1_qkv_kernel grid=(256,1,1) block=(512,1,1) lds=148480
; @launch kernel=k2_attn_kernel grid=(256,1,1) block=(768,1,1) lds=163840
; @launch kernel=k3_wo_kernel grid=(256,1,1) block=(384,1,1) lds=98304
; @launch kernel=k4_ffn_kernel grid=(256,1,1) block=(256,1,1) lds=152576
; @launch kernel=k5_reduce_kernel grid=(576,1,1) block=(128,1,1) lds=0
.amdgcn_target "amdgcn-amd-amdhsa--gfx950"
.text
.globl k1_qkv_kernel
.p2align 8
.type k1_qkv_kernel,@function
k1_qkv_kernel:
    s_cmp_ge_u32 s2, 256
    s_cbranch_scc1 K1_END
    s_load_dwordx4 s[4:7], s[0:1], 0
    s_load_dwordx2 s[8:9], s[0:1], 72
    v_and_b32 v1, 63, v0
    v_lshrrev_b32 v13, 6, v0
    s_and_b32 s31, s2, 7
    s_lshr_b32 s30, s2, 3
    s_lshr_b32 s32, s31, 1
    s_and_b32 s29, s31, 1
    s_lshl_b32 s25, s32, 3
    s_and_b32 s32, s30, 7
    s_add_u32 s25, s25, s32
    s_lshl_b32 s24, s29, 2
    s_lshr_b32 s32, s30, 3
    s_add_u32 s24, s24, s32
    v_readfirstlane_b32 s26, v13
    s_lshl_b32 s56, s30, 3
    s_nop 1
    s_add_u32 s56, s56, s26
    s_cmp_ge_u32 s56, 13
    s_cbranch_scc1 K1_NOSELF
    v_lshlrev_b32 v11, 4, v1
    s_getpc_b64 s[52:53]
PFC_1:
    s_sub_u32 s52, s52, PFC_1 - k1_qkv_kernel
    s_subb_u32 s53, s53, 0
    s_mul_i32 s54, s56, 1
    s_add_u32 s54, s54, 0
    s_min_u32 s54, s54, 12
    s_lshl_b32 s54, s54, 10
    v_add_u32 v12, s54, v11
    global_load_dwordx4 v[248:251], v12, s[52:53]
K1_NOSELF:
    v_lshrrev_b32 v14, 3, v0
    v_mul_u32_u24 v9, 1152, v14
    v_and_b32 v15, 7, v0
    v_lshl_add_u32 v9, v15, 4, v9
    s_mul_i32 s33, s25, 73728
    s_waitcnt lgkmcnt(0)
    s_mov_b32 s12, s4
    s_and_b32 s13, s5, 0xffff
    s_mov_b32 s14, 2359296
    s_mov_b32 s15, 0x20000
    buffer_load_dwordx4 v[32:35], v9, s[12:15], s33 offen offset:0
    buffer_load_dwordx4 v[36:39], v9, s[12:15], s33 offen offset:128
    buffer_load_dwordx4 v[40:43], v9, s[12:15], s33 offen offset:256
    buffer_load_dwordx4 v[44:47], v9, s[12:15], s33 offen offset:384
    buffer_load_dwordx4 v[48:51], v9, s[12:15], s33 offen offset:512
    buffer_load_dwordx4 v[52:55], v9, s[12:15], s33 offen offset:640
    buffer_load_dwordx4 v[56:59], v9, s[12:15], s33 offen offset:768
    buffer_load_dwordx4 v[60:63], v9, s[12:15], s33 offen offset:896
    buffer_load_dwordx4 v[64:67], v9, s[12:15], s33 offen offset:1024
    s_mov_b32 s16, s6
    s_and_b32 s17, s7, 0xffff
    s_mov_b32 s18, 1990656
    s_mov_b32 s19, 0x20000
    s_mov_b32 s20, s8
    s_and_b32 s21, s9, 0xffff
    s_mov_b32 s22, 48234496
    s_mov_b32 s23, 0x20000
    v_add_u32 v13, 0, v0
    v_min_u32 v13, 2303, v13
    v_mul_u32_u24 v14, 29128, v13
    v_lshrrev_b32 v14, 20, v14
    v_mul_u32_u24 v15, 36, v14
    v_sub_u32 v15, v13, v15
    v_mul_u32_u24 v16, 43, v15
    v_lshrrev_b32 v16, 9, v16
    v_mul_u32_u24 v14, 3456, v14
    v_mul_u32_u24 v16, 960, v16
    v_add_u32 v14, v14, v16
    v_lshl_add_u32 v240, v15, 4, v14
    v_add_u32 v13, 512, v0
    v_min_u32 v13, 2303, v13
    v_mul_u32_u24 v14, 29128, v13
    v_lshrrev_b32 v14, 20, v14
    v_mul_u32_u24 v15, 36, v14
    v_sub_u32 v15, v13, v15
    v_mul_u32_u24 v16, 43, v15
    v_lshrrev_b32 v16, 9, v16
    v_mul_u32_u24 v14, 3456, v14
    v_mul_u32_u24 v16, 960, v16
    v_add_u32 v14, v14, v16
    v_lshl_add_u32 v241, v15, 4, v14
    v_add_u32 v13, 1024, v0
    v_min_u32 v13, 2303, v13
    v_mul_u32_u24 v14, 29128, v13
    v_lshrrev_b32 v14, 20, v14
    v_mul_u32_u24 v15, 36, v14
    v_sub_u32 v15, v13, v15
    v_mul_u32_u24 v16, 43, v15
    v_lshrrev_b32 v16, 9, v16
    v_mul_u32_u24 v14, 3456, v14
    v_mul_u32_u24 v16, 960, v16
    v_add_u32 v14, v14, v16
    v_lshl_add_u32 v242, v15, 4, v14
    v_add_u32 v13, 1536, v0
    v_min_u32 v13, 2303, v13
    v_mul_u32_u24 v14, 29128, v13
    v_lshrrev_b32 v14, 20, v14
    v_mul_u32_u24 v15, 36, v14
    v_sub_u32 v15, v13, v15
    v_mul_u32_u24 v16, 43, v15
    v_lshrrev_b32 v16, 9, v16
    v_mul_u32_u24 v14, 3456, v14
    v_mul_u32_u24 v16, 960, v16
    v_add_u32 v14, v14, v16
    v_lshl_add_u32 v243, v15, 4, v14
    v_add_u32 v13, 2048, v0
    v_min_u32 v13, 2303, v13
    v_mul_u32_u24 v14, 29128, v13
    v_lshrrev_b32 v14, 20, v14
    v_mul_u32_u24 v15, 36, v14
    v_sub_u32 v15, v13, v15
    v_mul_u32_u24 v16, 43, v15
    v_lshrrev_b32 v16, 9, v16
    v_mul_u32_u24 v14, 3456, v14
    v_mul_u32_u24 v16, 960, v16
    v_add_u32 v14, v14, v16
    v_lshl_add_u32 v244, v15, 4, v14
    s_and_b32 s27, s26, 1
    s_lshr_b32 s28, s26, 1
    s_lshl_b32 s35, s26, 10
    s_mul_i32 s36, s24, 144
    s_and_b32 s38, s36, 63
    s_sub_u32 s36, s36, s38
    s_mov_b32 s51, s38
    s_add_u32 m0, s35, 0
    s_nop 0
    buffer_load_dwordx4 v240, s[16:19], s36 offen lds
    s_add_u32 m0, s35, 8192
    s_nop 0
    buffer_load_dwordx4 v241, s[16:19], s36 offen lds
    s_add_u32 m0, s35, 16384
    s_nop 0
    buffer_load_dwordx4 v242, s[16:19], s36 offen lds
    s_add_u32 m0, s35, 24576
    s_nop 0
    buffer_load_dwordx4 v243, s[16:19], s36 offen lds
    s_cmp_ge_u32 s26, 4
    s_cbranch_scc1 K1_D0
    s_add_u32 m0, s35, 32768
    s_nop 0
    buffer_load_dwordx4 v244, s[16:19], s36 offen lds
K1_D0:
    s_add_u32 s36, s36, 221184
    s_cmp_lg_u32 s26, 7
    s_cbranch_scc1 K1_NOPFC
    v_lshlrev_b32 v11, 4, v1
    s_getpc_b64 s[52:53]
PFC_2:
    s_add_u32 s52, s52, k2_attn_kernel - PFC_2
    s_addc_u32 s53, s53, 0
    s_mul_i32 s54, s30, 1
    s_add_u32 s54, s54, 0
    s_min_u32 s54, s54, 12
    s_lshl_b32 s54, s54, 10
    v_add_u32 v12, s54, v11
    global_load_dwordx4 v[252:255], v12, s[52:53]
K1_NOPFC:
    v_lshrrev_b32 v13, 5, v1
    v_bfe_u32 v14, v1, 2, 2
    v_lshl_add_u32 v13, v13, 3, v14
    v_mul_u32_u24 v2, 576, v13
    v_bfe_u32 v13, v1, 4, 1
    v_and_b32 v14, 3, v1
    s_cmp_eq_u32 s28, 3
    s_cbranch_scc1 K1_REMADDR
    s_mul_i32 s38, s28, 192
    v_mul_u32_u24 v13, 5, v13
    v_and_b32 v15, 1, v14
    v_lshl_add_u32 v13, v15, 1, v13
    v_lshrrev_b32 v14, 1, v14
    v_add_u32 v13, v13, v14
    v_lshl_add_u32 v13, v13, 3, s38
    s_branch K1_ADDRDONE
K1_REMADDR:
    v_lshl_add_u32 v13, v13, 2, v14
    v_cmp_gt_u32 vcc, 6, v13
    s_nop 1
    v_cndmask_b32 v13, 0, v13, vcc
    v_lshrrev_b32 v14, 1, v13
    v_mul_u32_u24 v14, 192, v14
    v_and_b32 v13, 1, v13
    v_mul_u32_u24 v13, 72, v13
    v_add3_u32 v13, v13, v14, 32
K1_ADDRDONE:
    v_add_u32 v2, v2, v13
    v_add_u32 v2, s51, v2
    v_add_u32 v3, 55296, v2
    v_add_u32 v4, 110592, v2
    v_add_u32 v5, 72, v2
    v_add_u32 v6, 72, v3
    v_add_u32 v7, 72, v4
    s_waitcnt vmcnt(4)
    v_lshlrev_b32 v68, 16, v32
    v_and_b32 v69, 0xffff0000, v32
    v_lshlrev_b32 v70, 16, v33
    v_and_b32 v71, 0xffff0000, v33
    v_lshlrev_b32 v72, 16, v34
    v_and_b32 v73, 0xffff0000, v34
    v_lshlrev_b32 v74, 16, v35
    v_and_b32 v75, 0xffff0000, v35
    v_lshlrev_b32 v76, 16, v36
    v_and_b32 v77, 0xffff0000, v36
    v_lshlrev_b32 v78, 16, v37
    v_and_b32 v79, 0xffff0000, v37
    v_lshlrev_b32 v80, 16, v38
    v_and_b32 v81, 0xffff0000, v38
    v_lshlrev_b32 v82, 16, v39
    v_and_b32 v83, 0xffff0000, v39
    v_lshlrev_b32 v84, 16, v40
    v_and_b32 v85, 0xffff0000, v40
    v_lshlrev_b32 v86, 16, v41
    v_and_b32 v87, 0xffff0000, v41
    v_lshlrev_b32 v88, 16, v42
    v_and_b32 v89, 0xffff0000, v42
    v_lshlrev_b32 v90, 16, v43
    v_and_b32 v91, 0xffff0000, v43
    v_lshlrev_b32 v92, 16, v44
    v_and_b32 v93, 0xffff0000, v44
    v_lshlrev_b32 v94, 16, v45
    v_and_b32 v95, 0xffff0000, v45
    v_lshlrev_b32 v96, 16, v46
    v_and_b32 v97, 0xffff0000, v46
    v_lshlrev_b32 v98, 16, v47
    v_and_b32 v99, 0xffff0000, v47
    v_lshlrev_b32 v100, 16, v48
    v_and_b32 v101, 0xffff0000, v48
    v_lshlrev_b32 v102, 16, v49
    v_and_b32 v103, 0xffff0000, v49
    v_lshlrev_b32 v104, 16, v50
    v_and_b32 v105, 0xffff0000, v50
    v_lshlrev_b32 v106, 16, v51
    v_and_b32 v107, 0xffff0000, v51
    v_lshlrev_b32 v108, 16, v52
    v_and_b32 v109, 0xffff0000, v52
    v_lshlrev_b32 v110, 16, v53
    v_and_b32 v111, 0xffff0000, v53
    v_lshlrev_b32 v112, 16, v54
    v_and_b32 v113, 0xffff0000, v54
    v_lshlrev_b32 v114, 16, v55
    v_and_b32 v115, 0xffff0000, v55
    v_lshlrev_b32 v116, 16, v56
    v_and_b32 v117, 0xffff0000, v56
    v_lshlrev_b32 v118, 16, v57
    v_and_b32 v119, 0xffff0000, v57
    v_lshlrev_b32 v120, 16, v58
    v_and_b32 v121, 0xffff0000, v58
    v_lshlrev_b32 v122, 16, v59
    v_and_b32 v123, 0xffff0000, v59
    v_lshlrev_b32 v124, 16, v60
    v_and_b32 v125, 0xffff0000, v60
    v_lshlrev_b32 v126, 16, v61
    v_and_b32 v127, 0xffff0000, v61
    v_lshlrev_b32 v128, 16, v62
    v_and_b32 v129, 0xffff0000, v62
    v_lshlrev_b32 v130, 16, v63
    v_and_b32 v131, 0xffff0000, v63
    v_lshlrev_b32 v132, 16, v64
    v_and_b32 v133, 0xffff0000, v64
    v_lshlrev_b32 v134, 16, v65
    v_and_b32 v135, 0xffff0000, v65
    v_lshlrev_b32 v136, 16, v66
    v_and_b32 v137, 0xffff0000, v66
    v_lshlrev_b32 v138, 16, v67
    v_and_b32 v139, 0xffff0000, v67
    s_add_u32 m0, s35, 36864
    s_nop 0
    buffer_load_dwordx4 v240, s[16:19], s36 offen lds
    s_add_u32 m0, s35, 45056
    s_nop 0
    buffer_load_dwordx4 v241, s[16:19], s36 offen lds
    s_add_u32 m0, s35, 53248
    s_nop 0
    buffer_load_dwordx4 v242, s[16:19], s36 offen lds
    s_add_u32 m0, s35, 61440
    s_nop 0
    buffer_load_dwordx4 v243, s[16:19], s36 offen lds
    s_cmp_ge_u32 s26, 4
    s_cbranch_scc1 K1_D1
    s_add_u32 m0, s35, 69632
    s_nop 0
    buffer_load_dwordx4 v244, s[16:19], s36 offen lds
K1_D1:
    s_add_u32 s36, s36, 221184
    v_pk_add_f32 v[20:21], v[68:69], v[76:77]
    v_pk_add_f32 v[22:23], v[70:71], v[78:79]
    v_pk_add_f32 v[24:25], v[72:73], v[80:81]
    v_pk_add_f32 v[26:27], v[74:75], v[82:83]
    v_pk_add_f32 v[20:21], v[20:21], v[84:85]
    v_pk_add_f32 v[22:23], v[22:23], v[86:87]
    v_pk_add_f32 v[24:25], v[24:25], v[88:89]
    v_pk_add_f32 v[26:27], v[26:27], v[90:91]
    v_pk_add_f32 v[20:21], v[20:21], v[92:93]
    v_pk_add_f32 v[22:23], v[22:23], v[94:95]
    v_pk_add_f32 v[24:25], v[24:25], v[96:97]
    v_pk_add_f32 v[26:27], v[26:27], v[98:99]
    v_pk_add_f32 v[20:21], v[20:21], v[100:101]
    v_pk_add_f32 v[22:23], v[22:23], v[102:103]
    v_pk_add_f32 v[24:25], v[24:25], v[104:105]
    v_pk_add_f32 v[26:27], v[26:27], v[106:107]
    v_pk_add_f32 v[20:21], v[20:21], v[108:109]
    v_pk_add_f32 v[22:23], v[22:23], v[110:111]
    v_pk_add_f32 v[24:25], v[24:25], v[112:113]
    v_pk_add_f32 v[26:27], v[26:27], v[114:115]
    v_pk_add_f32 v[20:21], v[20:21], v[116:117]
    v_pk_add_f32 v[22:23], v[22:23], v[118:119]
    v_pk_add_f32 v[24:25], v[24:25], v[120:121]
    v_pk_add_f32 v[26:27], v[26:27], v[122:123]
    v_pk_add_f32 v[20:21], v[20:21], v[124:125]
    v_pk_add_f32 v[22:23], v[22:23], v[126:127]
    v_pk_add_f32 v[24:25], v[24:25], v[128:129]
    v_pk_add_f32 v[26:27], v[26:27], v[130:131]
    v_pk_add_f32 v[20:21], v[20:21], v[132:133]
    v_pk_add_f32 v[22:23], v[22:23], v[134:135]
    v_pk_add_f32 v[24:25], v[24:25], v[136:137]
    v_pk_add_f32 v[26:27], v[26:27], v[138:139]
    v_pk_add_f32 v[20:21], v[20:21], v[22:23]
    v_pk_add_f32 v[24:25], v[24:25], v[26:27]
    v_pk_add_f32 v[20:21], v[20:21], v[24:25]
    v_add_f32 v20, v20, v21
    s_nop 1
    v_add_f32_dpp v20, v20, v20 quad_perm:[1,0,3,2] row_mask:0xf bank_mask:0xf
    s_nop 1
    v_add_f32_dpp v20, v20, v20 quad_perm:[2,3,0,1] row_mask:0xf bank_mask:0xf
    s_nop 1
    v_add_f32_dpp v20, v20, v20 row_half_mirror row_mask:0xf bank_mask:0xf
    v_mul_f32 v18, 0xbae38e39, v20
    v_mul_f32 v19, 0xbae38e39, v20
    v_pk_add_f32 v[68:69], v[68:69], v[18:19]
    v_pk_add_f32 v[70:71], v[70:71], v[18:19]
    v_pk_add_f32 v[72:73], v[72:73], v[18:19]
    v_pk_add_f32 v[74:75], v[74:75], v[18:19]
    v_pk_add_f32 v[76:77], v[76:77], v[18:19]
    v_pk_add_f32 v[78:79], v[78:79], v[18:19]
    v_pk_add_f32 v[80:81], v[80:81], v[18:19]
    v_pk_add_f32 v[82:83], v[82:83], v[18:19]
    v_pk_add_f32 v[84:85], v[84:85], v[18:19]
    v_pk_add_f32 v[86:87], v[86:87], v[18:19]
    v_pk_add_f32 v[88:89], v[88:89], v[18:19]
    v_pk_add_f32 v[90:91], v[90:91], v[18:19]
    v_pk_add_f32 v[92:93], v[92:93], v[18:19]
    v_pk_add_f32 v[94:95], v[94:95], v[18:19]
    v_pk_add_f32 v[96:97], v[96:97], v[18:19]
    v_pk_add_f32 v[98:99], v[98:99], v[18:19]
    v_pk_add_f32 v[100:101], v[100:101], v[18:19]
    v_pk_add_f32 v[102:103], v[102:103], v[18:19]
    v_pk_add_f32 v[104:105], v[104:105], v[18:19]
    v_pk_add_f32 v[106:107], v[106:107], v[18:19]
    v_pk_add_f32 v[108:109], v[108:109], v[18:19]
    v_pk_add_f32 v[110:111], v[110:111], v[18:19]
    v_pk_add_f32 v[112:113], v[112:113], v[18:19]
    v_pk_add_f32 v[114:115], v[114:115], v[18:19]
    v_pk_add_f32 v[116:117], v[116:117], v[18:19]
    v_pk_add_f32 v[118:119], v[118:119], v[18:19]
    v_pk_add_f32 v[120:121], v[120:121], v[18:19]
    v_pk_add_f32 v[122:123], v[122:123], v[18:19]
    v_pk_add_f32 v[124:125], v[124:125], v[18:19]
    v_pk_add_f32 v[126:127], v[126:127], v[18:19]
    v_pk_add_f32 v[128:129], v[128:129], v[18:19]
    v_pk_add_f32 v[130:131], v[130:131], v[18:19]
    v_pk_add_f32 v[132:133], v[132:133], v[18:19]
    v_pk_add_f32 v[134:135], v[134:135], v[18:19]
    v_pk_add_f32 v[136:137], v[136:137], v[18:19]
    v_pk_add_f32 v[138:139], v[138:139], v[18:19]
    v_add_u32 v13, 0, v0
    v_min_u32 v13, 1943, v13
    v_mul_u32_u24 v14, 9710, v13
    v_lshrrev_b32 v14, 20, v14
    v_mul_u32_u24 v15, 108, v14
    v_sub_u32 v15, v13, v15
    v_mul_u32_u24 v16, 1821, v15
    v_lshrrev_b32 v16, 16, v16
    v_mul_u32_u24 v14, 3456, v14
    v_mul_u32_u24 v16, 576, v16
    v_add_u32 v14, v14, v16
    v_lshl_add_u32 v10, v15, 4, v14
    s_mul_i32 s37, s30, 62208
    s_mul_i32 s38, s29, 576
    s_add_u32 s37, s37, s38
    buffer_load_dwordx4 v[224:227], v10, s[16:19], s37 offen
    v_add_u32 v13, 512, v0
    v_min_u32 v13, 1943, v13
    v_mul_u32_u24 v14, 9710, v13
    v_lshrrev_b32 v14, 20, v14
    v_mul_u32_u24 v15, 108, v14
    v_sub_u32 v15, v13, v15
    v_mul_u32_u24 v16, 1821, v15
    v_lshrrev_b32 v16, 16, v16
    v_mul_u32_u24 v14, 3456, v14
    v_mul_u32_u24 v16, 576, v16
    v_add_u32 v14, v14, v16
    v_lshl_add_u32 v10, v15, 4, v14
    buffer_load_dwordx4 v[228:231], v10, s[16:19], s37 offen
    v_add_u32 v13, 1024, v0
    v_min_u32 v13, 1943, v13
    v_mul_u32_u24 v14, 9710, v13
    v_lshrrev_b32 v14, 20, v14
    v_mul_u32_u24 v15, 108, v14
    v_sub_u32 v15, v13, v15
    v_mul_u32_u24 v16, 1821, v15
    v_lshrrev_b32 v16, 16, v16
    v_mul_u32_u24 v14, 3456, v14
    v_mul_u32_u24 v16, 576, v16
    v_add_u32 v14, v14, v16
    v_lshl_add_u32 v10, v15, 4, v14
    buffer_load_dwordx4 v[232:235], v10, s[16:19], s37 offen
    v_add_u32 v13, 1536, v0
    v_min_u32 v13, 1943, v13
    v_mul_u32_u24 v14, 9710, v13
    v_lshrrev_b32 v14, 20, v14
    v_mul_u32_u24 v15, 108, v14
    v_sub_u32 v15, v13, v15
    v_mul_u32_u24 v16, 1821, v15
    v_lshrrev_b32 v16, 16, v16
    v_mul_u32_u24 v14, 3456, v14
    v_mul_u32_u24 v16, 576, v16
    v_add_u32 v14, v14, v16
    v_lshl_add_u32 v10, v15, 4, v14
    buffer_load_dwordx4 v[236:239], v10, s[16:19], s37 offen
    v_pk_mul_f32 v[20:21], v[68:69], v[68:69]
    v_pk_mul_f32 v[22:23], v[70:71], v[70:71]
    v_pk_mul_f32 v[24:25], v[72:73], v[72:73]
    v_pk_mul_f32 v[26:27], v[74:75], v[74:75]
    v_pk_fma_f32 v[20:21], v[76:77], v[76:77], v[20:21]
    v_pk_fma_f32 v[22:23], v[78:79], v[78:79], v[22:23]
    v_pk_fma_f32 v[24:25], v[80:81], v[80:81], v[24:25]
    v_pk_fma_f32 v[26:27], v[82:83], v[82:83], v[26:27]
    v_pk_fma_f32 v[20:21], v[84:85], v[84:85], v[20:21]
    v_pk_fma_f32 v[22:23], v[86:87], v[86:87], v[22:23]
    v_pk_fma_f32 v[24:25], v[88:89], v[88:89], v[24:25]
    v_pk_fma_f32 v[26:27], v[90:91], v[90:91], v[26:27]
    v_pk_fma_f32 v[20:21], v[92:93], v[92:93], v[20:21]
    v_pk_fma_f32 v[22:23], v[94:95], v[94:95], v[22:23]
    v_pk_fma_f32 v[24:25], v[96:97], v[96:97], v[24:25]
    v_pk_fma_f32 v[26:27], v[98:99], v[98:99], v[26:27]
    v_pk_fma_f32 v[20:21], v[100:101], v[100:101], v[20:21]
    v_pk_fma_f32 v[22:23], v[102:103], v[102:103], v[22:23]
    v_pk_fma_f32 v[24:25], v[104:105], v[104:105], v[24:25]
    v_pk_fma_f32 v[26:27], v[106:107], v[106:107], v[26:27]
    v_pk_fma_f32 v[20:21], v[108:109], v[108:109], v[20:21]
    v_pk_fma_f32 v[22:23], v[110:111], v[110:111], v[22:23]
    v_pk_fma_f32 v[24:25], v[112:113], v[112:113], v[24:25]
    v_pk_fma_f32 v[26:27], v[114:115], v[114:115], v[26:27]
    v_pk_fma_f32 v[20:21], v[116:117], v[116:117], v[20:21]
    v_pk_fma_f32 v[22:23], v[118:119], v[118:119], v[22:23]
    v_pk_fma_f32 v[24:25], v[120:121], v[120:121], v[24:25]
    v_pk_fma_f32 v[26:27], v[122:123], v[122:123], v[26:27]
    v_pk_fma_f32 v[20:21], v[124:125], v[124:125], v[20:21]
    v_pk_fma_f32 v[22:23], v[126:127], v[126:127], v[22:23]
    v_pk_fma_f32 v[24:25], v[128:129], v[128:129], v[24:25]
    v_pk_fma_f32 v[26:27], v[130:131], v[130:131], v[26:27]
    v_pk_fma_f32 v[20:21], v[132:133], v[132:133], v[20:21]
    v_pk_fma_f32 v[22:23], v[134:135], v[134:135], v[22:23]
    v_pk_fma_f32 v[24:25], v[136:137], v[136:137], v[24:25]
    v_pk_fma_f32 v[26:27], v[138:139], v[138:139], v[26:27]
    v_pk_add_f32 v[20:21], v[20:21], v[22:23]
    v_pk_add_f32 v[24:25], v[24:25], v[26:27]
    v_pk_add_f32 v[20:21], v[20:21], v[24:25]
    v_add_f32 v20, v20, v21
    s_nop 1
    v_add_f32_dpp v20, v20, v20 quad_perm:[1,0,3,2] row_mask:0xf bank_mask:0xf
    s_nop 1
    v_add_f32_dpp v20, v20, v20 quad_perm:[2,3,0,1] row_mask:0xf bank_mask:0xf
    s_nop 1
    v_add_f32_dpp v20, v20, v20 row_half_mirror row_mask:0xf bank_mask:0xf
    v_mov_b32 v18, 0x3727c5ac
    v_fmac_f32 v18, 0x3ae38e39, v20
    v_rsq_f32 v18, v18
    s_nop 0
    v_mov_b32 v19, v18
    v_pk_mul_f32 v[68:69], v[68:69], v[18:19]
    v_pk_mul_f32 v[70:71], v[70:71], v[18:19]
    v_pk_mul_f32 v[72:73], v[72:73], v[18:19]
    v_pk_mul_f32 v[74:75], v[74:75], v[18:19]
    v_pk_mul_f32 v[76:77], v[76:77], v[18:19]
    v_pk_mul_f32 v[78:79], v[78:79], v[18:19]
    v_pk_mul_f32 v[80:81], v[80:81], v[18:19]
    v_pk_mul_f32 v[82:83], v[82:83], v[18:19]
    v_pk_mul_f32 v[84:85], v[84:85], v[18:19]
    v_pk_mul_f32 v[86:87], v[86:87], v[18:19]
    v_pk_mul_f32 v[88:89], v[88:89], v[18:19]
    v_pk_mul_f32 v[90:91], v[90:91], v[18:19]
    v_pk_mul_f32 v[92:93], v[92:93], v[18:19]
    v_pk_mul_f32 v[94:95], v[94:95], v[18:19]
    v_pk_mul_f32 v[96:97], v[96:97], v[18:19]
    v_pk_mul_f32 v[98:99], v[98:99], v[18:19]
    v_pk_mul_f32 v[100:101], v[100:101], v[18:19]
    v_pk_mul_f32 v[102:103], v[102:103], v[18:19]
    v_pk_mul_f32 v[104:105], v[104:105], v[18:19]
    v_pk_mul_f32 v[106:107], v[106:107], v[18:19]
    v_pk_mul_f32 v[108:109], v[108:109], v[18:19]
    v_pk_mul_f32 v[110:111], v[110:111], v[18:19]
    v_pk_mul_f32 v[112:113], v[112:113], v[18:19]
    v_pk_mul_f32 v[114:115], v[114:115], v[18:19]
    v_pk_mul_f32 v[116:117], v[116:117], v[18:19]
    v_pk_mul_f32 v[118:119], v[118:119], v[18:19]
    v_pk_mul_f32 v[120:121], v[120:121], v[18:19]
    v_pk_mul_f32 v[122:123], v[122:123], v[18:19]
    v_pk_mul_f32 v[124:125], v[124:125], v[18:19]
    v_pk_mul_f32 v[126:127], v[126:127], v[18:19]
    v_pk_mul_f32 v[128:129], v[128:129], v[18:19]
    v_pk_mul_f32 v[130:131], v[130:131], v[18:19]
    v_pk_mul_f32 v[132:133], v[132:133], v[18:19]
    v_pk_mul_f32 v[134:135], v[134:135], v[18:19]
    v_pk_mul_f32 v[136:137], v[136:137], v[18:19]
    v_pk_mul_f32 v[138:139], v[138:139], v[18:19]
    v_cvt_pk_bf16_f32 v32, v68, v69
    v_cvt_pk_bf16_f32 v33, v70, v71
    v_cvt_pk_bf16_f32 v34, v72, v73
    v_cvt_pk_bf16_f32 v35, v74, v75
    v_cvt_pk_bf16_f32 v36, v76, v77
    v_cvt_pk_bf16_f32 v37, v78, v79
    v_cvt_pk_bf16_f32 v38, v80, v81
    v_cvt_pk_bf16_f32 v39, v82, v83
    v_cvt_pk_bf16_f32 v40, v84, v85
    v_cvt_pk_bf16_f32 v41, v86, v87
    v_cvt_pk_bf16_f32 v42, v88, v89
    v_cvt_pk_bf16_f32 v43, v90, v91
    v_cvt_pk_bf16_f32 v44, v92, v93
    v_cvt_pk_bf16_f32 v45, v94, v95
    v_cvt_pk_bf16_f32 v46, v96, v97
    v_cvt_pk_bf16_f32 v47, v98, v99
    v_cvt_pk_bf16_f32 v48, v100, v101
    v_cvt_pk_bf16_f32 v49, v102, v103
    v_cvt_pk_bf16_f32 v50, v104, v105
    v_cvt_pk_bf16_f32 v51, v106, v107
    v_cvt_pk_bf16_f32 v52, v108, v109
    v_cvt_pk_bf16_f32 v53, v110, v111
    v_cvt_pk_bf16_f32 v54, v112, v113
    v_cvt_pk_bf16_f32 v55, v114, v115
    v_cvt_pk_bf16_f32 v56, v116, v117
    v_cvt_pk_bf16_f32 v57, v118, v119
    v_cvt_pk_bf16_f32 v58, v120, v121
    v_cvt_pk_bf16_f32 v59, v122, v123
    v_cvt_pk_bf16_f32 v60, v124, v125
    v_cvt_pk_bf16_f32 v61, v126, v127
    v_cvt_pk_bf16_f32 v62, v128, v129
    v_cvt_pk_bf16_f32 v63, v130, v131
    v_cvt_pk_bf16_f32 v64, v132, v133
    v_cvt_pk_bf16_f32 v65, v134, v135
    v_cvt_pk_bf16_f32 v66, v136, v137
    v_cvt_pk_bf16_f32 v67, v138, v139
    v_and_b32 v13, 7, v1
    v_lshrrev_b32 v14, 3, v1
    v_xor_b32 v14, v14, v13
    v_lshlrev_b32 v14, 4, v14
    v_lshrrev_b32 v15, 1, v13
    v_lshl_add_u32 v14, v15, 10, v14
    v_and_b32 v13, 1, v13
    v_lshl_add_u32 v14, v13, 9, v14
    s_and_b32 s38, s26, 3
    s_lshl_b32 s38, s38, 7
    s_lshr_b32 s39, s26, 2
    s_mul_i32 s39, s39, 36864
    s_add_u32 s38, s38, s39
    s_add_u32 s38, s38, 73728
    v_add_u32 v14, s38, v14
    ds_write_b128 v14, v[32:35] offset:0
    ds_write_b128 v14, v[36:39] offset:4096
    ds_write_b128 v14, v[40:43] offset:8192
    ds_write_b128 v14, v[44:47] offset:12288
    ds_write_b128 v14, v[48:51] offset:16384
    ds_write_b128 v14, v[52:55] offset:20480
    ds_write_b128 v14, v[56:59] offset:24576
    ds_write_b128 v14, v[60:63] offset:28672
    ds_write_b128 v14, v[64:67] offset:32768
    v_and_b32 v13, 31, v1
    v_lshrrev_b32 v14, 5, v1
    s_mul_i32 s38, s27, 36864
    s_add_u32 s38, s38, 73728
    v_or_b32 v15, 0, v14
    v_xor_b32 v15, v13, v15
    v_lshlrev_b32 v15, 4, v15
    v_lshl_add_u32 v15, v14, 9, v15
    v_add_u32 v15, 0, v15
    v_add_u32 v20, s38, v15
    v_or_b32 v15, 2, v14
    v_xor_b32 v15, v13, v15
    v_lshlrev_b32 v15, 4, v15
    v_lshl_add_u32 v15, v14, 9, v15
    v_add_u32 v15, 1024, v15
    v_add_u32 v21, s38, v15
    v_or_b32 v15, 4, v14
    v_xor_b32 v15, v13, v15
    v_lshlrev_b32 v15, 4, v15
    v_lshl_add_u32 v15, v14, 9, v15
    v_add_u32 v15, 2048, v15
    v_add_u32 v22, s38, v15
    v_or_b32 v15, 6, v14
    v_xor_b32 v15, v13, v15
    v_lshlrev_b32 v15, 4, v15
    v_lshl_add_u32 v15, v14, 9, v15
    v_add_u32 v15, 3072, v15
    v_add_u32 v23, s38, v15
    s_waitcnt lgkmcnt(0)
    s_barrier
    ds_read_b128 v[32:35], v20 offset:0
    ds_read_b128 v[36:39], v21 offset:0
    ds_read_b128 v[40:43], v22 offset:0
    ds_read_b128 v[44:47], v23 offset:0
    ds_read_b128 v[48:51], v20 offset:4096
    ds_read_b128 v[52:55], v21 offset:4096
    ds_read_b128 v[56:59], v22 offset:4096
    ds_read_b128 v[60:63], v23 offset:4096
    ds_read_b128 v[64:67], v20 offset:8192
    ds_read_b128 v[68:71], v21 offset:8192
    ds_read_b128 v[72:75], v22 offset:8192
    ds_read_b128 v[76:79], v23 offset:8192
    s_waitcnt lgkmcnt(0)
    ds_read_b128 v[80:83], v20 offset:12288
    ds_read_b128 v[84:87], v21 offset:12288
    ds_read_b128 v[88:91], v22 offset:12288
    ds_read_b128 v[92:95], v23 offset:12288
    ds_read_b128 v[96:99], v20 offset:16384
    ds_read_b128 v[100:103], v21 offset:16384
    ds_read_b128 v[104:107], v22 offset:16384
    ds_read_b128 v[108:111], v23 offset:16384
    ds_read_b128 v[112:115], v20 offset:20480
    ds_read_b128 v[116:119], v21 offset:20480
    ds_read_b128 v[120:123], v22 offset:20480
    ds_read_b128 v[124:127], v23 offset:20480
    s_waitcnt lgkmcnt(0)
    ds_read_b128 v[128:131], v20 offset:24576
    ds_read_b128 v[132:135], v21 offset:24576
    ds_read_b128 v[136:139], v22 offset:24576
    ds_read_b128 v[140:143], v23 offset:24576
    ds_read_b128 v[144:147], v20 offset:28672
    ds_read_b128 v[148:151], v21 offset:28672
    ds_read_b128 v[152:155], v22 offset:28672
    ds_read_b128 v[156:159], v23 offset:28672
    ds_read_b128 v[160:163], v20 offset:32768
    ds_read_b128 v[164:167], v21 offset:32768
    ds_read_b128 v[168:171], v22 offset:32768
    ds_read_b128 v[172:175], v23 offset:32768
    s_waitcnt lgkmcnt(0)
    s_barrier
    s_add_u32 m0, s35, 73728
    s_nop 0
    buffer_load_dwordx4 v240, s[16:19], s36 offen lds
    s_add_u32 m0, s35, 81920
    s_nop 0
    buffer_load_dwordx4 v241, s[16:19], s36 offen lds
    s_add_u32 m0, s35, 90112
    s_nop 0
    buffer_load_dwordx4 v242, s[16:19], s36 offen lds
    s_add_u32 m0, s35, 98304
    s_nop 0
    buffer_load_dwordx4 v243, s[16:19], s36 offen lds
    s_cmp_ge_u32 s26, 4
    s_cbranch_scc1 K1_D2
    s_add_u32 m0, s35, 106496
    s_nop 0
    buffer_load_dwordx4 v244, s[16:19], s36 offen lds
K1_D2:
    s_add_u32 s36, s36, 221184
    s_cmp_eq_u32 s28, 2
    s_cbranch_scc1 K1_VLOOP
    s_cmp_eq_u32 s28, 3
    s_cbranch_scc1 K1_RLOOP
    s_waitcnt vmcnt(4)
    s_barrier
    ds_read_b64_tr_b16 v[176:177], v2 offset:0
    ds_read_b64_tr_b16 v[178:179], v2 offset:2304
    ds_read_b64_tr_b16 v[192:193], v5 offset:0
    ds_read_b64_tr_b16 v[194:195], v5 offset:2304
    ds_read_b64_tr_b16 v[180:181], v2 offset:9216
    ds_read_b64_tr_b16 v[182:183], v2 offset:11520
    ds_read_b64_tr_b16 v[196:197], v5 offset:9216
    ds_read_b64_tr_b16 v[198:199], v5 offset:11520
    ds_read_b64_tr_b16 v[184:185], v2 offset:18432
    ds_read_b64_tr_b16 v[186:187], v2 offset:20736
    ds_read_b64_tr_b16 v[200:201], v5 offset:18432
    ds_read_b64_tr_b16 v[202:203], v5 offset:20736
    s_waitcnt lgkmcnt(8)
    v_mfma_f32_32x32x16_bf16 v[208:223], v[176:179], v[32:35], 0
    v_mfma_f32_32x32x16_bf16 v[224:239], v[192:195], v[32:35], 0
    s_add_u32 m0, s35, 110592
    s_nop 0
    buffer_load_dwordx4 v240, s[16:19], s36 offen lds
    ds_read_b64_tr_b16 v[188:189], v2 offset:27648
    ds_read_b64_tr_b16 v[190:191], v2 offset:29952
    ds_read_b64_tr_b16 v[204:205], v5 offset:27648
    ds_read_b64_tr_b16 v[206:207], v5 offset:29952
    s_waitcnt lgkmcnt(8)
    v_mfma_f32_32x32x16_bf16 v[208:223], v[180:183], v[36:39], v[208:223]
    v_mfma_f32_32x32x16_bf16 v[224:239], v[196:199], v[36:39], v[224:239]
    s_add_u32 m0, s35, 118784
    s_nop 0
    buffer_load_dwordx4 v241, s[16:19], s36 offen lds
    s_waitcnt vmcnt(6)
    s_barrier
    ds_read_b64_tr_b16 v[176:177], v2 offset:36864
    ds_read_b64_tr_b16 v[178:179], v2 offset:39168
    ds_read_b64_tr_b16 v[192:193], v5 offset:36864
    ds_read_b64_tr_b16 v[194:195], v5 offset:39168
    s_waitcnt lgkmcnt(8)
    v_mfma_f32_32x32x16_bf16 v[208:223], v[184:187], v[40:43], v[208:223]
    v_mfma_f32_32x32x16_bf16 v[224:239], v[200:203], v[40:43], v[224:239]
    s_add_u32 m0, s35, 126976
    s_nop 0
    buffer_load_dwordx4 v242, s[16:19], s36 offen lds
    ds_read_b64_tr_b16 v[180:181], v2 offset:46080
    ds_read_b64_tr_b16 v[182:183], v2 offset:48384
    ds_read_b64_tr_b16 v[196:197], v5 offset:46080
    ds_read_b64_tr_b16 v[198:199], v5 offset:48384
    s_waitcnt lgkmcnt(8)
    v_mfma_f32_32x32x16_bf16 v[208:223], v[188:191], v[44:47], v[208:223]
    v_mfma_f32_32x32x16_bf16 v[224:239], v[204:207], v[44:47], v[224:239]
    s_add_u32 m0, s35, 135168
    s_nop 0
    buffer_load_dwordx4 v243, s[16:19], s36 offen lds
    ds_read_b64_tr_b16 v[184:185], v3 offset:0
    ds_read_b64_tr_b16 v[186:187], v3 offset:2304
    ds_read_b64_tr_b16 v[200:201], v6 offset:0
    ds_read_b64_tr_b16 v[202:203], v6 offset:2304
    s_waitcnt lgkmcnt(8)
    v_mfma_f32_32x32x16_bf16 v[208:223], v[176:179], v[48:51], v[208:223]
    v_mfma_f32_32x32x16_bf16 v[224:239], v[192:195], v[48:51], v[224:239]
    s_cmp_ge_u32 s26, 4
    s_cbranch_scc1 K1_Da3
    s_add_u32 m0, s35, 143360
    s_nop 0
    buffer_load_dwordx4 v244, s[16:19], s36 offen lds
K1_Da3:
    s_add_u32 s36, s36, 221184
    ds_read_b64_tr_b16 v[188:189], v3 offset:9216
    ds_read_b64_tr_b16 v[190:191], v3 offset:11520
    ds_read_b64_tr_b16 v[204:205], v6 offset:9216
    ds_read_b64_tr_b16 v[206:207], v6 offset:11520
    s_waitcnt lgkmcnt(8)
    v_mfma_f32_32x32x16_bf16 v[208:223], v[180:183], v[52:55], v[208:223]
    v_mfma_f32_32x32x16_bf16 v[224:239], v[196:199], v[52:55], v[224:239]
    s_waitcnt vmcnt(4)
    s_barrier
    ds_read_b64_tr_b16 v[176:177], v3 offset:18432
    ds_read_b64_tr_b16 v[178:179], v3 offset:20736
    ds_read_b64_tr_b16 v[192:193], v6 offset:18432
    ds_read_b64_tr_b16 v[194:195], v6 offset:20736
    s_waitcnt lgkmcnt(8)
    v_mfma_f32_32x32x16_bf16 v[208:223], v[184:187], v[56:59], v[208:223]
    v_mfma_f32_32x32x16_bf16 v[224:239], v[200:203], v[56:59], v[224:239]
    s_add_u32 m0, s35, 0
    s_nop 0
    buffer_load_dwordx4 v240, s[16:19], s36 offen lds
    ds_read_b64_tr_b16 v[180:181], v3 offset:27648
    ds_read_b64_tr_b16 v[182:183], v3 offset:29952
    ds_read_b64_tr_b16 v[196:197], v6 offset:27648
    ds_read_b64_tr_b16 v[198:199], v6 offset:29952
    s_waitcnt lgkmcnt(8)
    v_mfma_f32_32x32x16_bf16 v[208:223], v[188:191], v[60:63], v[208:223]
    v_mfma_f32_32x32x16_bf16 v[224:239], v[204:207], v[60:63], v[224:239]
    s_add_u32 m0, s35, 8192
    s_nop 0
    buffer_load_dwordx4 v241, s[16:19], s36 offen lds
    ds_read_b64_tr_b16 v[184:185], v3 offset:36864
    ds_read_b64_tr_b16 v[186:187], v3 offset:39168
    ds_read_b64_tr_b16 v[200:201], v6 offset:36864
    ds_read_b64_tr_b16 v[202:203], v6 offset:39168
    s_waitcnt lgkmcnt(8)
    v_mfma_f32_32x32x16_bf16 v[208:223], v[176:179], v[64:67], v[208:223]
    v_mfma_f32_32x32x16_bf16 v[224:239], v[192:195], v[64:67], v[224:239]
    s_add_u32 m0, s35, 16384
    s_nop 0
    buffer_load_dwordx4 v242, s[16:19], s36 offen lds
    ds_read_b64_tr_b16 v[188:189], v3 offset:46080
    ds_read_b64_tr_b16 v[190:191], v3 offset:48384
    ds_read_b64_tr_b16 v[204:205], v6 offset:46080
    ds_read_b64_tr_b16 v[206:207], v6 offset:48384
    s_waitcnt lgkmcnt(8)
    v_mfma_f32_32x32x16_bf16 v[208:223], v[180:183], v[68:71], v[208:223]
    v_mfma_f32_32x32x16_bf16 v[224:239], v[196:199], v[68:71], v[224:239]
    s_add_u32 m0, s35, 24576
    s_nop 0
    buffer_load_dwordx4 v243, s[16:19], s36 offen lds
    s_cmp_ge_u32 s26, 4
    s_cbranch_scc1 K1_Da4
    s_add_u32 m0, s35, 32768
    s_nop 0
    buffer_load_dwordx4 v244, s[16:19], s36 offen lds
K1_Da4:
    s_add_u32 s36, s36, 221184
    s_waitcnt vmcnt(4)
    s_barrier
    ds_read_b64_tr_b16 v[176:177], v4 offset:0
    ds_read_b64_tr_b16 v[178:179], v4 offset:2304
    ds_read_b64_tr_b16 v[192:193], v7 offset:0
    ds_read_b64_tr_b16 v[194:195], v7 offset:2304
    s_waitcnt lgkmcnt(8)
    v_mfma_f32_32x32x16_bf16 v[208:223], v[184:187], v[72:75], v[208:223]
    v_mfma_f32_32x32x16_bf16 v[224:239], v[200:203], v[72:75], v[224:239]
    s_add_u32 m0, s35, 36864
    s_nop 0
    buffer_load_dwordx4 v240, s[16:19], s36 offen lds
    ds_read_b64_tr_b16 v[180:181], v4 offset:9216
    ds_read_b64_tr_b16 v[182:183], v4 offset:11520
    ds_read_b64_tr_b16 v[196:197], v7 offset:9216
    ds_read_b64_tr_b16 v[198:199], v7 offset:11520
    s_waitcnt lgkmcnt(8)
    v_mfma_f32_32x32x16_bf16 v[208:223], v[188:191], v[76:79], v[208:223]
    v_mfma_f32_32x32x16_bf16 v[224:239], v[204:207], v[76:79], v[224:239]
    s_add_u32 m0, s35, 45056
    s_nop 0
    buffer_load_dwordx4 v241, s[16:19], s36 offen lds
    ds_read_b64_tr_b16 v[184:185], v4 offset:18432
    ds_read_b64_tr_b16 v[186:187], v4 offset:20736
    ds_read_b64_tr_b16 v[200:201], v7 offset:18432
    ds_read_b64_tr_b16 v[202:203], v7 offset:20736
    s_waitcnt lgkmcnt(8)
    v_mfma_f32_32x32x16_bf16 v[208:223], v[176:179], v[80:83], v[208:223]
    v_mfma_f32_32x32x16_bf16 v[224:239], v[192:195], v[80:83], v[224:239]
    s_add_u32 m0, s35, 53248
    s_nop 0
    buffer_load_dwordx4 v242, s[16:19], s36 offen lds
    ds_read_b64_tr_b16 v[188:189], v4 offset:27648
    ds_read_b64_tr_b16 v[190:191], v4 offset:29952
    ds_read_b64_tr_b16 v[204:205], v7 offset:27648
    ds_read_b64_tr_b16 v[206:207], v7 offset:29952
    s_waitcnt lgkmcnt(8)
    v_mfma_f32_32x32x16_bf16 v[208:223], v[180:183], v[84:87], v[208:223]
    v_mfma_f32_32x32x16_bf16 v[224:239], v[196:199], v[84:87], v[224:239]
    s_add_u32 m0, s35, 61440
    s_nop 0
    buffer_load_dwordx4 v243, s[16:19], s36 offen lds
    s_cmp_ge_u32 s26, 4
    s_cbranch_scc1 K1_Da5
    s_add_u32 m0, s35, 69632
    s_nop 0
    buffer_load_dwordx4 v244, s[16:19], s36 offen lds
K1_Da5:
    s_add_u32 s36, s36, 221184
    s_waitcnt vmcnt(4)
    s_barrier
    ds_read_b64_tr_b16 v[176:177], v2 offset:0
    ds_read_b64_tr_b16 v[178:179], v2 offset:2304
    ds_read_b64_tr_b16 v[192:193], v5 offset:0
    ds_read_b64_tr_b16 v[194:195], v5 offset:2304
    s_waitcnt lgkmcnt(8)
    v_mfma_f32_32x32x16_bf16 v[208:223], v[184:187], v[88:91], v[208:223]
    v_mfma_f32_32x32x16_bf16 v[224:239], v[200:203], v[88:91], v[224:239]
    s_add_u32 m0, s35, 73728
    s_nop 0
    buffer_load_dwordx4 v240, s[16:19], s36 offen lds
    ds_read_b64_tr_b16 v[180:181], v2 offset:9216
    ds_read_b64_tr_b16 v[182:183], v2 offset:11520
    ds_read_b64_tr_b16 v[196:197], v5 offset:9216
    ds_read_b64_tr_b16 v[198:199], v5 offset:11520
    s_waitcnt lgkmcnt(8)
    v_mfma_f32_32x32x16_bf16 v[208:223], v[188:191], v[92:95], v[208:223]
    v_mfma_f32_32x32x16_bf16 v[224:239], v[204:207], v[92:95], v[224:239]
    s_add_u32 m0, s35, 81920
    s_nop 0
    buffer_load_dwordx4 v241, s[16:19], s36 offen lds
    ds_read_b64_tr_b16 v[184:185], v2 offset:18432
    ds_read_b64_tr_b16 v[186:187], v2 offset:20736
    ds_read_b64_tr_b16 v[200:201], v5 offset:18432
    ds_read_b64_tr_b16 v[202:203], v5 offset:20736
    s_waitcnt lgkmcnt(8)
    v_mfma_f32_32x32x16_bf16 v[208:223], v[176:179], v[96:99], v[208:223]
    v_mfma_f32_32x32x16_bf16 v[224:239], v[192:195], v[96:99], v[224:239]
    s_add_u32 m0, s35, 90112
    s_nop 0
    buffer_load_dwordx4 v242, s[16:19], s36 offen lds
    ds_read_b64_tr_b16 v[188:189], v2 offset:27648
    ds_read_b64_tr_b16 v[190:191], v2 offset:29952
    ds_read_b64_tr_b16 v[204:205], v5 offset:27648
    ds_read_b64_tr_b16 v[206:207], v5 offset:29952
    s_waitcnt lgkmcnt(8)
    v_mfma_f32_32x32x16_bf16 v[208:223], v[180:183], v[100:103], v[208:223]
    v_mfma_f32_32x32x16_bf16 v[224:239], v[196:199], v[100:103], v[224:239]
    s_add_u32 m0, s35, 98304
    s_nop 0
    buffer_load_dwordx4 v243, s[16:19], s36 offen lds
    s_cmp_ge_u32 s26, 4
    s_cbranch_scc1 K1_Da6
    s_add_u32 m0, s35, 106496
    s_nop 0
    buffer_load_dwordx4 v244, s[16:19], s36 offen lds
K1_Da6:
    s_add_u32 s36, s36, 221184
    s_waitcnt vmcnt(4)
    s_barrier
    ds_read_b64_tr_b16 v[176:177], v2 offset:36864
    ds_read_b64_tr_b16 v[178:179], v2 offset:39168
    ds_read_b64_tr_b16 v[192:193], v5 offset:36864
    ds_read_b64_tr_b16 v[194:195], v5 offset:39168
    s_waitcnt lgkmcnt(8)
    v_mfma_f32_32x32x16_bf16 v[208:223], v[184:187], v[104:107], v[208:223]
    v_mfma_f32_32x32x16_bf16 v[224:239], v[200:203], v[104:107], v[224:239]
    s_add_u32 m0, s35, 110592
    s_nop 0
    buffer_load_dwordx4 v240, s[16:19], s36 offen lds
    ds_read_b64_tr_b16 v[180:181], v2 offset:46080
    ds_read_b64_tr_b16 v[182:183], v2 offset:48384
    ds_read_b64_tr_b16 v[196:197], v5 offset:46080
    ds_read_b64_tr_b16 v[198:199], v5 offset:48384
    s_waitcnt lgkmcnt(8)
    v_mfma_f32_32x32x16_bf16 v[208:223], v[188:191], v[108:111], v[208:223]
    v_mfma_f32_32x32x16_bf16 v[224:239], v[204:207], v[108:111], v[224:239]
    s_add_u32 m0, s35, 118784
    s_nop 0
    buffer_load_dwordx4 v241, s[16:19], s36 offen lds
    ds_read_b64_tr_b16 v[184:185], v3 offset:0
    ds_read_b64_tr_b16 v[186:187], v3 offset:2304
    ds_read_b64_tr_b16 v[200:201], v6 offset:0
    ds_read_b64_tr_b16 v[202:203], v6 offset:2304
    s_waitcnt lgkmcnt(8)
    v_mfma_f32_32x32x16_bf16 v[208:223], v[176:179], v[112:115], v[208:223]
    v_mfma_f32_32x32x16_bf16 v[224:239], v[192:195], v[112:115], v[224:239]
    s_add_u32 m0, s35, 126976
    s_nop 0
    buffer_load_dwordx4 v242, s[16:19], s36 offen lds
    ds_read_b64_tr_b16 v[188:189], v3 offset:9216
    ds_read_b64_tr_b16 v[190:191], v3 offset:11520
    ds_read_b64_tr_b16 v[204:205], v6 offset:9216
    ds_read_b64_tr_b16 v[206:207], v6 offset:11520
    s_waitcnt lgkmcnt(8)
    v_mfma_f32_32x32x16_bf16 v[208:223], v[180:183], v[116:119], v[208:223]
    v_mfma_f32_32x32x16_bf16 v[224:239], v[196:199], v[116:119], v[224:239]
    s_add_u32 m0, s35, 135168
    s_nop 0
    buffer_load_dwordx4 v243, s[16:19], s36 offen lds
    s_cmp_ge_u32 s26, 4
    s_cbranch_scc1 K1_Da7
    s_add_u32 m0, s35, 143360
    s_nop 0
    buffer_load_dwordx4 v244, s[16:19], s36 offen lds
K1_Da7:
    s_add_u32 s36, s36, 221184
    s_waitcnt vmcnt(4)
    s_barrier
    ds_read_b64_tr_b16 v[176:177], v3 offset:18432
    ds_read_b64_tr_b16 v[178:179], v3 offset:20736
    ds_read_b64_tr_b16 v[192:193], v6 offset:18432
    ds_read_b64_tr_b16 v[194:195], v6 offset:20736
    s_waitcnt lgkmcnt(8)
    v_mfma_f32_32x32x16_bf16 v[208:223], v[184:187], v[120:123], v[208:223]
    v_mfma_f32_32x32x16_bf16 v[224:239], v[200:203], v[120:123], v[224:239]
    s_add_u32 m0, s35, 0
    s_nop 0
    buffer_load_dwordx4 v240, s[16:19], s36 offen lds
    ds_read_b64_tr_b16 v[180:181], v3 offset:27648
    ds_read_b64_tr_b16 v[182:183], v3 offset:29952
    ds_read_b64_tr_b16 v[196:197], v6 offset:27648
    ds_read_b64_tr_b16 v[198:199], v6 offset:29952
    s_waitcnt lgkmcnt(8)
    v_mfma_f32_32x32x16_bf16 v[208:223], v[188:191], v[124:127], v[208:223]
    v_mfma_f32_32x32x16_bf16 v[224:239], v[204:207], v[124:127], v[224:239]
    s_add_u32 m0, s35, 8192
    s_nop 0
    buffer_load_dwordx4 v241, s[16:19], s36 offen lds
    ds_read_b64_tr_b16 v[184:185], v3 offset:36864
    ds_read_b64_tr_b16 v[186:187], v3 offset:39168
    ds_read_b64_tr_b16 v[200:201], v6 offset:36864
    ds_read_b64_tr_b16 v[202:203], v6 offset:39168
    s_waitcnt lgkmcnt(8)
    v_mfma_f32_32x32x16_bf16 v[208:223], v[176:179], v[128:131], v[208:223]
    v_mfma_f32_32x32x16_bf16 v[224:239], v[192:195], v[128:131], v[224:239]
    s_add_u32 m0, s35, 16384
    s_nop 0
    buffer_load_dwordx4 v242, s[16:19], s36 offen lds
    ds_read_b64_tr_b16 v[188:189], v3 offset:46080
    ds_read_b64_tr_b16 v[190:191], v3 offset:48384
    ds_read_b64_tr_b16 v[204:205], v6 offset:46080
    ds_read_b64_tr_b16 v[206:207], v6 offset:48384
    s_waitcnt lgkmcnt(8)
    v_mfma_f32_32x32x16_bf16 v[208:223], v[180:183], v[132:135], v[208:223]
    v_mfma_f32_32x32x16_bf16 v[224:239], v[196:199], v[132:135], v[224:239]
    s_add_u32 m0, s35, 24576
    s_nop 0
    buffer_load_dwordx4 v243, s[16:19], s36 offen lds
    s_cmp_ge_u32 s26, 4
    s_cbranch_scc1 K1_Da8
    s_add_u32 m0, s35, 32768
    s_nop 0
    buffer_load_dwordx4 v244, s[16:19], s36 offen lds
K1_Da8:
    s_add_u32 s36, s36, 221184
    s_waitcnt vmcnt(4)
    s_barrier
    ds_read_b64_tr_b16 v[176:177], v4 offset:0
    ds_read_b64_tr_b16 v[178:179], v4 offset:2304
    ds_read_b64_tr_b16 v[192:193], v7 offset:0
    ds_read_b64_tr_b16 v[194:195], v7 offset:2304
    s_waitcnt lgkmcnt(8)
    v_mfma_f32_32x32x16_bf16 v[208:223], v[184:187], v[136:139], v[208:223]
    v_mfma_f32_32x32x16_bf16 v[224:239], v[200:203], v[136:139], v[224:239]
    ds_read_b64_tr_b16 v[180:181], v4 offset:9216
    ds_read_b64_tr_b16 v[182:183], v4 offset:11520
    ds_read_b64_tr_b16 v[196:197], v7 offset:9216
    ds_read_b64_tr_b16 v[198:199], v7 offset:11520
    s_waitcnt lgkmcnt(8)
    v_mfma_f32_32x32x16_bf16 v[208:223], v[188:191], v[140:143], v[208:223]
    v_mfma_f32_32x32x16_bf16 v[224:239], v[204:207], v[140:143], v[224:239]
    ds_read_b64_tr_b16 v[184:185], v4 offset:18432
    ds_read_b64_tr_b16 v[186:187], v4 offset:20736
    ds_read_b64_tr_b16 v[200:201], v7 offset:18432
    ds_read_b64_tr_b16 v[202:203], v7 offset:20736
    s_waitcnt lgkmcnt(8)
    v_mfma_f32_32x32x16_bf16 v[208:223], v[176:179], v[144:147], v[208:223]
    v_mfma_f32_32x32x16_bf16 v[224:239], v[192:195], v[144:147], v[224:239]
    ds_read_b64_tr_b16 v[188:189], v4 offset:27648
    ds_read_b64_tr_b16 v[190:191], v4 offset:29952
    ds_read_b64_tr_b16 v[204:205], v7 offset:27648
    ds_read_b64_tr_b16 v[206:207], v7 offset:29952
    s_waitcnt lgkmcnt(8)
    v_mfma_f32_32x32x16_bf16 v[208:223], v[180:183], v[148:151], v[208:223]
    v_mfma_f32_32x32x16_bf16 v[224:239], v[196:199], v[148:151], v[224:239]
    s_waitcnt vmcnt(0)
    s_barrier
    ds_read_b64_tr_b16 v[176:177], v2 offset:0
    ds_read_b64_tr_b16 v[178:179], v2 offset:2304
    ds_read_b64_tr_b16 v[192:193], v5 offset:0
    ds_read_b64_tr_b16 v[194:195], v5 offset:2304
    s_waitcnt lgkmcnt(8)
    v_mfma_f32_32x32x16_bf16 v[208:223], v[184:187], v[152:155], v[208:223]
    v_mfma_f32_32x32x16_bf16 v[224:239], v[200:203], v[152:155], v[224:239]
    ds_read_b64_tr_b16 v[180:181], v2 offset:9216
    ds_read_b64_tr_b16 v[182:183], v2 offset:11520
    ds_read_b64_tr_b16 v[196:197], v5 offset:9216
    ds_read_b64_tr_b16 v[198:199], v5 offset:11520
    s_waitcnt lgkmcnt(8)
    v_mfma_f32_32x32x16_bf16 v[208:223], v[188:191], v[156:159], v[208:223]
    v_mfma_f32_32x32x16_bf16 v[224:239], v[204:207], v[156:159], v[224:239]
    ds_read_b64_tr_b16 v[184:185], v2 offset:18432
    ds_read_b64_tr_b16 v[186:187], v2 offset:20736
    ds_read_b64_tr_b16 v[200:201], v5 offset:18432
    ds_read_b64_tr_b16 v[202:203], v5 offset:20736
    s_waitcnt lgkmcnt(8)
    v_mfma_f32_32x32x16_bf16 v[208:223], v[176:179], v[160:163], v[208:223]
    v_mfma_f32_32x32x16_bf16 v[224:239], v[192:195], v[160:163], v[224:239]
    ds_read_b64_tr_b16 v[188:189], v2 offset:27648
    ds_read_b64_tr_b16 v[190:191], v2 offset:29952
    ds_read_b64_tr_b16 v[204:205], v5 offset:27648
    ds_read_b64_tr_b16 v[206:207], v5 offset:29952
    s_waitcnt lgkmcnt(8)
    v_mfma_f32_32x32x16_bf16 v[208:223], v[180:183], v[164:167], v[208:223]
    v_mfma_f32_32x32x16_bf16 v[224:239], v[196:199], v[164:167], v[224:239]
    s_waitcnt lgkmcnt(4)
    v_mfma_f32_32x32x16_bf16 v[208:223], v[184:187], v[168:171], v[208:223]
    v_mfma_f32_32x32x16_bf16 v[224:239], v[200:203], v[168:171], v[224:239]
    s_waitcnt lgkmcnt(0)
    v_mfma_f32_32x32x16_bf16 v[208:223], v[188:191], v[172:175], v[208:223]
    v_mfma_f32_32x32x16_bf16 v[224:239], v[204:207], v[172:175], v[224:239]
    s_nop 15
    s_lshl_b32 s40, s25, 1
    s_add_u32 s40, s40, s27
    s_lshl_b32 s41, s24, 2
    v_lshlrev_b32 v13, 4, v1
    s_cmp_eq_u32 s28, 1
    s_cbranch_scc1 K1_EPI_K
    s_lshl_b32 s42, s41, 6
    s_add_u32 s42, s42, s40
    s_lshl_b32 s42, s42, 10
    s_add_u32 s42, s42, 0
    s_mov_b32 s43, 0x3eae1a93
    v_mul_f32 v208, s43, v208
    v_mul_f32 v209, s43, v209
    v_mul_f32 v210, s43, v210
    v_mul_f32 v211, s43, v211
    v_mul_f32 v212, s43, v212
    v_mul_f32 v213, s43, v213
    v_mul_f32 v214, s43, v214
    v_mul_f32 v215, s43, v215
    v_mul_f32 v216, s43, v216
    v_mul_f32 v217, s43, v217
    v_mul_f32 v218, s43, v218
    v_mul_f32 v219, s43, v219
    v_mul_f32 v220, s43, v220
    v_mul_f32 v221, s43, v221
    v_mul_f32 v222, s43, v222
    v_mul_f32 v223, s43, v223
    v_cvt_pk_bf16_f32 v32, v208, v209
    v_cvt_pk_bf16_f32 v33, v210, v211
    v_cvt_pk_bf16_f32 v34, v212, v213
    v_cvt_pk_bf16_f32 v35, v214, v215
    v_cvt_pk_bf16_f32 v36, v216, v217
    v_cvt_pk_bf16_f32 v37, v218, v219
    v_cvt_pk_bf16_f32 v38, v220, v221
    v_cvt_pk_bf16_f32 v39, v222, v223
    buffer_store_dwordx4 v[32:35], v13, s[20:23], s42 offen sc1
    s_add_u32 s42, s42, 65536
    buffer_store_dwordx4 v[36:39], v13, s[20:23], s42 offen sc1
    s_add_u32 s42, s42, 65536
    v_mul_f32 v224, s43, v224
    v_mul_f32 v225, s43, v225
    v_mul_f32 v226, s43, v226
    v_mul_f32 v227, s43, v227
    v_mul_f32 v228, s43, v228
    v_mul_f32 v229, s43, v229
    v_mul_f32 v230, s43, v230
    v_mul_f32 v231, s43, v231
    v_mul_f32 v232, s43, v232
    v_mul_f32 v233, s43, v233
    v_mul_f32 v234, s43, v234
    v_mul_f32 v235, s43, v235
    v_mul_f32 v236, s43, v236
    v_mul_f32 v237, s43, v237
    v_mul_f32 v238, s43, v238
    v_mul_f32 v239, s43, v239
    v_cvt_pk_bf16_f32 v40, v224, v225
    v_cvt_pk_bf16_f32 v41, v226, v227
    v_cvt_pk_bf16_f32 v42, v228, v229
    v_cvt_pk_bf16_f32 v43, v230, v231
    v_cvt_pk_bf16_f32 v44, v232, v233
    v_cvt_pk_bf16_f32 v45, v234, v235
    v_cvt_pk_bf16_f32 v46, v236, v237
    v_cvt_pk_bf16_f32 v47, v238, v239
    buffer_store_dwordx4 v[40:43], v13, s[20:23], s42 offen sc1
    s_add_u32 s42, s42, 65536
    buffer_store_dwordx4 v[44:47], v13, s[20:23], s42 offen sc1
    s_add_u32 s42, s42, 65536
    s_endpgm
K1_EPI_K:
    s_mul_i32 s42, s41, 151552
    s_mul_i32 s43, s40, 1152
    s_add_u32 s42, s42, s43
    s_add_u32 s42, s42, 2359296
    v_cvt_pk_bf16_f32 v32, v208, v209
    v_cvt_pk_bf16_f32 v33, v210, v211
    v_cvt_pk_bf16_f32 v34, v212, v213
    v_cvt_pk_bf16_f32 v35, v214, v215
    v_cvt_pk_bf16_f32 v36, v216, v217
    v_cvt_pk_bf16_f32 v37, v218, v219
    v_cvt_pk_bf16_f32 v38, v220, v221
    v_cvt_pk_bf16_f32 v39, v222, v223
    buffer_store_dwordx4 v[32:35], v13, s[20:23], s42 offen sc1
    s_add_u32 s42, s42, 151552
    buffer_store_dwordx4 v[36:39], v13, s[20:23], s42 offen sc1
    s_add_u32 s42, s42, 151552
    v_cvt_pk_bf16_f32 v40, v224, v225
    v_cvt_pk_bf16_f32 v41, v226, v227
    v_cvt_pk_bf16_f32 v42, v228, v229
    v_cvt_pk_bf16_f32 v43, v230, v231
    v_cvt_pk_bf16_f32 v44, v232, v233
    v_cvt_pk_bf16_f32 v45, v234, v235
    v_cvt_pk_bf16_f32 v46, v236, v237
    v_cvt_pk_bf16_f32 v47, v238, v239
    buffer_store_dwordx4 v[40:43], v13, s[20:23], s42 offen sc1
    s_add_u32 s42, s42, 151552
    buffer_store_dwordx4 v[44:47], v13, s[20:23], s42 offen sc1
    s_add_u32 s42, s42, 151552
    s_endpgm
K1_VLOOP:
    s_waitcnt vmcnt(4)
    s_barrier
    ds_read_b64_tr_b16 v[176:177], v2 offset:0
    ds_read_b64_tr_b16 v[178:179], v2 offset:2304
    ds_read_b64_tr_b16 v[192:193], v5 offset:0
    ds_read_b64_tr_b16 v[194:195], v5 offset:2304
    ds_read_b64_tr_b16 v[180:181], v2 offset:9216
    ds_read_b64_tr_b16 v[182:183], v2 offset:11520
    ds_read_b64_tr_b16 v[196:197], v5 offset:9216
    ds_read_b64_tr_b16 v[198:199], v5 offset:11520
    ds_read_b64_tr_b16 v[184:185], v2 offset:18432
    ds_read_b64_tr_b16 v[186:187], v2 offset:20736
    ds_read_b64_tr_b16 v[200:201], v5 offset:18432
    ds_read_b64_tr_b16 v[202:203], v5 offset:20736
    s_waitcnt lgkmcnt(8)
    v_mfma_f32_32x32x16_bf16 v[208:223], v[32:35], v[176:179], 0
    v_mfma_f32_32x32x16_bf16 v[224:239], v[32:35], v[192:195], 0
    s_add_u32 m0, s35, 110592
    s_nop 0
    buffer_load_dwordx4 v240, s[16:19], s36 offen lds
    ds_read_b64_tr_b16 v[188:189], v2 offset:27648
    ds_read_b64_tr_b16 v[190:191], v2 offset:29952
    ds_read_b64_tr_b16 v[204:205], v5 offset:27648
    ds_read_b64_tr_b16 v[206:207], v5 offset:29952
    s_waitcnt lgkmcnt(8)
    v_mfma_f32_32x32x16_bf16 v[208:223], v[36:39], v[180:183], v[208:223]
    v_mfma_f32_32x32x16_bf16 v[224:239], v[36:39], v[196:199], v[224:239]
    s_add_u32 m0, s35, 118784
    s_nop 0
    buffer_load_dwordx4 v241, s[16:19], s36 offen lds
    s_waitcnt vmcnt(6)
    s_barrier
    ds_read_b64_tr_b16 v[176:177], v2 offset:36864
    ds_read_b64_tr_b16 v[178:179], v2 offset:39168
    ds_read_b64_tr_b16 v[192:193], v5 offset:36864
    ds_read_b64_tr_b16 v[194:195], v5 offset:39168
    s_waitcnt lgkmcnt(8)
    v_mfma_f32_32x32x16_bf16 v[208:223], v[40:43], v[184:187], v[208:223]
    v_mfma_f32_32x32x16_bf16 v[224:239], v[40:43], v[200:203], v[224:239]
    s_add_u32 m0, s35, 126976
    s_nop 0
    buffer_load_dwordx4 v242, s[16:19], s36 offen lds
    ds_read_b64_tr_b16 v[180:181], v2 offset:46080
    ds_read_b64_tr_b16 v[182:183], v2 offset:48384
    ds_read_b64_tr_b16 v[196:197], v5 offset:46080
    ds_read_b64_tr_b16 v[198:199], v5 offset:48384
    s_waitcnt lgkmcnt(8)
    v_mfma_f32_32x32x16_bf16 v[208:223], v[44:47], v[188:191], v[208:223]
    v_mfma_f32_32x32x16_bf16 v[224:239], v[44:47], v[204:207], v[224:239]
    s_add_u32 m0, s35, 135168
    s_nop 0
    buffer_load_dwordx4 v243, s[16:19], s36 offen lds
    ds_read_b64_tr_b16 v[184:185], v3 offset:0
    ds_read_b64_tr_b16 v[186:187], v3 offset:2304
    ds_read_b64_tr_b16 v[200:201], v6 offset:0
    ds_read_b64_tr_b16 v[202:203], v6 offset:2304
    s_waitcnt lgkmcnt(8)
    v_mfma_f32_32x32x16_bf16 v[208:223], v[48:51], v[176:179], v[208:223]
    v_mfma_f32_32x32x16_bf16 v[224:239], v[48:51], v[192:195], v[224:239]
    s_cmp_ge_u32 s26, 4
    s_cbranch_scc1 K1_Dv3
    s_add_u32 m0, s35, 143360
    s_nop 0
    buffer_load_dwordx4 v244, s[16:19], s36 offen lds
K1_Dv3:
    s_add_u32 s36, s36, 221184
    ds_read_b64_tr_b16 v[188:189], v3 offset:9216
    ds_read_b64_tr_b16 v[190:191], v3 offset:11520
    ds_read_b64_tr_b16 v[204:205], v6 offset:9216
    ds_read_b64_tr_b16 v[206:207], v6 offset:11520
    s_waitcnt lgkmcnt(8)
    v_mfma_f32_32x32x16_bf16 v[208:223], v[52:55], v[180:183], v[208:223]
    v_mfma_f32_32x32x16_bf16 v[224:239], v[52:55], v[196:199], v[224:239]
    s_waitcnt vmcnt(4)
    s_barrier
    ds_read_b64_tr_b16 v[176:177], v3 offset:18432
    ds_read_b64_tr_b16 v[178:179], v3 offset:20736
    ds_read_b64_tr_b16 v[192:193], v6 offset:18432
    ds_read_b64_tr_b16 v[194:195], v6 offset:20736
    s_waitcnt lgkmcnt(8)
    v_mfma_f32_32x32x16_bf16 v[208:223], v[56:59], v[184:187], v[208:223]
    v_mfma_f32_32x32x16_bf16 v[224:239], v[56:59], v[200:203], v[224:239]
    s_add_u32 m0, s35, 0
    s_nop 0
    buffer_load_dwordx4 v240, s[16:19], s36 offen lds
    ds_read_b64_tr_b16 v[180:181], v3 offset:27648
    ds_read_b64_tr_b16 v[182:183], v3 offset:29952
    ds_read_b64_tr_b16 v[196:197], v6 offset:27648
    ds_read_b64_tr_b16 v[198:199], v6 offset:29952
    s_waitcnt lgkmcnt(8)
    v_mfma_f32_32x32x16_bf16 v[208:223], v[60:63], v[188:191], v[208:223]
    v_mfma_f32_32x32x16_bf16 v[224:239], v[60:63], v[204:207], v[224:239]
    s_add_u32 m0, s35, 8192
    s_nop 0
    buffer_load_dwordx4 v241, s[16:19], s36 offen lds
    ds_read_b64_tr_b16 v[184:185], v3 offset:36864
    ds_read_b64_tr_b16 v[186:187], v3 offset:39168
    ds_read_b64_tr_b16 v[200:201], v6 offset:36864
    ds_read_b64_tr_b16 v[202:203], v6 offset:39168
    s_waitcnt lgkmcnt(8)
    v_mfma_f32_32x32x16_bf16 v[208:223], v[64:67], v[176:179], v[208:223]
    v_mfma_f32_32x32x16_bf16 v[224:239], v[64:67], v[192:195], v[224:239]
    s_add_u32 m0, s35, 16384
    s_nop 0
    buffer_load_dwordx4 v242, s[16:19], s36 offen lds
    ds_read_b64_tr_b16 v[188:189], v3 offset:46080
    ds_read_b64_tr_b16 v[190:191], v3 offset:48384
    ds_read_b64_tr_b16 v[204:205], v6 offset:46080
    ds_read_b64_tr_b16 v[206:207], v6 offset:48384
    s_waitcnt lgkmcnt(8)
    v_mfma_f32_32x32x16_bf16 v[208:223], v[68:71], v[180:183], v[208:223]
    v_mfma_f32_32x32x16_bf16 v[224:239], v[68:71], v[196:199], v[224:239]
    s_add_u32 m0, s35, 24576
    s_nop 0
    buffer_load_dwordx4 v243, s[16:19], s36 offen lds
    s_cmp_ge_u32 s26, 4
    s_cbranch_scc1 K1_Dv4
    s_add_u32 m0, s35, 32768
    s_nop 0
    buffer_load_dwordx4 v244, s[16:19], s36 offen lds
K1_Dv4:
    s_add_u32 s36, s36, 221184
    s_waitcnt vmcnt(4)
    s_barrier
    ds_read_b64_tr_b16 v[176:177], v4 offset:0
    ds_read_b64_tr_b16 v[178:179], v4 offset:2304
    ds_read_b64_tr_b16 v[192:193], v7 offset:0
    ds_read_b64_tr_b16 v[194:195], v7 offset:2304
    s_waitcnt lgkmcnt(8)
    v_mfma_f32_32x32x16_bf16 v[208:223], v[72:75], v[184:187], v[208:223]
    v_mfma_f32_32x32x16_bf16 v[224:239], v[72:75], v[200:203], v[224:239]
    s_add_u32 m0, s35, 36864
    s_nop 0
    buffer_load_dwordx4 v240, s[16:19], s36 offen lds
    ds_read_b64_tr_b16 v[180:181], v4 offset:9216
    ds_read_b64_tr_b16 v[182:183], v4 offset:11520
    ds_read_b64_tr_b16 v[196:197], v7 offset:9216
    ds_read_b64_tr_b16 v[198:199], v7 offset:11520
    s_waitcnt lgkmcnt(8)
    v_mfma_f32_32x32x16_bf16 v[208:223], v[76:79], v[188:191], v[208:223]
    v_mfma_f32_32x32x16_bf16 v[224:239], v[76:79], v[204:207], v[224:239]
    s_add_u32 m0, s35, 45056
    s_nop 0
    buffer_load_dwordx4 v241, s[16:19], s36 offen lds
    ds_read_b64_tr_b16 v[184:185], v4 offset:18432
    ds_read_b64_tr_b16 v[186:187], v4 offset:20736
    ds_read_b64_tr_b16 v[200:201], v7 offset:18432
    ds_read_b64_tr_b16 v[202:203], v7 offset:20736
    s_waitcnt lgkmcnt(8)
    v_mfma_f32_32x32x16_bf16 v[208:223], v[80:83], v[176:179], v[208:223]
    v_mfma_f32_32x32x16_bf16 v[224:239], v[80:83], v[192:195], v[224:239]
    s_add_u32 m0, s35, 53248
    s_nop 0
    buffer_load_dwordx4 v242, s[16:19], s36 offen lds
    ds_read_b64_tr_b16 v[188:189], v4 offset:27648
    ds_read_b64_tr_b16 v[190:191], v4 offset:29952
    ds_read_b64_tr_b16 v[204:205], v7 offset:27648
    ds_read_b64_tr_b16 v[206:207], v7 offset:29952
    s_waitcnt lgkmcnt(8)
    v_mfma_f32_32x32x16_bf16 v[208:223], v[84:87], v[180:183], v[208:223]
    v_mfma_f32_32x32x16_bf16 v[224:239], v[84:87], v[196:199], v[224:239]
    s_add_u32 m0, s35, 61440
    s_nop 0
    buffer_load_dwordx4 v243, s[16:19], s36 offen lds
    s_cmp_ge_u32 s26, 4
    s_cbranch_scc1 K1_Dv5
    s_add_u32 m0, s35, 69632
    s_nop 0
    buffer_load_dwordx4 v244, s[16:19], s36 offen lds
K1_Dv5:
    s_add_u32 s36, s36, 221184
    s_waitcnt vmcnt(4)
    s_barrier
    ds_read_b64_tr_b16 v[176:177], v2 offset:0
    ds_read_b64_tr_b16 v[178:179], v2 offset:2304
    ds_read_b64_tr_b16 v[192:193], v5 offset:0
    ds_read_b64_tr_b16 v[194:195], v5 offset:2304
    s_waitcnt lgkmcnt(8)
    v_mfma_f32_32x32x16_bf16 v[208:223], v[88:91], v[184:187], v[208:223]
    v_mfma_f32_32x32x16_bf16 v[224:239], v[88:91], v[200:203], v[224:239]
    s_add_u32 m0, s35, 73728
    s_nop 0
    buffer_load_dwordx4 v240, s[16:19], s36 offen lds
    ds_read_b64_tr_b16 v[180:181], v2 offset:9216
    ds_read_b64_tr_b16 v[182:183], v2 offset:11520
    ds_read_b64_tr_b16 v[196:197], v5 offset:9216
    ds_read_b64_tr_b16 v[198:199], v5 offset:11520
    s_waitcnt lgkmcnt(8)
    v_mfma_f32_32x32x16_bf16 v[208:223], v[92:95], v[188:191], v[208:223]
    v_mfma_f32_32x32x16_bf16 v[224:239], v[92:95], v[204:207], v[224:239]
    s_add_u32 m0, s35, 81920
    s_nop 0
    buffer_load_dwordx4 v241, s[16:19], s36 offen lds
    ds_read_b64_tr_b16 v[184:185], v2 offset:18432
    ds_read_b64_tr_b16 v[186:187], v2 offset:20736
    ds_read_b64_tr_b16 v[200:201], v5 offset:18432
    ds_read_b64_tr_b16 v[202:203], v5 offset:20736
    s_waitcnt lgkmcnt(8)
    v_mfma_f32_32x32x16_bf16 v[208:223], v[96:99], v[176:179], v[208:223]
    v_mfma_f32_32x32x16_bf16 v[224:239], v[96:99], v[192:195], v[224:239]
    s_add_u32 m0, s35, 90112
    s_nop 0
    buffer_load_dwordx4 v242, s[16:19], s36 offen lds
    ds_read_b64_tr_b16 v[188:189], v2 offset:27648
    ds_read_b64_tr_b16 v[190:191], v2 offset:29952
    ds_read_b64_tr_b16 v[204:205], v5 offset:27648
    ds_read_b64_tr_b16 v[206:207], v5 offset:29952
    s_waitcnt lgkmcnt(8)
    v_mfma_f32_32x32x16_bf16 v[208:223], v[100:103], v[180:183], v[208:223]
    v_mfma_f32_32x32x16_bf16 v[224:239], v[100:103], v[196:199], v[224:239]
    s_add_u32 m0, s35, 98304
    s_nop 0
    buffer_load_dwordx4 v243, s[16:19], s36 offen lds
    s_cmp_ge_u32 s26, 4
    s_cbranch_scc1 K1_Dv6
    s_add_u32 m0, s35, 106496
    s_nop 0
    buffer_load_dwordx4 v244, s[16:19], s36 offen lds
K1_Dv6:
    s_add_u32 s36, s36, 221184
    s_waitcnt vmcnt(4)
    s_barrier
    ds_read_b64_tr_b16 v[176:177], v2 offset:36864
    ds_read_b64_tr_b16 v[178:179], v2 offset:39168
    ds_read_b64_tr_b16 v[192:193], v5 offset:36864
    ds_read_b64_tr_b16 v[194:195], v5 offset:39168
    s_waitcnt lgkmcnt(8)
    v_mfma_f32_32x32x16_bf16 v[208:223], v[104:107], v[184:187], v[208:223]
    v_mfma_f32_32x32x16_bf16 v[224:239], v[104:107], v[200:203], v[224:239]
    s_add_u32 m0, s35, 110592
    s_nop 0
    buffer_load_dwordx4 v240, s[16:19], s36 offen lds
    ds_read_b64_tr_b16 v[180:181], v2 offset:46080
    ds_read_b64_tr_b16 v[182:183], v2 offset:48384
    ds_read_b64_tr_b16 v[196:197], v5 offset:46080
    ds_read_b64_tr_b16 v[198:199], v5 offset:48384
    s_waitcnt lgkmcnt(8)
    v_mfma_f32_32x32x16_bf16 v[208:223], v[108:111], v[188:191], v[208:223]
    v_mfma_f32_32x32x16_bf16 v[224:239], v[108:111], v[204:207], v[224:239]
    s_add_u32 m0, s35, 118784
    s_nop 0
    buffer_load_dwordx4 v241, s[16:19], s36 offen lds
    ds_read_b64_tr_b16 v[184:185], v3 offset:0
    ds_read_b64_tr_b16 v[186:187], v3 offset:2304
    ds_read_b64_tr_b16 v[200:201], v6 offset:0
    ds_read_b64_tr_b16 v[202:203], v6 offset:2304
    s_waitcnt lgkmcnt(8)
    v_mfma_f32_32x32x16_bf16 v[208:223], v[112:115], v[176:179], v[208:223]
    v_mfma_f32_32x32x16_bf16 v[224:239], v[112:115], v[192:195], v[224:239]
    s_add_u32 m0, s35, 126976
    s_nop 0
    buffer_load_dwordx4 v242, s[16:19], s36 offen lds
    ds_read_b64_tr_b16 v[188:189], v3 offset:9216
    ds_read_b64_tr_b16 v[190:191], v3 offset:11520
    ds_read_b64_tr_b16 v[204:205], v6 offset:9216
    ds_read_b64_tr_b16 v[206:207], v6 offset:11520
    s_waitcnt lgkmcnt(8)
    v_mfma_f32_32x32x16_bf16 v[208:223], v[116:119], v[180:183], v[208:223]
    v_mfma_f32_32x32x16_bf16 v[224:239], v[116:119], v[196:199], v[224:239]
    s_add_u32 m0, s35, 135168
    s_nop 0
    buffer_load_dwordx4 v243, s[16:19], s36 offen lds
    s_cmp_ge_u32 s26, 4
    s_cbranch_scc1 K1_Dv7
    s_add_u32 m0, s35, 143360
    s_nop 0
    buffer_load_dwordx4 v244, s[16:19], s36 offen lds
K1_Dv7:
    s_add_u32 s36, s36, 221184
    s_waitcnt vmcnt(4)
    s_barrier
    ds_read_b64_tr_b16 v[176:177], v3 offset:18432
    ds_read_b64_tr_b16 v[178:179], v3 offset:20736
    ds_read_b64_tr_b16 v[192:193], v6 offset:18432
    ds_read_b64_tr_b16 v[194:195], v6 offset:20736
    s_waitcnt lgkmcnt(8)
    v_mfma_f32_32x32x16_bf16 v[208:223], v[120:123], v[184:187], v[208:223]
    v_mfma_f32_32x32x16_bf16 v[224:239], v[120:123], v[200:203], v[224:239]
    s_add_u32 m0, s35, 0
    s_nop 0
    buffer_load_dwordx4 v240, s[16:19], s36 offen lds
    ds_read_b64_tr_b16 v[180:181], v3 offset:27648
    ds_read_b64_tr_b16 v[182:183], v3 offset:29952
    ds_read_b64_tr_b16 v[196:197], v6 offset:27648
    ds_read_b64_tr_b16 v[198:199], v6 offset:29952
    s_waitcnt lgkmcnt(8)
    v_mfma_f32_32x32x16_bf16 v[208:223], v[124:127], v[188:191], v[208:223]
    v_mfma_f32_32x32x16_bf16 v[224:239], v[124:127], v[204:207], v[224:239]
    s_add_u32 m0, s35, 8192
    s_nop 0
    buffer_load_dwordx4 v241, s[16:19], s36 offen lds
    ds_read_b64_tr_b16 v[184:185], v3 offset:36864
    ds_read_b64_tr_b16 v[186:187], v3 offset:39168
    ds_read_b64_tr_b16 v[200:201], v6 offset:36864
    ds_read_b64_tr_b16 v[202:203], v6 offset:39168
    s_waitcnt lgkmcnt(8)
    v_mfma_f32_32x32x16_bf16 v[208:223], v[128:131], v[176:179], v[208:223]
    v_mfma_f32_32x32x16_bf16 v[224:239], v[128:131], v[192:195], v[224:239]
    s_add_u32 m0, s35, 16384
    s_nop 0
    buffer_load_dwordx4 v242, s[16:19], s36 offen lds
    ds_read_b64_tr_b16 v[188:189], v3 offset:46080
    ds_read_b64_tr_b16 v[190:191], v3 offset:48384
    ds_read_b64_tr_b16 v[204:205], v6 offset:46080
    ds_read_b64_tr_b16 v[206:207], v6 offset:48384
    s_waitcnt lgkmcnt(8)
    v_mfma_f32_32x32x16_bf16 v[208:223], v[132:135], v[180:183], v[208:223]
    v_mfma_f32_32x32x16_bf16 v[224:239], v[132:135], v[196:199], v[224:239]
    s_add_u32 m0, s35, 24576
    s_nop 0
    buffer_load_dwordx4 v243, s[16:19], s36 offen lds
    s_cmp_ge_u32 s26, 4
    s_cbranch_scc1 K1_Dv8
    s_add_u32 m0, s35, 32768
    s_nop 0
    buffer_load_dwordx4 v244, s[16:19], s36 offen lds
K1_Dv8:
    s_add_u32 s36, s36, 221184
    s_waitcnt vmcnt(4)
    s_barrier
    ds_read_b64_tr_b16 v[176:177], v4 offset:0
    ds_read_b64_tr_b16 v[178:179], v4 offset:2304
    ds_read_b64_tr_b16 v[192:193], v7 offset:0
    ds_read_b64_tr_b16 v[194:195], v7 offset:2304
    s_waitcnt lgkmcnt(8)
    v_mfma_f32_32x32x16_bf16 v[208:223], v[136:139], v[184:187], v[208:223]
    v_mfma_f32_32x32x16_bf16 v[224:239], v[136:139], v[200:203], v[224:239]
    ds_read_b64_tr_b16 v[180:181], v4 offset:9216
    ds_read_b64_tr_b16 v[182:183], v4 offset:11520
    ds_read_b64_tr_b16 v[196:197], v7 offset:9216
    ds_read_b64_tr_b16 v[198:199], v7 offset:11520
    s_waitcnt lgkmcnt(8)
    v_mfma_f32_32x32x16_bf16 v[208:223], v[140:143], v[188:191], v[208:223]
    v_mfma_f32_32x32x16_bf16 v[224:239], v[140:143], v[204:207], v[224:239]
    ds_read_b64_tr_b16 v[184:185], v4 offset:18432
    ds_read_b64_tr_b16 v[186:187], v4 offset:20736
    ds_read_b64_tr_b16 v[200:201], v7 offset:18432
    ds_read_b64_tr_b16 v[202:203], v7 offset:20736
    s_waitcnt lgkmcnt(8)
    v_mfma_f32_32x32x16_bf16 v[208:223], v[144:147], v[176:179], v[208:223]
    v_mfma_f32_32x32x16_bf16 v[224:239], v[144:147], v[192:195], v[224:239]
    ds_read_b64_tr_b16 v[188:189], v4 offset:27648
    ds_read_b64_tr_b16 v[190:191], v4 offset:29952
    ds_read_b64_tr_b16 v[204:205], v7 offset:27648
    ds_read_b64_tr_b16 v[206:207], v7 offset:29952
    s_waitcnt lgkmcnt(8)
    v_mfma_f32_32x32x16_bf16 v[208:223], v[148:151], v[180:183], v[208:223]
    v_mfma_f32_32x32x16_bf16 v[224:239], v[148:151], v[196:199], v[224:239]
    s_waitcnt vmcnt(0)
    s_barrier
    ds_read_b64_tr_b16 v[176:177], v2 offset:0
    ds_read_b64_tr_b16 v[178:179], v2 offset:2304
    ds_read_b64_tr_b16 v[192:193], v5 offset:0
    ds_read_b64_tr_b16 v[194:195], v5 offset:2304
    s_waitcnt lgkmcnt(8)
    v_mfma_f32_32x32x16_bf16 v[208:223], v[152:155], v[184:187], v[208:223]
    v_mfma_f32_32x32x16_bf16 v[224:239], v[152:155], v[200:203], v[224:239]
    ds_read_b64_tr_b16 v[180:181], v2 offset:9216
    ds_read_b64_tr_b16 v[182:183], v2 offset:11520
    ds_read_b64_tr_b16 v[196:197], v5 offset:9216
    ds_read_b64_tr_b16 v[198:199], v5 offset:11520
    s_waitcnt lgkmcnt(8)
    v_mfma_f32_32x32x16_bf16 v[208:223], v[156:159], v[188:191], v[208:223]
    v_mfma_f32_32x32x16_bf16 v[224:239], v[156:159], v[204:207], v[224:239]
    ds_read_b64_tr_b16 v[184:185], v2 offset:18432
    ds_read_b64_tr_b16 v[186:187], v2 offset:20736
    ds_read_b64_tr_b16 v[200:201], v5 offset:18432
    ds_read_b64_tr_b16 v[202:203], v5 offset:20736
    s_waitcnt lgkmcnt(8)
    v_mfma_f32_32x32x16_bf16 v[208:223], v[160:163], v[176:179], v[208:223]
    v_mfma_f32_32x32x16_bf16 v[224:239], v[160:163], v[192:195], v[224:239]
    ds_read_b64_tr_b16 v[188:189], v2 offset:27648
    ds_read_b64_tr_b16 v[190:191], v2 offset:29952
    ds_read_b64_tr_b16 v[204:205], v5 offset:27648
    ds_read_b64_tr_b16 v[206:207], v5 offset:29952
    s_waitcnt lgkmcnt(8)
    v_mfma_f32_32x32x16_bf16 v[208:223], v[164:167], v[180:183], v[208:223]
    v_mfma_f32_32x32x16_bf16 v[224:239], v[164:167], v[196:199], v[224:239]
    s_waitcnt lgkmcnt(4)
    v_mfma_f32_32x32x16_bf16 v[208:223], v[168:171], v[184:187], v[208:223]
    v_mfma_f32_32x32x16_bf16 v[224:239], v[168:171], v[200:203], v[224:239]
    s_waitcnt lgkmcnt(0)
    v_mfma_f32_32x32x16_bf16 v[208:223], v[172:175], v[188:191], v[208:223]
    v_mfma_f32_32x32x16_bf16 v[224:239], v[172:175], v[204:207], v[224:239]
    s_nop 15
    s_lshl_b32 s40, s25, 1
    s_add_u32 s40, s40, s27
    s_lshl_b32 s41, s24, 2
    v_lshlrev_b32 v13, 4, v1
    v_bfe_u32 v13, v1, 4, 1
    s_mov_b32 s44, 151552
    v_mul_lo_u32 v13, v13, s44
    v_and_b32 v14, 15, v1
    v_lshl_add_u32 v13, v14, 4, v13
    v_lshrrev_b32 v14, 5, v1
    v_mul_u32_u24 v14, 304, v14
    v_add_u32 v13, v13, v14
    s_mul_i32 s42, s41, 151552
    s_mul_i32 s43, s40, 1216
    s_add_u32 s42, s42, s43
    s_add_u32 s42, s42, 2433024
    v_cvt_pk_bf16_f32 v32, v208, v209
    v_cvt_pk_bf16_f32 v33, v210, v211
    v_cvt_pk_bf16_f32 v34, v212, v213
    v_cvt_pk_bf16_f32 v35, v214, v215
    v_cvt_pk_bf16_f32 v36, v216, v217
    v_cvt_pk_bf16_f32 v37, v218, v219
    v_cvt_pk_bf16_f32 v38, v220, v221
    v_cvt_pk_bf16_f32 v39, v222, v223
    buffer_store_dwordx4 v[32:35], v13, s[20:23], s42 offen sc1
    buffer_store_dwordx4 v[36:39], v13, s[20:23], s42 offen offset:608 sc1
    s_add_u32 s42, s42, 303104
    v_cvt_pk_bf16_f32 v40, v224, v225
    v_cvt_pk_bf16_f32 v41, v226, v227
    v_cvt_pk_bf16_f32 v42, v228, v229
    v_cvt_pk_bf16_f32 v43, v230, v231
    v_cvt_pk_bf16_f32 v44, v232, v233
    v_cvt_pk_bf16_f32 v45, v234, v235
    v_cvt_pk_bf16_f32 v46, v236, v237
    v_cvt_pk_bf16_f32 v47, v238, v239
    buffer_store_dwordx4 v[40:43], v13, s[20:23], s42 offen sc1
    buffer_store_dwordx4 v[44:47], v13, s[20:23], s42 offen offset:608 sc1
    s_endpgm
K1_RLOOP:
    s_waitcnt vmcnt(4)
    s_barrier
    ds_read_b64_tr_b16 v[176:177], v2 offset:0
    ds_read_b64_tr_b16 v[178:179], v2 offset:2304
    ds_read_b64_tr_b16 v[180:181], v2 offset:9216
    ds_read_b64_tr_b16 v[182:183], v2 offset:11520
    ds_read_b64_tr_b16 v[184:185], v2 offset:18432
    ds_read_b64_tr_b16 v[186:187], v2 offset:20736
    s_waitcnt lgkmcnt(4)
    v_mfma_f32_32x32x16_bf16 v[208:223], v[176:179], v[32:35], 0
    s_add_u32 m0, s35, 110592
    s_nop 0
    buffer_load_dwordx4 v240, s[16:19], s36 offen lds
    ds_read_b64_tr_b16 v[188:189], v2 offset:27648
    ds_read_b64_tr_b16 v[190:191], v2 offset:29952
    s_waitcnt lgkmcnt(4)
    v_mfma_f32_32x32x16_bf16 v[208:223], v[180:183], v[36:39], v[208:223]
    s_add_u32 m0, s35, 118784
    s_nop 0
    buffer_load_dwordx4 v241, s[16:19], s36 offen lds
    s_waitcnt vmcnt(6)
    s_barrier
    ds_read_b64_tr_b16 v[176:177], v2 offset:36864
    ds_read_b64_tr_b16 v[178:179], v2 offset:39168
    s_waitcnt lgkmcnt(4)
    v_mfma_f32_32x32x16_bf16 v[208:223], v[184:187], v[40:43], v[208:223]
    s_add_u32 m0, s35, 126976
    s_nop 0
    buffer_load_dwordx4 v242, s[16:19], s36 offen lds
    ds_read_b64_tr_b16 v[180:181], v2 offset:46080
    ds_read_b64_tr_b16 v[182:183], v2 offset:48384
    s_waitcnt lgkmcnt(4)
    v_mfma_f32_32x32x16_bf16 v[208:223], v[188:191], v[44:47], v[208:223]
    s_add_u32 m0, s35, 135168
    s_nop 0
    buffer_load_dwordx4 v243, s[16:19], s36 offen lds
    ds_read_b64_tr_b16 v[184:185], v3 offset:0
    ds_read_b64_tr_b16 v[186:187], v3 offset:2304
    s_waitcnt lgkmcnt(4)
    v_mfma_f32_32x32x16_bf16 v[208:223], v[176:179], v[48:51], v[208:223]
    s_cmp_ge_u32 s26, 4
    s_cbranch_scc1 K1_Dr3
    s_add_u32 m0, s35, 143360
    s_nop 0
    buffer_load_dwordx4 v244, s[16:19], s36 offen lds
K1_Dr3:
    s_add_u32 s36, s36, 221184
    ds_read_b64_tr_b16 v[188:189], v3 offset:9216
    ds_read_b64_tr_b16 v[190:191], v3 offset:11520
    s_waitcnt lgkmcnt(4)
    v_mfma_f32_32x32x16_bf16 v[208:223], v[180:183], v[52:55], v[208:223]
    s_waitcnt vmcnt(4)
    s_barrier
    ds_read_b64_tr_b16 v[176:177], v3 offset:18432
    ds_read_b64_tr_b16 v[178:179], v3 offset:20736
    s_waitcnt lgkmcnt(4)
    v_mfma_f32_32x32x16_bf16 v[208:223], v[184:187], v[56:59], v[208:223]
    s_add_u32 m0, s35, 0
    s_nop 0
    buffer_load_dwordx4 v240, s[16:19], s36 offen lds
    ds_read_b64_tr_b16 v[180:181], v3 offset:27648
    ds_read_b64_tr_b16 v[182:183], v3 offset:29952
    s_waitcnt lgkmcnt(4)
    v_mfma_f32_32x32x16_bf16 v[208:223], v[188:191], v[60:63], v[208:223]
    s_add_u32 m0, s35, 8192
    s_nop 0
    buffer_load_dwordx4 v241, s[16:19], s36 offen lds
    ds_read_b64_tr_b16 v[184:185], v3 offset:36864
    ds_read_b64_tr_b16 v[186:187], v3 offset:39168
    s_waitcnt lgkmcnt(4)
    v_mfma_f32_32x32x16_bf16 v[208:223], v[176:179], v[64:67], v[208:223]
    s_add_u32 m0, s35, 16384
    s_nop 0
    buffer_load_dwordx4 v242, s[16:19], s36 offen lds
    ds_read_b64_tr_b16 v[188:189], v3 offset:46080
    ds_read_b64_tr_b16 v[190:191], v3 offset:48384
    s_waitcnt lgkmcnt(4)
    v_mfma_f32_32x32x16_bf16 v[208:223], v[180:183], v[68:71], v[208:223]
    s_add_u32 m0, s35, 24576
    s_nop 0
    buffer_load_dwordx4 v243, s[16:19], s36 offen lds
    s_cmp_ge_u32 s26, 4
    s_cbranch_scc1 K1_Dr4
    s_add_u32 m0, s35, 32768
    s_nop 0
    buffer_load_dwordx4 v244, s[16:19], s36 offen lds
K1_Dr4:
    s_add_u32 s36, s36, 221184
    s_waitcnt vmcnt(4)
    s_barrier
    ds_read_b64_tr_b16 v[176:177], v4 offset:0
    ds_read_b64_tr_b16 v[178:179], v4 offset:2304
    s_waitcnt lgkmcnt(4)
    v_mfma_f32_32x32x16_bf16 v[208:223], v[184:187], v[72:75], v[208:223]
    s_add_u32 m0, s35, 36864
    s_nop 0
    buffer_load_dwordx4 v240, s[16:19], s36 offen lds
    ds_read_b64_tr_b16 v[180:181], v4 offset:9216
    ds_read_b64_tr_b16 v[182:183], v4 offset:11520
    s_waitcnt lgkmcnt(4)
    v_mfma_f32_32x32x16_bf16 v[208:223], v[188:191], v[76:79], v[208:223]
    s_add_u32 m0, s35, 45056
    s_nop 0
    buffer_load_dwordx4 v241, s[16:19], s36 offen lds
    ds_read_b64_tr_b16 v[184:185], v4 offset:18432
    ds_read_b64_tr_b16 v[186:187], v4 offset:20736
    s_waitcnt lgkmcnt(4)
    v_mfma_f32_32x32x16_bf16 v[208:223], v[176:179], v[80:83], v[208:223]
    s_add_u32 m0, s35, 53248
    s_nop 0
    buffer_load_dwordx4 v242, s[16:19], s36 offen lds
    ds_read_b64_tr_b16 v[188:189], v4 offset:27648
    ds_read_b64_tr_b16 v[190:191], v4 offset:29952
    s_waitcnt lgkmcnt(4)
    v_mfma_f32_32x32x16_bf16 v[208:223], v[180:183], v[84:87], v[208:223]
    s_add_u32 m0, s35, 61440
    s_nop 0
    buffer_load_dwordx4 v243, s[16:19], s36 offen lds
    s_cmp_ge_u32 s26, 4
    s_cbranch_scc1 K1_Dr5
    s_add_u32 m0, s35, 69632
    s_nop 0
    buffer_load_dwordx4 v244, s[16:19], s36 offen lds
K1_Dr5:
    s_add_u32 s36, s36, 221184
    s_waitcnt vmcnt(4)
    s_barrier
    ds_read_b64_tr_b16 v[176:177], v2 offset:0
    ds_read_b64_tr_b16 v[178:179], v2 offset:2304
    s_waitcnt lgkmcnt(4)
    v_mfma_f32_32x32x16_bf16 v[208:223], v[184:187], v[88:91], v[208:223]
    s_add_u32 m0, s35, 73728
    s_nop 0
    buffer_load_dwordx4 v240, s[16:19], s36 offen lds
    ds_read_b64_tr_b16 v[180:181], v2 offset:9216
    ds_read_b64_tr_b16 v[182:183], v2 offset:11520
    s_waitcnt lgkmcnt(4)
    v_mfma_f32_32x32x16_bf16 v[208:223], v[188:191], v[92:95], v[208:223]
    s_add_u32 m0, s35, 81920
    s_nop 0
    buffer_load_dwordx4 v241, s[16:19], s36 offen lds
    ds_read_b64_tr_b16 v[184:185], v2 offset:18432
    ds_read_b64_tr_b16 v[186:187], v2 offset:20736
    s_waitcnt lgkmcnt(4)
    v_mfma_f32_32x32x16_bf16 v[208:223], v[176:179], v[96:99], v[208:223]
    s_add_u32 m0, s35, 90112
    s_nop 0
    buffer_load_dwordx4 v242, s[16:19], s36 offen lds
    ds_read_b64_tr_b16 v[188:189], v2 offset:27648
    ds_read_b64_tr_b16 v[190:191], v2 offset:29952
    s_waitcnt lgkmcnt(4)
    v_mfma_f32_32x32x16_bf16 v[208:223], v[180:183], v[100:103], v[208:223]
    s_add_u32 m0, s35, 98304
    s_nop 0
    buffer_load_dwordx4 v243, s[16:19], s36 offen lds
    s_cmp_ge_u32 s26, 4
    s_cbranch_scc1 K1_Dr6
    s_add_u32 m0, s35, 106496
    s_nop 0
    buffer_load_dwordx4 v244, s[16:19], s36 offen lds
K1_Dr6:
    s_add_u32 s36, s36, 221184
    s_waitcnt vmcnt(4)
    s_barrier
    ds_read_b64_tr_b16 v[176:177], v2 offset:36864
    ds_read_b64_tr_b16 v[178:179], v2 offset:39168
    s_waitcnt lgkmcnt(4)
    v_mfma_f32_32x32x16_bf16 v[208:223], v[184:187], v[104:107], v[208:223]
    s_add_u32 m0, s35, 110592
    s_nop 0
    buffer_load_dwordx4 v240, s[16:19], s36 offen lds
    ds_read_b64_tr_b16 v[180:181], v2 offset:46080
    ds_read_b64_tr_b16 v[182:183], v2 offset:48384
    s_waitcnt lgkmcnt(4)
    v_mfma_f32_32x32x16_bf16 v[208:223], v[188:191], v[108:111], v[208:223]
    s_add_u32 m0, s35, 118784
    s_nop 0
    buffer_load_dwordx4 v241, s[16:19], s36 offen lds
    ds_read_b64_tr_b16 v[184:185], v3 offset:0
    ds_read_b64_tr_b16 v[186:187], v3 offset:2304
    s_waitcnt lgkmcnt(4)
    v_mfma_f32_32x32x16_bf16 v[208:223], v[176:179], v[112:115], v[208:223]
    s_add_u32 m0, s35, 126976
    s_nop 0
    buffer_load_dwordx4 v242, s[16:19], s36 offen lds
    ds_read_b64_tr_b16 v[188:189], v3 offset:9216
    ds_read_b64_tr_b16 v[190:191], v3 offset:11520
    s_waitcnt lgkmcnt(4)
    v_mfma_f32_32x32x16_bf16 v[208:223], v[180:183], v[116:119], v[208:223]
    s_add_u32 m0, s35, 135168
    s_nop 0
    buffer_load_dwordx4 v243, s[16:19], s36 offen lds
    s_cmp_ge_u32 s26, 4
    s_cbranch_scc1 K1_Dr7
    s_add_u32 m0, s35, 143360
    s_nop 0
    buffer_load_dwordx4 v244, s[16:19], s36 offen lds
K1_Dr7:
    s_add_u32 s36, s36, 221184
    s_waitcnt vmcnt(4)
    s_barrier
    ds_read_b64_tr_b16 v[176:177], v3 offset:18432
    ds_read_b64_tr_b16 v[178:179], v3 offset:20736
    s_waitcnt lgkmcnt(4)
    v_mfma_f32_32x32x16_bf16 v[208:223], v[184:187], v[120:123], v[208:223]
    s_add_u32 m0, s35, 0
    s_nop 0
    buffer_load_dwordx4 v240, s[16:19], s36 offen lds
    ds_read_b64_tr_b16 v[180:181], v3 offset:27648
    ds_read_b64_tr_b16 v[182:183], v3 offset:29952
    s_waitcnt lgkmcnt(4)
    v_mfma_f32_32x32x16_bf16 v[208:223], v[188:191], v[124:127], v[208:223]
    s_add_u32 m0, s35, 8192
    s_nop 0
    buffer_load_dwordx4 v241, s[16:19], s36 offen lds
    ds_read_b64_tr_b16 v[184:185], v3 offset:36864
    ds_read_b64_tr_b16 v[186:187], v3 offset:39168
    s_waitcnt lgkmcnt(4)
    v_mfma_f32_32x32x16_bf16 v[208:223], v[176:179], v[128:131], v[208:223]
    s_add_u32 m0, s35, 16384
    s_nop 0
    buffer_load_dwordx4 v242, s[16:19], s36 offen lds
    ds_read_b64_tr_b16 v[188:189], v3 offset:46080
    ds_read_b64_tr_b16 v[190:191], v3 offset:48384
    s_waitcnt lgkmcnt(4)
    v_mfma_f32_32x32x16_bf16 v[208:223], v[180:183], v[132:135], v[208:223]
    s_add_u32 m0, s35, 24576
    s_nop 0
    buffer_load_dwordx4 v243, s[16:19], s36 offen lds
    s_cmp_ge_u32 s26, 4
    s_cbranch_scc1 K1_Dr8
    s_add_u32 m0, s35, 32768
    s_nop 0
    buffer_load_dwordx4 v244, s[16:19], s36 offen lds
K1_Dr8:
    s_add_u32 s36, s36, 221184
    s_waitcnt vmcnt(4)
    s_barrier
    ds_read_b64_tr_b16 v[176:177], v4 offset:0
    ds_read_b64_tr_b16 v[178:179], v4 offset:2304
    s_waitcnt lgkmcnt(4)
    v_mfma_f32_32x32x16_bf16 v[208:223], v[184:187], v[136:139], v[208:223]
    ds_read_b64_tr_b16 v[180:181], v4 offset:9216
    ds_read_b64_tr_b16 v[182:183], v4 offset:11520
    s_waitcnt lgkmcnt(4)
    v_mfma_f32_32x32x16_bf16 v[208:223], v[188:191], v[140:143], v[208:223]
    ds_read_b64_tr_b16 v[184:185], v4 offset:18432
    ds_read_b64_tr_b16 v[186:187], v4 offset:20736
    s_waitcnt lgkmcnt(4)
    v_mfma_f32_32x32x16_bf16 v[208:223], v[176:179], v[144:147], v[208:223]
    ds_read_b64_tr_b16 v[188:189], v4 offset:27648
    ds_read_b64_tr_b16 v[190:191], v4 offset:29952
    s_waitcnt lgkmcnt(4)
    v_mfma_f32_32x32x16_bf16 v[208:223], v[180:183], v[148:151], v[208:223]
    s_waitcnt vmcnt(0)
    s_barrier
    ds_read_b64_tr_b16 v[176:177], v2 offset:0
    ds_read_b64_tr_b16 v[178:179], v2 offset:2304
    s_waitcnt lgkmcnt(4)
    v_mfma_f32_32x32x16_bf16 v[208:223], v[184:187], v[152:155], v[208:223]
    ds_read_b64_tr_b16 v[180:181], v2 offset:9216
    ds_read_b64_tr_b16 v[182:183], v2 offset:11520
    s_waitcnt lgkmcnt(4)
    v_mfma_f32_32x32x16_bf16 v[208:223], v[188:191], v[156:159], v[208:223]
    ds_read_b64_tr_b16 v[184:185], v2 offset:18432
    ds_read_b64_tr_b16 v[186:187], v2 offset:20736
    s_waitcnt lgkmcnt(4)
    v_mfma_f32_32x32x16_bf16 v[208:223], v[176:179], v[160:163], v[208:223]
    ds_read_b64_tr_b16 v[188:189], v2 offset:27648
    ds_read_b64_tr_b16 v[190:191], v2 offset:29952
    s_waitcnt lgkmcnt(4)
    v_mfma_f32_32x32x16_bf16 v[208:223], v[180:183], v[164:167], v[208:223]
    s_waitcnt lgkmcnt(2)
    v_mfma_f32_32x32x16_bf16 v[208:223], v[184:187], v[168:171], v[208:223]
    s_waitcnt lgkmcnt(0)
    v_mfma_f32_32x32x16_bf16 v[208:223], v[188:191], v[172:175], v[208:223]
    s_nop 15
    s_lshl_b32 s40, s25, 1
    s_add_u32 s40, s40, s27
    s_lshl_b32 s41, s24, 2
    v_lshlrev_b32 v13, 4, v1
    v_and_b32 v13, 31, v1
    v_lshrrev_b32 v14, 5, v1
    v_mov_b32 v23, v14
    v_lshl_add_u32 v14, v14, 1, s41
    s_mov_b32 s43, 0x3eae1a93
    s_mov_b32 s44, 151552
    v_mul_lo_u32 v15, v14, s44
    v_lshlrev_b32 v18, 13, v14
    v_lshl_add_u32 v18, v13, 2, v18
    v_lshl_add_u32 v19, v13, 2, v15
    s_lshl_b32 s45, s40, 7
    s_add_u32 s45, s45, 2097152
    s_add_u32 s46, s45, 8192
    s_mul_i32 s47, s40, 1152
    s_add_u32 s47, s47, 2360320
    s_add_u32 s48, s47, 151552
    v_and_b32 v20, 0x13, v13
    v_bfe_u32 v21, v13, 2, 1
    v_lshl_add_u32 v20, v21, 3, v20
    v_bfe_u32 v21, v13, 3, 1
    v_lshl_add_u32 v20, v21, 2, v20
    v_lshlrev_b32 v20, 1, v20
    v_lshl_add_u32 v20, v23, 8, v20
    s_lshl_b32 s49, s27, 9
    s_add_u32 s49, s49, 147456
    v_add_u32 v20, s49, v20
    v_mul_f32 v208, s43, v208
    v_mul_f32 v209, s43, v209
    v_mul_f32 v210, s43, v210
    v_mul_f32 v211, s43, v211
    v_cvt_pk_bf16_f32 v32, v208, v209
    v_cvt_pk_bf16_f32 v33, v210, v211
    v_cvt_pk_bf16_f32 v34, v212, v213
    v_cvt_pk_bf16_f32 v35, v214, v215
    v_cvt_pk_bf16_f32 v36, v216, v217
    v_cvt_pk_bf16_f32 v37, v218, v219
    buffer_store_dword v32, v18, s[20:23], s45 offen sc1
    buffer_store_dword v33, v18, s[20:23], s46 offen sc1
    buffer_store_dword v34, v19, s[20:23], s47 offen sc1
    buffer_store_dword v35, v19, s[20:23], s48 offen sc1
    ds_write_b16 v20, v36
    ds_write_b16_d16_hi v20, v36 offset:64
    ds_write_b16 v20, v37 offset:128
    ds_write_b16_d16_hi v20, v37 offset:192
    v_lshlrev_b32 v21, 4, v1
    v_add_u32 v21, s49, v21
    s_waitcnt lgkmcnt(0)
    ds_read_b128 v[24:27], v21
    v_bfe_u32 v13, v1, 3, 2
    v_mul_lo_u32 v13, v13, s44
    v_bfe_u32 v14, v1, 1, 1
    v_mul_u32_u24 v14, 608, v14
    v_add_u32 v13, v13, v14
    v_and_b32 v14, 1, v1
    v_mul_u32_u24 v14, 304, v14
    v_add_u32 v13, v13, v14
    v_bfe_u32 v14, v1, 2, 1
    v_lshl_add_u32 v22, v14, 4, v13
    s_mul_i32 s42, s41, 151552
    s_mul_i32 s43, s40, 1216
    s_add_u32 s42, s42, s43
    s_add_u32 s42, s42, 2433280
    v_mov_b32 v28, 0x3f803f80
    v_mov_b32 v29, 0x3f803f80
    v_mov_b32 v30, 0x3f803f80
    v_mov_b32 v31, 0x3f803f80
    s_waitcnt lgkmcnt(0)
    s_mov_b32 exec_hi, 0
    buffer_store_dwordx4 v[24:27], v22, s[20:23], s42 offen sc1
    s_mov_b32 exec_lo, 0x0f0f0f0f
    buffer_store_dwordx4 v[28:31], v13, s[20:23], s42 offen offset:32 sc1
    s_mov_b64 exec, -1
    s_endpgm
K1_END:
    s_endpgm
.text
.globl k2_attn_kernel
.p2align 8
.type k2_attn_kernel,@function
k2_attn_kernel:
    s_cmp_ge_u32 s2, 256
    s_cbranch_scc1 K2_END
    s_load_dwordx2 s[8:9], s[0:1], 72
    s_load_dwordx2 s[4:5], s[0:1], 16
    s_load_dwordx4 s[40:43], s[0:1], 32
    s_load_dwordx2 s[44:45], s[0:1], 48
    v_and_b32 v1, 63, v0
    v_lshrrev_b32 v14, 6, v0
    s_and_b32 s28, s2, 7
    s_lshl_b32 s28, s28, 2
    s_bfe_u32 s29, s2, 0x20003
    s_add_u32 s24, s28, s29
    s_lshr_b32 s25, s2, 5
    v_readfirstlane_b32 s26, v14
    v_lshlrev_b32 v7, 4, v1
    v_and_b32 v15, 31, v1
    v_lshlrev_b32 v22, 2, v15
    s_lshl_b32 s27, s25, 3
    s_add_u32 s27, s27, s26
    s_waitcnt lgkmcnt(0)
    s_mov_b32 s12, s8
    s_and_b32 s13, s9, 0xffff
    s_mov_b32 s14, 48234496
    s_mov_b32 s15, 0x20000
    s_cmp_ge_u32 s26, 8
    s_cbranch_scc1 K2_PACKER
    s_lshl_b32 s28, s24, 6
    s_add_u32 s28, s28, s27
    s_lshl_b32 s29, s28, 10
    s_lshl_b32 s30, s28, 7
    s_add_u32 s30, s30, 2097152
    buffer_load_dwordx4 v[8:11], v7, s[12:15], s29 offen
    buffer_load_dword v12, v22, s[12:15], s30 offen
    s_mul_i32 s31, s24, 151552
    s_add_u32 s31, s31, 2359296
    s_lshl_b32 s32, s26, 10
    s_add_u32 s31, s31, s32
    s_add_u32 m0, s32, 0
    s_add_u32 s33, s31, 0
    buffer_load_dwordx4 v7, s[12:15], s33 offen lds
    s_add_u32 m0, s32, 73728
    s_add_u32 s33, s31, 73728
    buffer_load_dwordx4 v7, s[12:15], s33 offen lds
    s_add_u32 m0, s32, 8192
    s_add_u32 s33, s31, 8192
    buffer_load_dwordx4 v7, s[12:15], s33 offen lds
    s_add_u32 m0, s32, 81920
    s_add_u32 s33, s31, 81920
    buffer_load_dwordx4 v7, s[12:15], s33 offen lds
    v_mov_b32 v2, v7
    v_and_b32 v15, 31, v1
    v_lshlrev_b32 v22, 2, v15
    v_add_u32 v3, 1024, v22
    v_lshrrev_b32 v23, 5, v1
    v_mul_u32_u24 v23, 304, v23
    v_lshl_add_u32 v4, v15, 4, v23
    v_add_u32 v4, 73728, v4
    v_cmp_gt_u32 vcc, 19, v15
    v_mov_b32 v23, 0x40000
    v_mov_b32 v21, 0
    v_cndmask_b32 v4, v23, v4, vcc
    v_mov_b32 v72, 0
    v_mov_b32 v73, 0
    v_mov_b32 v74, 0
    v_mov_b32 v75, 0
    v_mov_b32 v76, 0
    v_mov_b32 v77, 0
    v_mov_b32 v78, 0
    v_mov_b32 v79, 0
    v_mov_b32 v80, 0
    v_mov_b32 v81, 0
    v_mov_b32 v82, 0
    v_mov_b32 v83, 0
    v_mov_b32 v84, 0
    v_mov_b32 v85, 0
    v_mov_b32 v86, 0
    v_mov_b32 v87, 0
    v_mov_b32 v13, 0
    v_mov_b32 v28, 0
    v_mov_b32 v68, 0
    v_mov_b32 v29, 0
    v_mov_b32 v69, 0
    v_mov_b32 v30, 0
    v_mov_b32 v70, 0
    v_mov_b32 v31, 0
    v_mov_b32 v71, 0
    v_mov_b32 v88, 153600
    s_waitcnt vmcnt(0)
    v_cmp_gt_u32 vcc, 32, v1
    s_nop 1
    v_cndmask_b32 v12, 0, v12, vcc
    s_barrier
    ds_read_b128 v[16:19], v2 offset:0
    ds_read_b32 v20, v3 offset:0
    s_waitcnt lgkmcnt(0)
    v_mfma_f32_32x32x16_bf16 v[32:47], v[16:19], v[8:11], 0
    v_mfma_f32_32x32x8bf16_1k v[32:47], v[20:21], v[12:13], v[32:47]
    ds_read_b128 v[24:27], v4 offset:0
    s_waitcnt lgkmcnt(0)
    ds_read_b128 v[16:19], v2 offset:1152
    ds_read_b32 v20, v3 offset:1152
    s_waitcnt lgkmcnt(0)
    s_nop 7
    s_mov_b32 s50, 0
    s_setprio 3
.p2align 6
K2_LOOP:
    s_waitcnt lgkmcnt(1)
    v_mfma_f32_32x32x16_bf16 v[48:63], v[16:19], v[8:11], 0
    v_exp_f32 v32, v32
    v_exp_f32 v33, v33
    v_exp_f32 v34, v34
    v_exp_f32 v35, v35
    v_mfma_f32_32x32x16_bf16 v[72:87], v[28:31], v[68:71], v[72:87]
    ds_read_b128 v[28:31], v4 offset:608
    v_exp_f32 v36, v36
    v_cvt_pk_bf16_f32 v64, v32, v33
    v_cvt_pk_bf16_f32 v65, v34, v35
    v_exp_f32 v37, v37
    v_exp_f32 v38, v38
    v_exp_f32 v39, v39
    v_mfma_f32_32x32x8bf16_1k v[48:63], v[20:21], v[12:13], v[48:63]
    ds_read_b128 v[16:19], v2 offset:2304
    ds_read_b32 v20, v3 offset:2304
    v_exp_f32 v40, v40
    v_cvt_pk_bf16_f32 v66, v36, v37
    v_cvt_pk_bf16_f32 v67, v38, v39
    v_exp_f32 v41, v41
    v_exp_f32 v42, v42
    v_exp_f32 v43, v43
    s_waitcnt lgkmcnt(3)
    v_mfma_f32_32x32x16_bf16 v[72:87], v[24:27], v[64:67], v[72:87]
    ds_read_b128 v[24:27], v4 offset:1216
    v_exp_f32 v44, v44
    v_cvt_pk_bf16_f32 v68, v40, v41
    v_cvt_pk_bf16_f32 v69, v42, v43
    v_exp_f32 v45, v45
    v_exp_f32 v46, v46
    v_exp_f32 v47, v47
    v_cvt_pk_bf16_f32 v70, v44, v45
    v_cvt_pk_bf16_f32 v71, v46, v47
    s_waitcnt lgkmcnt(1)
    v_mfma_f32_32x32x16_bf16 v[32:47], v[16:19], v[8:11], 0
    v_exp_f32 v48, v48
    v_exp_f32 v49, v49
    v_exp_f32 v50, v50
    v_exp_f32 v51, v51
    v_mfma_f32_32x32x16_bf16 v[72:87], v[28:31], v[68:71], v[72:87]
    ds_read_b128 v[28:31], v4 offset:1824
    v_exp_f32 v52, v52
    v_cvt_pk_bf16_f32 v64, v48, v49
    v_cvt_pk_bf16_f32 v65, v50, v51
    v_exp_f32 v53, v53
    v_exp_f32 v54, v54
    v_exp_f32 v55, v55
    v_mfma_f32_32x32x8bf16_1k v[32:47], v[20:21], v[12:13], v[32:47]
    ds_read_b128 v[16:19], v2 offset:3456
    ds_read_b32 v20, v3 offset:3456
    v_exp_f32 v56, v56
    v_cvt_pk_bf16_f32 v66, v52, v53
    v_cvt_pk_bf16_f32 v67, v54, v55
    v_exp_f32 v57, v57
    v_exp_f32 v58, v58
    v_exp_f32 v59, v59
    s_waitcnt lgkmcnt(3)
    v_mfma_f32_32x32x16_bf16 v[72:87], v[24:27], v[64:67], v[72:87]
    ds_read_b128 v[24:27], v4 offset:2432
    v_exp_f32 v60, v60
    v_cvt_pk_bf16_f32 v68, v56, v57
    v_cvt_pk_bf16_f32 v69, v58, v59
    v_exp_f32 v61, v61
    v_exp_f32 v62, v62
    v_exp_f32 v63, v63
    v_cvt_pk_bf16_f32 v70, v60, v61
    v_cvt_pk_bf16_f32 v71, v62, v63
    s_waitcnt lgkmcnt(1)
    v_mfma_f32_32x32x16_bf16 v[48:63], v[16:19], v[8:11], 0
    v_exp_f32 v32, v32
    v_exp_f32 v33, v33
    v_exp_f32 v34, v34
    v_exp_f32 v35, v35
    v_mfma_f32_32x32x16_bf16 v[72:87], v[28:31], v[68:71], v[72:87]
    ds_read_b128 v[28:31], v4 offset:3040
    v_exp_f32 v36, v36
    v_cvt_pk_bf16_f32 v64, v32, v33
    v_cvt_pk_bf16_f32 v65, v34, v35
    v_exp_f32 v37, v37
    v_exp_f32 v38, v38
    v_exp_f32 v39, v39
    v_mfma_f32_32x32x8bf16_1k v[48:63], v[20:21], v[12:13], v[48:63]
    ds_read_b128 v[16:19], v2 offset:4608
    ds_read_b32 v20, v3 offset:4608
    v_exp_f32 v40, v40
    v_cvt_pk_bf16_f32 v66, v36, v37
    v_cvt_pk_bf16_f32 v67, v38, v39
    v_exp_f32 v41, v41
    v_exp_f32 v42, v42
    v_exp_f32 v43, v43
    s_waitcnt lgkmcnt(3)
    v_mfma_f32_32x32x16_bf16 v[72:87], v[24:27], v[64:67], v[72:87]
    ds_read_b128 v[24:27], v4 offset:3648
    v_exp_f32 v44, v44
    v_cvt_pk_bf16_f32 v68, v40, v41
    v_cvt_pk_bf16_f32 v69, v42, v43
    v_exp_f32 v45, v45
    v_exp_f32 v46, v46
    v_exp_f32 v47, v47
    v_cvt_pk_bf16_f32 v70, v44, v45
    v_cvt_pk_bf16_f32 v71, v46, v47
    s_waitcnt lgkmcnt(1)
    v_mfma_f32_32x32x16_bf16 v[32:47], v[16:19], v[8:11], 0
    v_exp_f32 v48, v48
    v_exp_f32 v49, v49
    v_exp_f32 v50, v50
    v_exp_f32 v51, v51
    v_mfma_f32_32x32x16_bf16 v[72:87], v[28:31], v[68:71], v[72:87]
    ds_read_b128 v[28:31], v4 offset:4256
    v_exp_f32 v52, v52
    v_cvt_pk_bf16_f32 v64, v48, v49
    v_cvt_pk_bf16_f32 v65, v50, v51
    v_exp_f32 v53, v53
    v_exp_f32 v54, v54
    v_exp_f32 v55, v55
    v_mfma_f32_32x32x8bf16_1k v[32:47], v[20:21], v[12:13], v[32:47]
    ds_read_b128 v[16:19], v2 offset:5760
    ds_read_b32 v20, v3 offset:5760
    v_exp_f32 v56, v56
    v_cvt_pk_bf16_f32 v66, v52, v53
    v_cvt_pk_bf16_f32 v67, v54, v55
    v_exp_f32 v57, v57
    v_exp_f32 v58, v58
    v_exp_f32 v59, v59
    s_waitcnt lgkmcnt(3)
    v_mfma_f32_32x32x16_bf16 v[72:87], v[24:27], v[64:67], v[72:87]
    ds_read_b128 v[24:27], v4 offset:4864
    v_exp_f32 v60, v60
    v_cvt_pk_bf16_f32 v68, v56, v57
    v_cvt_pk_bf16_f32 v69, v58, v59
    v_exp_f32 v61, v61
    v_exp_f32 v62, v62
    v_exp_f32 v63, v63
    v_cvt_pk_bf16_f32 v70, v60, v61
    v_cvt_pk_bf16_f32 v71, v62, v63
    s_waitcnt lgkmcnt(1)
    v_mfma_f32_32x32x16_bf16 v[48:63], v[16:19], v[8:11], 0
    v_exp_f32 v32, v32
    v_exp_f32 v33, v33
    v_exp_f32 v34, v34
    v_exp_f32 v35, v35
    v_mfma_f32_32x32x16_bf16 v[72:87], v[28:31], v[68:71], v[72:87]
    ds_read_b128 v[28:31], v4 offset:5472
    v_exp_f32 v36, v36
    v_cvt_pk_bf16_f32 v64, v32, v33
    v_cvt_pk_bf16_f32 v65, v34, v35
    v_exp_f32 v37, v37
    v_exp_f32 v38, v38
    v_exp_f32 v39, v39
    v_mfma_f32_32x32x8bf16_1k v[48:63], v[20:21], v[12:13], v[48:63]
    ds_read_b128 v[16:19], v2 offset:6912
    ds_read_b32 v20, v3 offset:6912
    v_exp_f32 v40, v40
    v_cvt_pk_bf16_f32 v66, v36, v37
    v_cvt_pk_bf16_f32 v67, v38, v39
    v_exp_f32 v41, v41
    v_exp_f32 v42, v42
    v_exp_f32 v43, v43
    s_waitcnt lgkmcnt(3)
    v_mfma_f32_32x32x16_bf16 v[72:87], v[24:27], v[64:67], v[72:87]
    ds_read_b128 v[24:27], v4 offset:6080
    v_exp_f32 v44, v44
    v_cvt_pk_bf16_f32 v68, v40, v41
    v_cvt_pk_bf16_f32 v69, v42, v43
    v_exp_f32 v45, v45
    v_exp_f32 v46, v46
    v_exp_f32 v47, v47
    v_cvt_pk_bf16_f32 v70, v44, v45
    v_cvt_pk_bf16_f32 v71, v46, v47
    s_waitcnt lgkmcnt(1)
    v_mfma_f32_32x32x16_bf16 v[32:47], v[16:19], v[8:11], 0
    v_exp_f32 v48, v48
    v_exp_f32 v49, v49
    v_exp_f32 v50, v50
    v_exp_f32 v51, v51
    v_mfma_f32_32x32x16_bf16 v[72:87], v[28:31], v[68:71], v[72:87]
    ds_read_b128 v[28:31], v4 offset:6688
    v_exp_f32 v52, v52
    v_cvt_pk_bf16_f32 v64, v48, v49
    v_cvt_pk_bf16_f32 v65, v50, v51
    v_exp_f32 v53, v53
    v_exp_f32 v54, v54
    v_exp_f32 v55, v55
    v_mfma_f32_32x32x8bf16_1k v[32:47], v[20:21], v[12:13], v[32:47]
    ds_read_b128 v[16:19], v2 offset:8064
    ds_read_b32 v20, v3 offset:8064
    v_exp_f32 v56, v56
    v_cvt_pk_bf16_f32 v66, v52, v53
    v_cvt_pk_bf16_f32 v67, v54, v55
    v_exp_f32 v57, v57
    v_exp_f32 v58, v58
    v_exp_f32 v59, v59
    s_waitcnt lgkmcnt(3)
    v_mfma_f32_32x32x16_bf16 v[72:87], v[24:27], v[64:67], v[72:87]
    ds_read_b128 v[24:27], v4 offset:7296
    v_exp_f32 v60, v60
    v_cvt_pk_bf16_f32 v68, v56, v57
    v_cvt_pk_bf16_f32 v69, v58, v59
    v_exp_f32 v61, v61
    v_exp_f32 v62, v62
    v_exp_f32 v63, v63
    v_cvt_pk_bf16_f32 v70, v60, v61
    v_cvt_pk_bf16_f32 v71, v62, v63
    s_waitcnt lgkmcnt(1)
    v_mfma_f32_32x32x16_bf16 v[48:63], v[16:19], v[8:11], 0
    v_exp_f32 v32, v32
    v_exp_f32 v33, v33
    v_exp_f32 v34, v34
    v_exp_f32 v35, v35
    v_mfma_f32_32x32x16_bf16 v[72:87], v[28:31], v[68:71], v[72:87]
    ds_read_b128 v[28:31], v4 offset:7904
    v_exp_f32 v36, v36
    v_cvt_pk_bf16_f32 v64, v32, v33
    v_cvt_pk_bf16_f32 v65, v34, v35
    v_exp_f32 v37, v37
    v_exp_f32 v38, v38
    v_exp_f32 v39, v39
    v_mfma_f32_32x32x8bf16_1k v[48:63], v[20:21], v[12:13], v[48:63]
    ds_read_b128 v[16:19], v2 offset:9216
    ds_read_b32 v20, v3 offset:9216
    v_exp_f32 v40, v40
    v_cvt_pk_bf16_f32 v66, v36, v37
    v_cvt_pk_bf16_f32 v67, v38, v39
    v_exp_f32 v41, v41
    v_exp_f32 v42, v42
    v_exp_f32 v43, v43
    s_waitcnt lgkmcnt(3)
    v_mfma_f32_32x32x16_bf16 v[72:87], v[24:27], v[64:67], v[72:87]
    ds_read_b128 v[24:27], v4 offset:8512
    v_exp_f32 v44, v44
    v_cvt_pk_bf16_f32 v68, v40, v41
    v_cvt_pk_bf16_f32 v69, v42, v43
    v_exp_f32 v45, v45
    v_exp_f32 v46, v46
    v_exp_f32 v47, v47
    v_cvt_pk_bf16_f32 v70, v44, v45
    v_cvt_pk_bf16_f32 v71, v46, v47
    s_waitcnt lgkmcnt(1)
    v_mfma_f32_32x32x16_bf16 v[32:47], v[16:19], v[8:11], 0
    v_exp_f32 v48, v48
    v_exp_f32 v49, v49
    v_exp_f32 v50, v50
    v_exp_f32 v51, v51
    v_mfma_f32_32x32x16_bf16 v[72:87], v[28:31], v[68:71], v[72:87]
    ds_read_b128 v[28:31], v4 offset:9120
    v_exp_f32 v52, v52
    v_cvt_pk_bf16_f32 v64, v48, v49
    v_cvt_pk_bf16_f32 v65, v50, v51
    v_exp_f32 v53, v53
    v_exp_f32 v54, v54
    v_exp_f32 v55, v55
    v_mfma_f32_32x32x8bf16_1k v[32:47], v[20:21], v[12:13], v[32:47]
    ds_read_b128 v[16:19], v2 offset:10368
    ds_read_b32 v20, v3 offset:10368
    v_exp_f32 v56, v56
    v_cvt_pk_bf16_f32 v66, v52, v53
    v_cvt_pk_bf16_f32 v67, v54, v55
    v_exp_f32 v57, v57
    v_exp_f32 v58, v58
    v_exp_f32 v59, v59
    s_waitcnt lgkmcnt(3)
    v_mfma_f32_32x32x16_bf16 v[72:87], v[24:27], v[64:67], v[72:87]
    ds_read_b128 v[24:27], v4 offset:9728
    v_exp_f32 v60, v60
    v_cvt_pk_bf16_f32 v68, v56, v57
    v_cvt_pk_bf16_f32 v69, v58, v59
    v_exp_f32 v61, v61
    v_exp_f32 v62, v62
    v_exp_f32 v63, v63
    v_cvt_pk_bf16_f32 v70, v60, v61
    v_cvt_pk_bf16_f32 v71, v62, v63
    v_add_u32 v2, 9216, v2
    v_add_u32 v3, 9216, v3
    v_add_u32 v4, 9728, v4
    s_cmp_eq_u32 s50, 0
    s_cbranch_scc1 K2_SYNC0
    s_cmp_lg_u32 s50, 3
    s_cbranch_scc1 K2_NOSYNC
    s_branch K2_W2_1
K2_W2:
    s_sleep 1
K2_W2_1:
    ds_read_b32 v15, v88 offset:8
    s_waitcnt lgkmcnt(0)
    v_readfirstlane_b32 s51, v15
    s_cmp_ge_u32 s51, 4
    s_cbranch_scc0 K2_W2
    s_branch K2_NOSYNC
K2_SYNC0:
    s_branch K2_W1_1
K2_W1:
    s_sleep 1
K2_W1_1:
    ds_read_b32 v15, v88 offset:4
    s_waitcnt lgkmcnt(0)
    v_readfirstlane_b32 s51, v15
    s_cmp_ge_u32 s51, 4
    s_cbranch_scc0 K2_W1
K2_NOSYNC:
    s_add_u32 s50, s50, 1
    s_cmp_lt_u32 s50, 5
    s_cbranch_scc1 K2_LOOP
    s_cmp_eq_u32 s50, 5
    s_cbranch_scc0 K2_PR6
    s_setprio 2
    s_branch K2_LOOP
K2_PR6:
    s_cmp_eq_u32 s50, 6
    s_cbranch_scc0 K2_PR7
    s_setprio 1
    s_branch K2_LOOP
K2_PR7:
    s_cmp_eq_u32 s50, 7
    s_cbranch_scc0 K2_LOOPEND
    s_setprio 0
    s_branch K2_LOOP
K2_LOOPEND:
    s_waitcnt lgkmcnt(0)
    v_mfma_f32_32x32x16_bf16 v[72:87], v[28:31], v[68:71], v[72:87]
    s_nop 15
    v_mov_b32 v14, v82
    v_mov_b32 v15, v82
    s_nop 1
    v_permlane32_swap_b32 v14, v15
    s_mov_b32 s54, 0x21800000
    s_mov_b32 s55, 0x5d800000
    v_cmp_nle_f32 vcc, s54, v14
    v_cmp_nge_f32 s[56:57], s55, v14
    s_nop 1
    s_or_b64 vcc, vcc, s[56:57]
    s_cbranch_vccnz K2_SLOW
K2_FIN:
    v_rcp_f32 v14, v14
    s_nop 0
    v_mul_f32 v72, v72, v14
    v_mul_f32 v73, v73, v14
    v_mul_f32 v74, v74, v14
    v_mul_f32 v75, v75, v14
    v_mul_f32 v76, v76, v14
    v_mul_f32 v77, v77, v14
    v_mul_f32 v78, v78, v14
    v_mul_f32 v79, v79, v14
    v_mul_f32 v80, v80, v14
    v_mul_f32 v81, v81, v14
    v_cvt_pk_bf16_f32 v64, v72, v73
    v_cvt_pk_bf16_f32 v65, v74, v75
    v_cvt_pk_bf16_f32 v66, v76, v77
    v_cvt_pk_bf16_f32 v67, v78, v79
    v_cvt_pk_bf16_f32 v68, v80, v81
    s_mul_i32 s28, s27, 36
    s_add_u32 s29, s28, s24
    s_lshl_b32 s29, s29, 10
    s_add_u32 s29, s29, 7208960
    buffer_store_dwordx4 v[64:67], v7, s[12:15], s29 offen sc1
    s_lshr_b32 s30, s24, 3
    s_add_u32 s30, s30, s28
    s_add_u32 s30, s30, 32
    s_lshl_b32 s30, s30, 10
    s_bfe_u32 s31, s24, 0x10002
    s_lshl_b32 s31, s31, 9
    s_add_u32 s30, s30, s31
    s_and_b32 s31, s24, 3
    s_lshl_b32 s31, s31, 2
    s_add_u32 s30, s30, s31
    s_add_u32 s30, s30, 7208960
    s_mov_b32 exec_hi, 0
    buffer_store_dword v68, v7, s[12:15], s30 offen sc1
    s_mov_b64 exec, -1
    s_endpgm
K2_SLOW:
    v_mov_b32 v2, v7
    v_and_b32 v15, 31, v1
    v_lshlrev_b32 v22, 2, v15
    v_add_u32 v3, 1024, v22
    v_lshrrev_b32 v23, 5, v1
    v_mul_u32_u24 v23, 304, v23
    v_lshl_add_u32 v4, v15, 4, v23
    v_add_u32 v4, 73728, v4
    v_cmp_gt_u32 vcc, 19, v15
    v_mov_b32 v23, 0x40000
    v_mov_b32 v21, 0
    v_cndmask_b32 v4, v23, v4, vcc
    v_mov_b32 v72, 0
    v_mov_b32 v73, 0
    v_mov_b32 v74, 0
    v_mov_b32 v75, 0
    v_mov_b32 v76, 0
    v_mov_b32 v77, 0
    v_mov_b32 v78, 0
    v_mov_b32 v79, 0
    v_mov_b32 v80, 0
    v_mov_b32 v81, 0
    v_mov_b32 v82, 0
    v_mov_b32 v83, 0
    v_mov_b32 v84, 0
    v_mov_b32 v85, 0
    v_mov_b32 v86, 0
    v_mov_b32 v87, 0
    v_mov_b32 v90, 0xff61b1e6
    s_mov_b32 s50, 64
K2_SLOOP:
    ds_read_b128 v[16:19], v2
    ds_read_b32 v20, v3
    ds_read_b128 v[24:27], v4
    ds_read_b128 v[28:31], v4 offset:608
    s_waitcnt lgkmcnt(0)
    v_mfma_f32_32x32x16_bf16 v[32:47], v[16:19], v[8:11], 0
    v_mfma_f32_32x32x8bf16_1k v[32:47], v[20:21], v[12:13], v[32:47]
    s_nop 15
    v_max3_f32 v91, v32, v33, v90
    v_max3_f32 v91, v34, v35, v91
    v_max3_f32 v91, v36, v37, v91
    v_max3_f32 v91, v38, v39, v91
    v_max3_f32 v91, v40, v41, v91
    v_max3_f32 v91, v42, v43, v91
    v_max3_f32 v91, v44, v45, v91
    v_max3_f32 v91, v46, v47, v91
    v_mov_b32 v15, v91
    s_nop 1
    v_permlane32_swap_b32 v91, v15
    s_nop 1
    v_max_f32 v91, v91, v15
    v_sub_f32 v92, v90, v91
    v_exp_f32 v92, v92
    v_mov_b32 v90, v91
    v_sub_f32 v32, v32, v91
    v_sub_f32 v33, v33, v91
    v_sub_f32 v34, v34, v91
    v_sub_f32 v35, v35, v91
    v_sub_f32 v36, v36, v91
    v_sub_f32 v37, v37, v91
    v_sub_f32 v38, v38, v91
    v_sub_f32 v39, v39, v91
    v_sub_f32 v40, v40, v91
    v_sub_f32 v41, v41, v91
    v_sub_f32 v42, v42, v91
    v_sub_f32 v43, v43, v91
    v_sub_f32 v44, v44, v91
    v_sub_f32 v45, v45, v91
    v_sub_f32 v46, v46, v91
    v_sub_f32 v47, v47, v91
    v_exp_f32 v32, v32
    v_exp_f32 v33, v33
    v_exp_f32 v34, v34
    v_exp_f32 v35, v35
    v_exp_f32 v36, v36
    v_exp_f32 v37, v37
    v_exp_f32 v38, v38
    v_exp_f32 v39, v39
    v_exp_f32 v40, v40
    v_exp_f32 v41, v41
    v_exp_f32 v42, v42
    v_exp_f32 v43, v43
    v_exp_f32 v44, v44
    v_exp_f32 v45, v45
    v_exp_f32 v46, v46
    v_exp_f32 v47, v47
    v_mul_f32 v72, v72, v92
    v_mul_f32 v73, v73, v92
    v_mul_f32 v74, v74, v92
    v_mul_f32 v75, v75, v92
    v_mul_f32 v76, v76, v92
    v_mul_f32 v77, v77, v92
    v_mul_f32 v78, v78, v92
    v_mul_f32 v79, v79, v92
    v_mul_f32 v80, v80, v92
    v_mul_f32 v81, v81, v92
    v_mul_f32 v82, v82, v92
    v_mul_f32 v83, v83, v92
    v_mul_f32 v84, v84, v92
    v_mul_f32 v85, v85, v92
    v_mul_f32 v86, v86, v92
    v_mul_f32 v87, v87, v92
    v_cvt_pk_bf16_f32 v64, v32, v33
    v_cvt_pk_bf16_f32 v65, v34, v35
    v_cvt_pk_bf16_f32 v66, v36, v37
    v_cvt_pk_bf16_f32 v67, v38, v39
    v_cvt_pk_bf16_f32 v68, v40, v41
    v_cvt_pk_bf16_f32 v69, v42, v43
    v_cvt_pk_bf16_f32 v70, v44, v45
    v_cvt_pk_bf16_f32 v71, v46, v47
    s_nop 1
    v_mfma_f32_32x32x16_bf16 v[72:87], v[24:27], v[64:67], v[72:87]
    v_mfma_f32_32x32x16_bf16 v[72:87], v[28:31], v[68:71], v[72:87]
    v_add_u32 v2, 1152, v2
    v_add_u32 v3, 1152, v3
    v_add_u32 v4, 1216, v4
    s_nop 15
    s_sub_u32 s50, s50, 1
    s_cmp_lg_u32 s50, 0
    s_cbranch_scc1 K2_SLOOP
    v_mov_b32 v14, v82
    v_mov_b32 v15, v82
    s_nop 1
    v_permlane32_swap_b32 v14, v15
    s_branch K2_FIN
K2_PACKER:
    s_mov_b32 s16, s8
    s_and_b32 s17, s9, 0xffff
    s_mov_b32 s18, 48234496
    s_mov_b32 s19, 0x20000
    v_lshrrev_b32 v156, 3, v1
    v_and_b32 v157, 7, v1
    s_sub_u32 s35, s26, 8
    s_mul_i32 s35, s35, 3072
    s_add_u32 s35, s35, 151552
    s_and_b32 s63, s2, 7
    s_lshr_b32 s34, s2, 3
    s_lshl_b32 s34, s34, 2
    s_add_u32 s34, s34, s26
    s_sub_u32 s34, s34, 8
    v_mov_b32 v152, 0x3f803f80
    v_mov_b32 v153, 0x3f803f80
    v_mov_b32 v154, 0x3f803f80
    v_mov_b32 v155, 0x3f803f80
    v_mov_b32 v160, 153600
    s_cmp_lg_u32 s26, 8
    s_cbranch_scc1 K2_NOINIT
    v_mov_b32 v14, 0
    s_mov_b64 exec, 1
    ds_write_b32 v160, v14
    ds_write_b32 v160, v14 offset:4
    ds_write_b32 v160, v14 offset:8
    s_mov_b64 exec, -1
    s_waitcnt lgkmcnt(0)
K2_NOINIT:
    s_sub_u32 s32, s26, 8
    s_lshl_b32 s32, s32, 10
    s_mul_i32 s31, s24, 151552
    s_add_u32 s31, s31, 2359296
    s_add_u32 s31, s31, s32
    s_barrier
    s_add_u32 m0, s32, 16384
    s_add_u32 s33, s31, 16384
    buffer_load_dwordx4 v7, s[12:15], s33 offen lds
    s_add_u32 m0, s32, 90112
    s_add_u32 s33, s31, 90112
    buffer_load_dwordx4 v7, s[12:15], s33 offen lds
    s_add_u32 m0, s32, 20480
    s_add_u32 s33, s31, 20480
    buffer_load_dwordx4 v7, s[12:15], s33 offen lds
    s_add_u32 m0, s32, 94208
    s_add_u32 s33, s31, 94208
    buffer_load_dwordx4 v7, s[12:15], s33 offen lds
    s_add_u32 m0, s32, 24576
    s_add_u32 s33, s31, 24576
    buffer_load_dwordx4 v7, s[12:15], s33 offen lds
    s_add_u32 m0, s32, 98304
    s_add_u32 s33, s31, 98304
    buffer_load_dwordx4 v7, s[12:15], s33 offen lds
    s_add_u32 m0, s32, 28672
    s_add_u32 s33, s31, 28672
    buffer_load_dwordx4 v7, s[12:15], s33 offen lds
    s_add_u32 m0, s32, 102400
    s_add_u32 s33, s31, 102400
    buffer_load_dwordx4 v7, s[12:15], s33 offen lds
    s_add_u32 m0, s32, 32768
    s_add_u32 s33, s31, 32768
    buffer_load_dwordx4 v7, s[12:15], s33 offen lds
    s_add_u32 m0, s32, 106496
    s_add_u32 s33, s31, 106496
    buffer_load_dwordx4 v7, s[12:15], s33 offen lds
    s_add_u32 m0, s32, 36864
    s_add_u32 s33, s31, 36864
    buffer_load_dwordx4 v7, s[12:15], s33 offen lds
    s_add_u32 m0, s32, 110592
    s_add_u32 s33, s31, 110592
    buffer_load_dwordx4 v7, s[12:15], s33 offen lds
    s_add_u32 m0, s32, 40960
    s_add_u32 s33, s31, 40960
    buffer_load_dwordx4 v7, s[12:15], s33 offen lds
    s_add_u32 m0, s32, 114688
    s_add_u32 s33, s31, 114688
    buffer_load_dwordx4 v7, s[12:15], s33 offen lds
    s_add_u32 m0, s32, 45056
    s_add_u32 s33, s31, 45056
    buffer_load_dwordx4 v7, s[12:15], s33 offen lds
    s_add_u32 m0, s32, 118784
    s_add_u32 s33, s31, 118784
    buffer_load_dwordx4 v7, s[12:15], s33 offen lds
    v_mov_b32 v15, 1
    s_add_u32 m0, s32, 49152
    s_add_u32 s33, s31, 49152
    buffer_load_dwordx4 v7, s[12:15], s33 offen lds
    s_add_u32 m0, s32, 122880
    s_add_u32 s33, s31, 122880
    buffer_load_dwordx4 v7, s[12:15], s33 offen lds
    s_add_u32 m0, s32, 53248
    s_add_u32 s33, s31, 53248
    buffer_load_dwordx4 v7, s[12:15], s33 offen lds
    s_add_u32 m0, s32, 126976
    s_add_u32 s33, s31, 126976
    buffer_load_dwordx4 v7, s[12:15], s33 offen lds
    s_add_u32 m0, s32, 57344
    s_add_u32 s33, s31, 57344
    buffer_load_dwordx4 v7, s[12:15], s33 offen lds
    s_add_u32 m0, s32, 131072
    s_add_u32 s33, s31, 131072
    buffer_load_dwordx4 v7, s[12:15], s33 offen lds
    s_add_u32 m0, s32, 61440
    s_add_u32 s33, s31, 61440
    buffer_load_dwordx4 v7, s[12:15], s33 offen lds
    s_add_u32 m0, s32, 135168
    s_add_u32 s33, s31, 135168
    buffer_load_dwordx4 v7, s[12:15], s33 offen lds
    s_add_u32 m0, s32, 65536
    s_add_u32 s33, s31, 65536
    buffer_load_dwordx4 v7, s[12:15], s33 offen lds
    s_add_u32 m0, s32, 139264
    s_add_u32 s33, s31, 139264
    buffer_load_dwordx4 v7, s[12:15], s33 offen lds
    s_add_u32 m0, s32, 69632
    s_add_u32 s33, s31, 69632
    buffer_load_dwordx4 v7, s[12:15], s33 offen lds
    s_add_u32 m0, s32, 143360
    s_add_u32 s33, s31, 143360
    buffer_load_dwordx4 v7, s[12:15], s33 offen lds
    s_add_u32 m0, s32, 147456
    s_add_u32 s33, s31, 147456
    buffer_load_dwordx4 v7, s[12:15], s33 offen lds
    s_waitcnt vmcnt(13)
    s_mov_b64 exec, 1
    ds_add_u32 v160, v15 offset:4
    s_mov_b64 exec, -1
    s_cmp_lt_u32 s34, 81
    s_cbranch_scc1 K2_PA
    s_cmp_lt_u32 s34, 117
    s_cbranch_scc1 K2_PB
    s_cmp_lt_u32 s34, 122
    s_cbranch_scc0 K2_PFC
    s_sub_u32 s34, s34, 117
    s_mul_i32 s36, s63, 5
    s_add_u32 s34, s34, s36
    s_cmp_lt_u32 s34, 36
    s_cbranch_scc0 K2_IDLE
    s_lshr_b32 s36, s34, 2
    s_and_b32 s37, s34, 3
    s_mul_i32 s37, s37, 9
    s_mul_i32 s38, s36, 72
    s_add_u32 s38, s38, s37
    s_lshl_b32 s38, s38, 10
    s_add_u32 s64, s38, 12222464
    s_lshl_b32 s36, s36, 7
    v_lshl_add_u32 v160, v157, 4, s36
    s_add_u32 s39, s37, 0
    s_mul_i32 s47, s39, 18
    s_and_b32 s48, s39, 1
    s_lshl_b32 s48, s48, 1
    s_add_u32 s47, s47, s48
    s_sub_u32 s48, s39, 32
    s_mul_i32 s48, s48, 144
    s_cmp_lt_u32 s39, 32
    s_cselect_b32 s47, s47, s48
    s_cselect_b64 vcc, -1, 0
    v_add_u32 v14, 0, v156
    v_lshrrev_b32 v15, 1, v14
    v_mul_u32_u24 v22, 18, v15
    v_and_b32 v15, 1, v15
    v_xor_b32 v15, 1, v15
    v_lshl_add_u32 v22, v15, 4, v22
    v_and_b32 v15, 1, v14
    v_add_u32 v22, v22, v15
    v_cndmask_b32 v14, v22, v14, vcc
    v_add_u32 v14, s47, v14
    v_mul_u32_u24 v14, 1152, v14
    v_add_u32 v14, v14, v160
    global_load_dwordx4 v[32:35], v14, s[4:5]
    s_add_u32 s39, s37, 0
    s_mul_i32 s47, s39, 18
    s_and_b32 s48, s39, 1
    s_lshl_b32 s48, s48, 1
    s_add_u32 s47, s47, s48
    s_sub_u32 s48, s39, 32
    s_mul_i32 s48, s48, 144
    s_cmp_lt_u32 s39, 32
    s_cselect_b32 s47, s47, s48
    s_cselect_b64 vcc, -1, 0
    v_add_u32 v14, 8, v156
    v_lshrrev_b32 v15, 1, v14
    v_mul_u32_u24 v22, 18, v15
    v_and_b32 v15, 1, v15
    v_xor_b32 v15, 1, v15
    v_lshl_add_u32 v22, v15, 4, v22
    v_and_b32 v15, 1, v14
    v_add_u32 v22, v22, v15
    v_cndmask_b32 v14, v22, v14, vcc
    v_add_u32 v14, s47, v14
    v_mul_u32_u24 v14, 1152, v14
    v_add_u32 v14, v14, v160
    global_load_dwordx4 v[36:39], v14, s[4:5]
    s_add_u32 s39, s37, 1
    s_mul_i32 s47, s39, 18
    s_and_b32 s48, s39, 1
    s_lshl_b32 s48, s48, 1
    s_add_u32 s47, s47, s48
    s_sub_u32 s48, s39, 32
    s_mul_i32 s48, s48, 144
    s_cmp_lt_u32 s39, 32
    s_cselect_b32 s47, s47, s48
    s_cselect_b64 vcc, -1, 0
    v_add_u32 v14, 0, v156
    v_lshrrev_b32 v15, 1, v14
    v_mul_u32_u24 v22, 18, v15
    v_and_b32 v15, 1, v15
    v_xor_b32 v15, 1, v15
    v_lshl_add_u32 v22, v15, 4, v22
    v_and_b32 v15, 1, v14
    v_add_u32 v22, v22, v15
    v_cndmask_b32 v14, v22, v14, vcc
    v_add_u32 v14, s47, v14
    v_mul_u32_u24 v14, 1152, v14
    v_add_u32 v14, v14, v160
    global_load_dwordx4 v[40:43], v14, s[4:5]
    s_add_u32 s39, s37, 1
    s_mul_i32 s47, s39, 18
    s_and_b32 s48, s39, 1
    s_lshl_b32 s48, s48, 1
    s_add_u32 s47, s47, s48
    s_sub_u32 s48, s39, 32
    s_mul_i32 s48, s48, 144
    s_cmp_lt_u32 s39, 32
    s_cselect_b32 s47, s47, s48
    s_cselect_b64 vcc, -1, 0
    v_add_u32 v14, 8, v156
    v_lshrrev_b32 v15, 1, v14
    v_mul_u32_u24 v22, 18, v15
    v_and_b32 v15, 1, v15
    v_xor_b32 v15, 1, v15
    v_lshl_add_u32 v22, v15, 4, v22
    v_and_b32 v15, 1, v14
    v_add_u32 v22, v22, v15
    v_cndmask_b32 v14, v22, v14, vcc
    v_add_u32 v14, s47, v14
    v_mul_u32_u24 v14, 1152, v14
    v_add_u32 v14, v14, v160
    global_load_dwordx4 v[44:47], v14, s[4:5]
    s_add_u32 s39, s37, 2
    s_mul_i32 s47, s39, 18
    s_and_b32 s48, s39, 1
    s_lshl_b32 s48, s48, 1
    s_add_u32 s47, s47, s48
    s_sub_u32 s48, s39, 32
    s_mul_i32 s48, s48, 144
    s_cmp_lt_u32 s39, 32
    s_cselect_b32 s47, s47, s48
    s_cselect_b64 vcc, -1, 0
    v_add_u32 v14, 0, v156
    v_lshrrev_b32 v15, 1, v14
    v_mul_u32_u24 v22, 18, v15
    v_and_b32 v15, 1, v15
    v_xor_b32 v15, 1, v15
    v_lshl_add_u32 v22, v15, 4, v22
    v_and_b32 v15, 1, v14
    v_add_u32 v22, v22, v15
    v_cndmask_b32 v14, v22, v14, vcc
    v_add_u32 v14, s47, v14
    v_mul_u32_u24 v14, 1152, v14
    v_add_u32 v14, v14, v160
    global_load_dwordx4 v[48:51], v14, s[4:5]
    s_add_u32 s39, s37, 2
    s_mul_i32 s47, s39, 18
    s_and_b32 s48, s39, 1
    s_lshl_b32 s48, s48, 1
    s_add_u32 s47, s47, s48
    s_sub_u32 s48, s39, 32
    s_mul_i32 s48, s48, 144
    s_cmp_lt_u32 s39, 32
    s_cselect_b32 s47, s47, s48
    s_cselect_b64 vcc, -1, 0
    v_add_u32 v14, 8, v156
    v_lshrrev_b32 v15, 1, v14
    v_mul_u32_u24 v22, 18, v15
    v_and_b32 v15, 1, v15
    v_xor_b32 v15, 1, v15
    v_lshl_add_u32 v22, v15, 4, v22
    v_and_b32 v15, 1, v14
    v_add_u32 v22, v22, v15
    v_cndmask_b32 v14, v22, v14, vcc
    v_add_u32 v14, s47, v14
    v_mul_u32_u24 v14, 1152, v14
    v_add_u32 v14, v14, v160
    global_load_dwordx4 v[52:55], v14, s[4:5]
    s_add_u32 s39, s37, 3
    s_mul_i32 s47, s39, 18
    s_and_b32 s48, s39, 1
    s_lshl_b32 s48, s48, 1
    s_add_u32 s47, s47, s48
    s_sub_u32 s48, s39, 32
    s_mul_i32 s48, s48, 144
    s_cmp_lt_u32 s39, 32
    s_cselect_b32 s47, s47, s48
    s_cselect_b64 vcc, -1, 0
    v_add_u32 v14, 0, v156
    v_lshrrev_b32 v15, 1, v14
    v_mul_u32_u24 v22, 18, v15
    v_and_b32 v15, 1, v15
    v_xor_b32 v15, 1, v15
    v_lshl_add_u32 v22, v15, 4, v22
    v_and_b32 v15, 1, v14
    v_add_u32 v22, v22, v15
    v_cndmask_b32 v14, v22, v14, vcc
    v_add_u32 v14, s47, v14
    v_mul_u32_u24 v14, 1152, v14
    v_add_u32 v14, v14, v160
    global_load_dwordx4 v[56:59], v14, s[4:5]
    s_add_u32 s39, s37, 3
    s_mul_i32 s47, s39, 18
    s_and_b32 s48, s39, 1
    s_lshl_b32 s48, s48, 1
    s_add_u32 s47, s47, s48
    s_sub_u32 s48, s39, 32
    s_mul_i32 s48, s48, 144
    s_cmp_lt_u32 s39, 32
    s_cselect_b32 s47, s47, s48
    s_cselect_b64 vcc, -1, 0
    v_add_u32 v14, 8, v156
    v_lshrrev_b32 v15, 1, v14
    v_mul_u32_u24 v22, 18, v15
    v_and_b32 v15, 1, v15
    v_xor_b32 v15, 1, v15
    v_lshl_add_u32 v22, v15, 4, v22
    v_and_b32 v15, 1, v14
    v_add_u32 v22, v22, v15
    v_cndmask_b32 v14, v22, v14, vcc
    v_add_u32 v14, s47, v14
    v_mul_u32_u24 v14, 1152, v14
    v_add_u32 v14, v14, v160
    global_load_dwordx4 v[60:63], v14, s[4:5]
    s_add_u32 s39, s37, 4
    s_mul_i32 s47, s39, 18
    s_and_b32 s48, s39, 1
    s_lshl_b32 s48, s48, 1
    s_add_u32 s47, s47, s48
    s_sub_u32 s48, s39, 32
    s_mul_i32 s48, s48, 144
    s_cmp_lt_u32 s39, 32
    s_cselect_b32 s47, s47, s48
    s_cselect_b64 vcc, -1, 0
    v_add_u32 v14, 0, v156
    v_lshrrev_b32 v15, 1, v14
    v_mul_u32_u24 v22, 18, v15
    v_and_b32 v15, 1, v15
    v_xor_b32 v15, 1, v15
    v_lshl_add_u32 v22, v15, 4, v22
    v_and_b32 v15, 1, v14
    v_add_u32 v22, v22, v15
    v_cndmask_b32 v14, v22, v14, vcc
    v_add_u32 v14, s47, v14
    v_mul_u32_u24 v14, 1152, v14
    v_add_u32 v14, v14, v160
    global_load_dwordx4 v[64:67], v14, s[4:5]
    s_add_u32 s39, s37, 4
    s_mul_i32 s47, s39, 18
    s_and_b32 s48, s39, 1
    s_lshl_b32 s48, s48, 1
    s_add_u32 s47, s47, s48
    s_sub_u32 s48, s39, 32
    s_mul_i32 s48, s48, 144
    s_cmp_lt_u32 s39, 32
    s_cselect_b32 s47, s47, s48
    s_cselect_b64 vcc, -1, 0
    v_add_u32 v14, 8, v156
    v_lshrrev_b32 v15, 1, v14
    v_mul_u32_u24 v22, 18, v15
    v_and_b32 v15, 1, v15
    v_xor_b32 v15, 1, v15
    v_lshl_add_u32 v22, v15, 4, v22
    v_and_b32 v15, 1, v14
    v_add_u32 v22, v22, v15
    v_cndmask_b32 v14, v22, v14, vcc
    v_add_u32 v14, s47, v14
    v_mul_u32_u24 v14, 1152, v14
    v_add_u32 v14, v14, v160
    global_load_dwordx4 v[68:71], v14, s[4:5]
    s_add_u32 s39, s37, 5
    s_mul_i32 s47, s39, 18
    s_and_b32 s48, s39, 1
    s_lshl_b32 s48, s48, 1
    s_add_u32 s47, s47, s48
    s_sub_u32 s48, s39, 32
    s_mul_i32 s48, s48, 144
    s_cmp_lt_u32 s39, 32
    s_cselect_b32 s47, s47, s48
    s_cselect_b64 vcc, -1, 0
    v_add_u32 v14, 0, v156
    v_lshrrev_b32 v15, 1, v14
    v_mul_u32_u24 v22, 18, v15
    v_and_b32 v15, 1, v15
    v_xor_b32 v15, 1, v15
    v_lshl_add_u32 v22, v15, 4, v22
    v_and_b32 v15, 1, v14
    v_add_u32 v22, v22, v15
    v_cndmask_b32 v14, v22, v14, vcc
    v_add_u32 v14, s47, v14
    v_mul_u32_u24 v14, 1152, v14
    v_add_u32 v14, v14, v160
    global_load_dwordx4 v[72:75], v14, s[4:5]
    s_add_u32 s39, s37, 5
    s_mul_i32 s47, s39, 18
    s_and_b32 s48, s39, 1
    s_lshl_b32 s48, s48, 1
    s_add_u32 s47, s47, s48
    s_sub_u32 s48, s39, 32
    s_mul_i32 s48, s48, 144
    s_cmp_lt_u32 s39, 32
    s_cselect_b32 s47, s47, s48
    s_cselect_b64 vcc, -1, 0
    v_add_u32 v14, 8, v156
    v_lshrrev_b32 v15, 1, v14
    v_mul_u32_u24 v22, 18, v15
    v_and_b32 v15, 1, v15
    v_xor_b32 v15, 1, v15
    v_lshl_add_u32 v22, v15, 4, v22
    v_and_b32 v15, 1, v14
    v_add_u32 v22, v22, v15
    v_cndmask_b32 v14, v22, v14, vcc
    v_add_u32 v14, s47, v14
    v_mul_u32_u24 v14, 1152, v14
    v_add_u32 v14, v14, v160
    global_load_dwordx4 v[76:79], v14, s[4:5]
    s_add_u32 s39, s37, 6
    s_mul_i32 s47, s39, 18
    s_and_b32 s48, s39, 1
    s_lshl_b32 s48, s48, 1
    s_add_u32 s47, s47, s48
    s_sub_u32 s48, s39, 32
    s_mul_i32 s48, s48, 144
    s_cmp_lt_u32 s39, 32
    s_cselect_b32 s47, s47, s48
    s_cselect_b64 vcc, -1, 0
    v_add_u32 v14, 0, v156
    v_lshrrev_b32 v15, 1, v14
    v_mul_u32_u24 v22, 18, v15
    v_and_b32 v15, 1, v15
    v_xor_b32 v15, 1, v15
    v_lshl_add_u32 v22, v15, 4, v22
    v_and_b32 v15, 1, v14
    v_add_u32 v22, v22, v15
    v_cndmask_b32 v14, v22, v14, vcc
    v_add_u32 v14, s47, v14
    v_mul_u32_u24 v14, 1152, v14
    v_add_u32 v14, v14, v160
    global_load_dwordx4 v[80:83], v14, s[4:5]
    s_add_u32 s39, s37, 6
    s_mul_i32 s47, s39, 18
    s_and_b32 s48, s39, 1
    s_lshl_b32 s48, s48, 1
    s_add_u32 s47, s47, s48
    s_sub_u32 s48, s39, 32
    s_mul_i32 s48, s48, 144
    s_cmp_lt_u32 s39, 32
    s_cselect_b32 s47, s47, s48
    s_cselect_b64 vcc, -1, 0
    v_add_u32 v14, 8, v156
    v_lshrrev_b32 v15, 1, v14
    v_mul_u32_u24 v22, 18, v15
    v_and_b32 v15, 1, v15
    v_xor_b32 v15, 1, v15
    v_lshl_add_u32 v22, v15, 4, v22
    v_and_b32 v15, 1, v14
    v_add_u32 v22, v22, v15
    v_cndmask_b32 v14, v22, v14, vcc
    v_add_u32 v14, s47, v14
    v_mul_u32_u24 v14, 1152, v14
    v_add_u32 v14, v14, v160
    global_load_dwordx4 v[84:87], v14, s[4:5]
    s_add_u32 s39, s37, 7
    s_mul_i32 s47, s39, 18
    s_and_b32 s48, s39, 1
    s_lshl_b32 s48, s48, 1
    s_add_u32 s47, s47, s48
    s_sub_u32 s48, s39, 32
    s_mul_i32 s48, s48, 144
    s_cmp_lt_u32 s39, 32
    s_cselect_b32 s47, s47, s48
    s_cselect_b64 vcc, -1, 0
    v_add_u32 v14, 0, v156
    v_lshrrev_b32 v15, 1, v14
    v_mul_u32_u24 v22, 18, v15
    v_and_b32 v15, 1, v15
    v_xor_b32 v15, 1, v15
    v_lshl_add_u32 v22, v15, 4, v22
    v_and_b32 v15, 1, v14
    v_add_u32 v22, v22, v15
    v_cndmask_b32 v14, v22, v14, vcc
    v_add_u32 v14, s47, v14
    v_mul_u32_u24 v14, 1152, v14
    v_add_u32 v14, v14, v160
    global_load_dwordx4 v[88:91], v14, s[4:5]
    s_add_u32 s39, s37, 7
    s_mul_i32 s47, s39, 18
    s_and_b32 s48, s39, 1
    s_lshl_b32 s48, s48, 1
    s_add_u32 s47, s47, s48
    s_sub_u32 s48, s39, 32
    s_mul_i32 s48, s48, 144
    s_cmp_lt_u32 s39, 32
    s_cselect_b32 s47, s47, s48
    s_cselect_b64 vcc, -1, 0
    v_add_u32 v14, 8, v156
    v_lshrrev_b32 v15, 1, v14
    v_mul_u32_u24 v22, 18, v15
    v_and_b32 v15, 1, v15
    v_xor_b32 v15, 1, v15
    v_lshl_add_u32 v22, v15, 4, v22
    v_and_b32 v15, 1, v14
    v_add_u32 v22, v22, v15
    v_cndmask_b32 v14, v22, v14, vcc
    v_add_u32 v14, s47, v14
    v_mul_u32_u24 v14, 1152, v14
    v_add_u32 v14, v14, v160
    global_load_dwordx4 v[92:95], v14, s[4:5]
    s_add_u32 s39, s37, 8
    s_mul_i32 s47, s39, 18
    s_and_b32 s48, s39, 1
    s_lshl_b32 s48, s48, 1
    s_add_u32 s47, s47, s48
    s_sub_u32 s48, s39, 32
    s_mul_i32 s48, s48, 144
    s_cmp_lt_u32 s39, 32
    s_cselect_b32 s47, s47, s48
    s_cselect_b64 vcc, -1, 0
    v_add_u32 v14, 0, v156
    v_lshrrev_b32 v15, 1, v14
    v_mul_u32_u24 v22, 18, v15
    v_and_b32 v15, 1, v15
    v_xor_b32 v15, 1, v15
    v_lshl_add_u32 v22, v15, 4, v22
    v_and_b32 v15, 1, v14
    v_add_u32 v22, v22, v15
    v_cndmask_b32 v14, v22, v14, vcc
    v_add_u32 v14, s47, v14
    v_mul_u32_u24 v14, 1152, v14
    v_add_u32 v14, v14, v160
    global_load_dwordx4 v[96:99], v14, s[4:5]
    s_add_u32 s39, s37, 8
    s_mul_i32 s47, s39, 18
    s_and_b32 s48, s39, 1
    s_lshl_b32 s48, s48, 1
    s_add_u32 s47, s47, s48
    s_sub_u32 s48, s39, 32
    s_mul_i32 s48, s48, 144
    s_cmp_lt_u32 s39, 32
    s_cselect_b32 s47, s47, s48
    s_cselect_b64 vcc, -1, 0
    v_add_u32 v14, 8, v156
    v_lshrrev_b32 v15, 1, v14
    v_mul_u32_u24 v22, 18, v15
    v_and_b32 v15, 1, v15
    v_xor_b32 v15, 1, v15
    v_lshl_add_u32 v22, v15, 4, v22
    v_and_b32 v15, 1, v14
    v_add_u32 v22, v22, v15
    v_cndmask_b32 v14, v22, v14, vcc
    v_add_u32 v14, s47, v14
    v_mul_u32_u24 v14, 1152, v14
    v_add_u32 v14, v14, v160
    global_load_dwordx4 v[100:103], v14, s[4:5]
    s_waitcnt vmcnt(18)
    v_mov_b32 v15, 1
    v_mov_b32 v22, 153600
    s_mov_b64 exec, 1
    ds_add_u32 v22, v15 offset:8
    s_mov_b64 exec, -1
    v_lshlrev_b32 v161, 4, v1
    v_add_u32 v161, s35, v161
    v_lshrrev_b32 v14, 5, v1
    v_bfe_u32 v15, v1, 2, 2
    v_lshl_add_u32 v14, v14, 3, v15
    v_lshlrev_b32 v14, 7, v14
    v_bfe_u32 v15, v1, 4, 1
    v_lshl_add_u32 v14, v15, 5, v14
    v_and_b32 v15, 1, v1
    v_lshl_add_u32 v14, v15, 4, v14
    v_bfe_u32 v15, v1, 1, 1
    v_lshl_add_u32 v14, v15, 3, v14
    v_add_u32 v162, s35, v14
    s_add_u32 s38, s64, 36864
    s_waitcnt vmcnt(0)
    ds_write_b128 v161, v[32:35]
    ds_write_b128 v161, v[36:39] offset:1024
    ds_read_b64_tr_b16 v[112:113], v162 offset:0
    ds_read_b64_tr_b16 v[114:115], v162 offset:512
    s_waitcnt lgkmcnt(0)
    buffer_store_dwordx4 v[112:115], v7, s[16:19], s64 offen sc1
    ds_read_b64_tr_b16 v[116:117], v162 offset:64
    ds_read_b64_tr_b16 v[118:119], v162 offset:576
    s_waitcnt lgkmcnt(0)
    buffer_store_dwordx4 v[116:119], v7, s[16:19], s38 offen sc1
    s_add_u32 s64, s64, 1024
    s_add_u32 s38, s38, 1024
    ds_write_b128 v161, v[40:43]
    ds_write_b128 v161, v[44:47] offset:1024
    ds_read_b64_tr_b16 v[112:113], v162 offset:0
    ds_read_b64_tr_b16 v[114:115], v162 offset:512
    s_waitcnt lgkmcnt(0)
    buffer_store_dwordx4 v[112:115], v7, s[16:19], s64 offen sc1
    ds_read_b64_tr_b16 v[116:117], v162 offset:64
    ds_read_b64_tr_b16 v[118:119], v162 offset:576
    s_waitcnt lgkmcnt(0)
    buffer_store_dwordx4 v[116:119], v7, s[16:19], s38 offen sc1
    s_add_u32 s64, s64, 1024
    s_add_u32 s38, s38, 1024
    ds_write_b128 v161, v[48:51]
    ds_write_b128 v161, v[52:55] offset:1024
    ds_read_b64_tr_b16 v[112:113], v162 offset:0
    ds_read_b64_tr_b16 v[114:115], v162 offset:512
    s_waitcnt lgkmcnt(0)
    buffer_store_dwordx4 v[112:115], v7, s[16:19], s64 offen sc1
    ds_read_b64_tr_b16 v[116:117], v162 offset:64
    ds_read_b64_tr_b16 v[118:119], v162 offset:576
    s_waitcnt lgkmcnt(0)
    buffer_store_dwordx4 v[116:119], v7, s[16:19], s38 offen sc1
    s_add_u32 s64, s64, 1024
    s_add_u32 s38, s38, 1024
    ds_write_b128 v161, v[56:59]
    ds_write_b128 v161, v[60:63] offset:1024
    ds_read_b64_tr_b16 v[112:113], v162 offset:0
    ds_read_b64_tr_b16 v[114:115], v162 offset:512
    s_waitcnt lgkmcnt(0)
    buffer_store_dwordx4 v[112:115], v7, s[16:19], s64 offen sc1
    ds_read_b64_tr_b16 v[116:117], v162 offset:64
    ds_read_b64_tr_b16 v[118:119], v162 offset:576
    s_waitcnt lgkmcnt(0)
    buffer_store_dwordx4 v[116:119], v7, s[16:19], s38 offen sc1
    s_add_u32 s64, s64, 1024
    s_add_u32 s38, s38, 1024
    ds_write_b128 v161, v[64:67]
    ds_write_b128 v161, v[68:71] offset:1024
    ds_read_b64_tr_b16 v[112:113], v162 offset:0
    ds_read_b64_tr_b16 v[114:115], v162 offset:512
    s_waitcnt lgkmcnt(0)
    buffer_store_dwordx4 v[112:115], v7, s[16:19], s64 offen sc1
    ds_read_b64_tr_b16 v[116:117], v162 offset:64
    ds_read_b64_tr_b16 v[118:119], v162 offset:576
    s_waitcnt lgkmcnt(0)
    buffer_store_dwordx4 v[116:119], v7, s[16:19], s38 offen sc1
    s_add_u32 s64, s64, 1024
    s_add_u32 s38, s38, 1024
    ds_write_b128 v161, v[72:75]
    ds_write_b128 v161, v[76:79] offset:1024
    ds_read_b64_tr_b16 v[112:113], v162 offset:0
    ds_read_b64_tr_b16 v[114:115], v162 offset:512
    s_waitcnt lgkmcnt(0)
    buffer_store_dwordx4 v[112:115], v7, s[16:19], s64 offen sc1
    ds_read_b64_tr_b16 v[116:117], v162 offset:64
    ds_read_b64_tr_b16 v[118:119], v162 offset:576
    s_waitcnt lgkmcnt(0)
    buffer_store_dwordx4 v[116:119], v7, s[16:19], s38 offen sc1
    s_add_u32 s64, s64, 1024
    s_add_u32 s38, s38, 1024
    ds_write_b128 v161, v[80:83]
    ds_write_b128 v161, v[84:87] offset:1024
    ds_read_b64_tr_b16 v[112:113], v162 offset:0
    ds_read_b64_tr_b16 v[114:115], v162 offset:512
    s_waitcnt lgkmcnt(0)
    buffer_store_dwordx4 v[112:115], v7, s[16:19], s64 offen sc1
    ds_read_b64_tr_b16 v[116:117], v162 offset:64
    ds_read_b64_tr_b16 v[118:119], v162 offset:576
    s_waitcnt lgkmcnt(0)
    buffer_store_dwordx4 v[116:119], v7, s[16:19], s38 offen sc1
    s_add_u32 s64, s64, 1024
    s_add_u32 s38, s38, 1024
    ds_write_b128 v161, v[88:91]
    ds_write_b128 v161, v[92:95] offset:1024
    ds_read_b64_tr_b16 v[112:113], v162 offset:0
    ds_read_b64_tr_b16 v[114:115], v162 offset:512
    s_waitcnt lgkmcnt(0)
    buffer_store_dwordx4 v[112:115], v7, s[16:19], s64 offen sc1
    ds_read_b64_tr_b16 v[116:117], v162 offset:64
    ds_read_b64_tr_b16 v[118:119], v162 offset:576
    s_waitcnt lgkmcnt(0)
    buffer_store_dwordx4 v[116:119], v7, s[16:19], s38 offen sc1
    s_add_u32 s64, s64, 1024
    s_add_u32 s38, s38, 1024
    ds_write_b128 v161, v[96:99]
    ds_write_b128 v161, v[100:103] offset:1024
    ds_read_b64_tr_b16 v[112:113], v162 offset:0
    ds_read_b64_tr_b16 v[114:115], v162 offset:512
    s_waitcnt lgkmcnt(0)
    buffer_store_dwordx4 v[112:115], v7, s[16:19], s64 offen sc1
    ds_read_b64_tr_b16 v[116:117], v162 offset:64
    ds_read_b64_tr_b16 v[118:119], v162 offset:576
    s_waitcnt lgkmcnt(0)
    buffer_store_dwordx4 v[116:119], v7, s[16:19], s38 offen sc1
    s_add_u32 s64, s64, 1024
    s_add_u32 s38, s38, 1024
    s_endpgm
K2_PA:
    s_mul_i32 s36, s34, 7282
    s_lshr_b32 s36, s36, 16
    s_mul_i32 s37, s36, 9
    s_sub_u32 s37, s34, s37
    s_mul_i32 s38, s63, 36
    s_lshl_b32 s39, s36, 2
    s_add_u32 s38, s38, s39
    s_lshl_b32 s39, s38, 5
    s_mul_i32 s47, s37, 589824
    s_add_u32 s39, s39, s47
    v_mul_u32_u24 v160, 9216, v156
    v_lshl_add_u32 v160, v157, 4, v160
    v_add_u32 v160, s39, v160
    s_mul_i32 s47, s38, 36
    s_lshl_b32 s48, s37, 1
    s_add_u32 s47, s47, s48
    s_lshl_b32 s47, s47, 10
    s_add_u32 s64, s47, 12886016
    s_mov_b32 s65, s64
    s_mul_i32 s47, s38, 9
    s_add_u32 s47, s47, s37
    s_lshl_b32 s47, s47, 7
    s_add_u32 s49, s47, 28811264
    global_load_dwordx4 v[32:35], v160, s[40:41]
    v_add_u32 v14, 73728, v160
    global_load_dwordx4 v[36:39], v14, s[40:41]
    v_add_u32 v14, 147456, v160
    global_load_dwordx4 v[40:43], v14, s[40:41]
    v_add_u32 v14, 221184, v160
    global_load_dwordx4 v[44:47], v14, s[40:41]
    global_load_dwordx4 v[48:51], v160, s[42:43]
    v_add_u32 v14, 73728, v160
    global_load_dwordx4 v[52:55], v14, s[42:43]
    v_add_u32 v14, 147456, v160
    global_load_dwordx4 v[56:59], v14, s[42:43]
    v_add_u32 v14, 221184, v160
    global_load_dwordx4 v[60:63], v14, s[42:43]
    v_add_u32 v14, 294912, v160
    global_load_dwordx4 v[64:67], v14, s[40:41]
    v_add_u32 v14, 368640, v160
    global_load_dwordx4 v[68:71], v14, s[40:41]
    v_add_u32 v14, 442368, v160
    global_load_dwordx4 v[72:75], v14, s[40:41]
    v_add_u32 v14, 516096, v160
    global_load_dwordx4 v[76:79], v14, s[40:41]
    v_add_u32 v14, 294912, v160
    global_load_dwordx4 v[80:83], v14, s[42:43]
    v_add_u32 v14, 368640, v160
    global_load_dwordx4 v[84:87], v14, s[42:43]
    v_add_u32 v14, 442368, v160
    global_load_dwordx4 v[88:91], v14, s[42:43]
    v_add_u32 v14, 516096, v160
    global_load_dwordx4 v[92:95], v14, s[42:43]
    s_waitcnt vmcnt(16)
    v_mov_b32 v15, 1
    v_mov_b32 v22, 153600
    s_mov_b64 exec, 1
    ds_add_u32 v22, v15 offset:8
    s_mov_b64 exec, -1
    v_lshlrev_b32 v161, 5, v156
    v_and_b32 v14, 1, v157
    v_lshl_add_u32 v161, v14, 4, v161
    v_add_u32 v161, s35, v161
    v_lshrrev_b32 v14, 4, v1
    v_bfe_u32 v15, v1, 2, 2
    v_lshl_add_u32 v14, v14, 3, v15
    v_lshlrev_b32 v14, 5, v14
    v_and_b32 v15, 3, v1
    v_lshl_add_u32 v14, v15, 3, v14
    v_add_u32 v162, s35, v14
    v_mov_b32 v120, 0
    v_mov_b32 v121, 0
    v_mov_b32 v122, 0
    v_mov_b32 v123, 0
    v_mov_b32 v124, 0
    v_mov_b32 v125, 0
    v_mov_b32 v126, 0
    v_mov_b32 v127, 0
    v_mov_b32 v128, 0
    v_mov_b32 v129, 0
    v_mov_b32 v130, 0
    v_mov_b32 v131, 0
    v_mov_b32 v132, 0
    v_mov_b32 v133, 0
    v_mov_b32 v134, 0
    v_mov_b32 v135, 0
    v_mov_b32 v136, 0
    v_mov_b32 v137, 0
    v_mov_b32 v138, 0
    v_mov_b32 v139, 0
    v_mov_b32 v140, 0
    v_mov_b32 v141, 0
    v_mov_b32 v142, 0
    v_mov_b32 v143, 0
    v_mov_b32 v144, 0
    v_mov_b32 v145, 0
    v_mov_b32 v146, 0
    v_mov_b32 v147, 0
    v_mov_b32 v148, 0
    v_mov_b32 v149, 0
    v_mov_b32 v150, 0
    v_mov_b32 v151, 0
    s_waitcnt vmcnt(0)
    s_mov_b32 exec_lo, 0x3030303
    s_mov_b32 exec_hi, 0x3030303
    ds_write_b128 v161, v[32:35] offset:0
    ds_write_b128 v161, v[36:39] offset:256
    ds_write_b128 v161, v[40:43] offset:512
    ds_write_b128 v161, v[44:47] offset:768
    s_mov_b64 exec, -1
    ds_read_b64_tr_b16 v[112:113], v162 offset:0
    ds_read_b64_tr_b16 v[114:115], v162 offset:128
    s_waitcnt lgkmcnt(0)
    v_mfma_f32_16x16x32_bf16 v[120:123], v[112:115], v[152:155], v[120:123]
    s_add_u32 s47, s64, 0
    buffer_store_dwordx4 v[112:115], v7, s[16:19], s47 offen sc1
    s_mov_b32 exec_lo, 0x3030303
    s_mov_b32 exec_hi, 0x3030303
    ds_write_b128 v161, v[48:51] offset:0
    ds_write_b128 v161, v[52:55] offset:256
    ds_write_b128 v161, v[56:59] offset:512
    ds_write_b128 v161, v[60:63] offset:768
    s_mov_b64 exec, -1
    ds_read_b64_tr_b16 v[116:117], v162 offset:0
    ds_read_b64_tr_b16 v[118:119], v162 offset:128
    s_waitcnt lgkmcnt(0)
    v_mfma_f32_16x16x32_bf16 v[124:127], v[116:119], v[152:155], v[124:127]
    s_add_u32 s47, s64, 18432
    buffer_store_dwordx4 v[116:119], v7, s[16:19], s47 offen sc1
    s_mov_b32 exec_lo, 0xc0c0c0c
    s_mov_b32 exec_hi, 0xc0c0c0c
    ds_write_b128 v161, v[32:35] offset:0
    ds_write_b128 v161, v[36:39] offset:256
    ds_write_b128 v161, v[40:43] offset:512
    ds_write_b128 v161, v[44:47] offset:768
    s_mov_b64 exec, -1
    ds_read_b64_tr_b16 v[112:113], v162 offset:0
    ds_read_b64_tr_b16 v[114:115], v162 offset:128
    s_waitcnt lgkmcnt(0)
    v_mfma_f32_16x16x32_bf16 v[128:131], v[112:115], v[152:155], v[128:131]
    s_add_u32 s47, s64, 36864
    buffer_store_dwordx4 v[112:115], v7, s[16:19], s47 offen sc1
    s_mov_b32 exec_lo, 0xc0c0c0c
    s_mov_b32 exec_hi, 0xc0c0c0c
    ds_write_b128 v161, v[48:51] offset:0
    ds_write_b128 v161, v[52:55] offset:256
    ds_write_b128 v161, v[56:59] offset:512
    ds_write_b128 v161, v[60:63] offset:768
    s_mov_b64 exec, -1
    ds_read_b64_tr_b16 v[116:117], v162 offset:0
    ds_read_b64_tr_b16 v[118:119], v162 offset:128
    s_waitcnt lgkmcnt(0)
    v_mfma_f32_16x16x32_bf16 v[132:135], v[116:119], v[152:155], v[132:135]
    s_add_u32 s47, s64, 55296
    buffer_store_dwordx4 v[116:119], v7, s[16:19], s47 offen sc1
    s_mov_b32 exec_lo, 0x30303030
    s_mov_b32 exec_hi, 0x30303030
    ds_write_b128 v161, v[32:35] offset:0
    ds_write_b128 v161, v[36:39] offset:256
    ds_write_b128 v161, v[40:43] offset:512
    ds_write_b128 v161, v[44:47] offset:768
    s_mov_b64 exec, -1
    ds_read_b64_tr_b16 v[112:113], v162 offset:0
    ds_read_b64_tr_b16 v[114:115], v162 offset:128
    s_waitcnt lgkmcnt(0)
    v_mfma_f32_16x16x32_bf16 v[136:139], v[112:115], v[152:155], v[136:139]
    s_add_u32 s47, s64, 73728
    buffer_store_dwordx4 v[112:115], v7, s[16:19], s47 offen sc1
    s_mov_b32 exec_lo, 0x30303030
    s_mov_b32 exec_hi, 0x30303030
    ds_write_b128 v161, v[48:51] offset:0
    ds_write_b128 v161, v[52:55] offset:256
    ds_write_b128 v161, v[56:59] offset:512
    ds_write_b128 v161, v[60:63] offset:768
    s_mov_b64 exec, -1
    ds_read_b64_tr_b16 v[116:117], v162 offset:0
    ds_read_b64_tr_b16 v[118:119], v162 offset:128
    s_waitcnt lgkmcnt(0)
    v_mfma_f32_16x16x32_bf16 v[140:143], v[116:119], v[152:155], v[140:143]
    s_add_u32 s47, s64, 92160
    buffer_store_dwordx4 v[116:119], v7, s[16:19], s47 offen sc1
    s_mov_b32 exec_lo, 0xc0c0c0c0
    s_mov_b32 exec_hi, 0xc0c0c0c0
    ds_write_b128 v161, v[32:35] offset:0
    ds_write_b128 v161, v[36:39] offset:256
    ds_write_b128 v161, v[40:43] offset:512
    ds_write_b128 v161, v[44:47] offset:768
    s_mov_b64 exec, -1
    ds_read_b64_tr_b16 v[112:113], v162 offset:0
    ds_read_b64_tr_b16 v[114:115], v162 offset:128
    s_waitcnt lgkmcnt(0)
    v_mfma_f32_16x16x32_bf16 v[144:147], v[112:115], v[152:155], v[144:147]
    s_add_u32 s47, s64, 110592
    buffer_store_dwordx4 v[112:115], v7, s[16:19], s47 offen sc1
    s_mov_b32 exec_lo, 0xc0c0c0c0
    s_mov_b32 exec_hi, 0xc0c0c0c0
    ds_write_b128 v161, v[48:51] offset:0
    ds_write_b128 v161, v[52:55] offset:256
    ds_write_b128 v161, v[56:59] offset:512
    ds_write_b128 v161, v[60:63] offset:768
    s_mov_b64 exec, -1
    ds_read_b64_tr_b16 v[116:117], v162 offset:0
    ds_read_b64_tr_b16 v[118:119], v162 offset:128
    s_waitcnt lgkmcnt(0)
    v_mfma_f32_16x16x32_bf16 v[148:151], v[116:119], v[152:155], v[148:151]
    s_add_u32 s47, s64, 129024
    buffer_store_dwordx4 v[116:119], v7, s[16:19], s47 offen sc1
    s_mov_b32 exec_lo, 0x3030303
    s_mov_b32 exec_hi, 0x3030303
    ds_write_b128 v161, v[64:67] offset:0
    ds_write_b128 v161, v[68:71] offset:256
    ds_write_b128 v161, v[72:75] offset:512
    ds_write_b128 v161, v[76:79] offset:768
    s_mov_b64 exec, -1
    ds_read_b64_tr_b16 v[112:113], v162 offset:0
    ds_read_b64_tr_b16 v[114:115], v162 offset:128
    s_waitcnt lgkmcnt(0)
    v_mfma_f32_16x16x32_bf16 v[120:123], v[112:115], v[152:155], v[120:123]
    s_add_u32 s47, s64, 1024
    buffer_store_dwordx4 v[112:115], v7, s[16:19], s47 offen sc1
    s_mov_b32 exec_lo, 0x3030303
    s_mov_b32 exec_hi, 0x3030303
    ds_write_b128 v161, v[80:83] offset:0
    ds_write_b128 v161, v[84:87] offset:256
    ds_write_b128 v161, v[88:91] offset:512
    ds_write_b128 v161, v[92:95] offset:768
    s_mov_b64 exec, -1
    ds_read_b64_tr_b16 v[116:117], v162 offset:0
    ds_read_b64_tr_b16 v[118:119], v162 offset:128
    s_waitcnt lgkmcnt(0)
    v_mfma_f32_16x16x32_bf16 v[124:127], v[116:119], v[152:155], v[124:127]
    s_add_u32 s47, s64, 19456
    buffer_store_dwordx4 v[116:119], v7, s[16:19], s47 offen sc1
    s_mov_b32 exec_lo, 0xc0c0c0c
    s_mov_b32 exec_hi, 0xc0c0c0c
    ds_write_b128 v161, v[64:67] offset:0
    ds_write_b128 v161, v[68:71] offset:256
    ds_write_b128 v161, v[72:75] offset:512
    ds_write_b128 v161, v[76:79] offset:768
    s_mov_b64 exec, -1
    ds_read_b64_tr_b16 v[112:113], v162 offset:0
    ds_read_b64_tr_b16 v[114:115], v162 offset:128
    s_waitcnt lgkmcnt(0)
    v_mfma_f32_16x16x32_bf16 v[128:131], v[112:115], v[152:155], v[128:131]
    s_add_u32 s47, s64, 37888
    buffer_store_dwordx4 v[112:115], v7, s[16:19], s47 offen sc1
    s_mov_b32 exec_lo, 0xc0c0c0c
    s_mov_b32 exec_hi, 0xc0c0c0c
    ds_write_b128 v161, v[80:83] offset:0
    ds_write_b128 v161, v[84:87] offset:256
    ds_write_b128 v161, v[88:91] offset:512
    ds_write_b128 v161, v[92:95] offset:768
    s_mov_b64 exec, -1
    ds_read_b64_tr_b16 v[116:117], v162 offset:0
    ds_read_b64_tr_b16 v[118:119], v162 offset:128
    s_waitcnt lgkmcnt(0)
    v_mfma_f32_16x16x32_bf16 v[132:135], v[116:119], v[152:155], v[132:135]
    s_add_u32 s47, s64, 56320
    buffer_store_dwordx4 v[116:119], v7, s[16:19], s47 offen sc1
    s_mov_b32 exec_lo, 0x30303030
    s_mov_b32 exec_hi, 0x30303030
    ds_write_b128 v161, v[64:67] offset:0
    ds_write_b128 v161, v[68:71] offset:256
    ds_write_b128 v161, v[72:75] offset:512
    ds_write_b128 v161, v[76:79] offset:768
    s_mov_b64 exec, -1
    ds_read_b64_tr_b16 v[112:113], v162 offset:0
    ds_read_b64_tr_b16 v[114:115], v162 offset:128
    s_waitcnt lgkmcnt(0)
    v_mfma_f32_16x16x32_bf16 v[136:139], v[112:115], v[152:155], v[136:139]
    s_add_u32 s47, s64, 74752
    buffer_store_dwordx4 v[112:115], v7, s[16:19], s47 offen sc1
    s_mov_b32 exec_lo, 0x30303030
    s_mov_b32 exec_hi, 0x30303030
    ds_write_b128 v161, v[80:83] offset:0
    ds_write_b128 v161, v[84:87] offset:256
    ds_write_b128 v161, v[88:91] offset:512
    ds_write_b128 v161, v[92:95] offset:768
    s_mov_b64 exec, -1
    ds_read_b64_tr_b16 v[116:117], v162 offset:0
    ds_read_b64_tr_b16 v[118:119], v162 offset:128
    s_waitcnt lgkmcnt(0)
    v_mfma_f32_16x16x32_bf16 v[140:143], v[116:119], v[152:155], v[140:143]
    s_add_u32 s47, s64, 93184
    buffer_store_dwordx4 v[116:119], v7, s[16:19], s47 offen sc1
    s_mov_b32 exec_lo, 0xc0c0c0c0
    s_mov_b32 exec_hi, 0xc0c0c0c0
    ds_write_b128 v161, v[64:67] offset:0
    ds_write_b128 v161, v[68:71] offset:256
    ds_write_b128 v161, v[72:75] offset:512
    ds_write_b128 v161, v[76:79] offset:768
    s_mov_b64 exec, -1
    ds_read_b64_tr_b16 v[112:113], v162 offset:0
    ds_read_b64_tr_b16 v[114:115], v162 offset:128
    s_waitcnt lgkmcnt(0)
    v_mfma_f32_16x16x32_bf16 v[144:147], v[112:115], v[152:155], v[144:147]
    s_add_u32 s47, s64, 111616
    buffer_store_dwordx4 v[112:115], v7, s[16:19], s47 offen sc1
    s_mov_b32 exec_lo, 0xc0c0c0c0
    s_mov_b32 exec_hi, 0xc0c0c0c0
    ds_write_b128 v161, v[80:83] offset:0
    ds_write_b128 v161, v[84:87] offset:256
    ds_write_b128 v161, v[88:91] offset:512
    ds_write_b128 v161, v[92:95] offset:768
    s_mov_b64 exec, -1
    ds_read_b64_tr_b16 v[116:117], v162 offset:0
    ds_read_b64_tr_b16 v[118:119], v162 offset:128
    s_waitcnt lgkmcnt(0)
    v_mfma_f32_16x16x32_bf16 v[148:151], v[116:119], v[152:155], v[148:151]
    s_add_u32 s47, s64, 130048
    buffer_store_dwordx4 v[116:119], v7, s[16:19], s47 offen sc1
    v_lshrrev_b32 v14, 4, v1
    v_lshlrev_b32 v14, 4, v14
    s_nop 7
    s_mov_b32 exec_lo, 0x00010001
    s_mov_b32 exec_hi, 0x00010001
    s_add_u32 s47, s49, 0
    buffer_store_dwordx4 v[120:123], v14, s[12:15], s47 offen sc1
    s_add_u32 s47, s49, 64
    buffer_store_dwordx4 v[124:127], v14, s[12:15], s47 offen sc1
    s_add_u32 s47, s49, 1152
    buffer_store_dwordx4 v[128:131], v14, s[12:15], s47 offen sc1
    s_add_u32 s47, s49, 1216
    buffer_store_dwordx4 v[132:135], v14, s[12:15], s47 offen sc1
    s_add_u32 s47, s49, 2304
    buffer_store_dwordx4 v[136:139], v14, s[12:15], s47 offen sc1
    s_add_u32 s47, s49, 2368
    buffer_store_dwordx4 v[140:143], v14, s[12:15], s47 offen sc1
    s_add_u32 s47, s49, 3456
    buffer_store_dwordx4 v[144:147], v14, s[12:15], s47 offen sc1
    s_add_u32 s47, s49, 3520
    buffer_store_dwordx4 v[148:151], v14, s[12:15], s47 offen sc1
    s_mov_b64 exec, -1
    s_endpgm
K2_PB:
    s_sub_u32 s34, s34, 81
    s_lshr_b32 s36, s34, 2
    s_and_b32 s37, s34, 3
    s_min_u32 s38, s37, 2
    s_lshl_b32 s39, s37, 2
    s_cmp_eq_u32 s37, 3
    s_cselect_b32 s47, 1, 0
    s_add_u32 s39, s39, s47
    s_mul_i32 s47, s63, 18
    s_add_u32 s39, s39, s47
    s_lshr_b32 s66, s37, 1
    s_mul_i32 s47, s39, 36864
    s_lshl_b32 s48, s36, 7
    s_add_u32 s47, s47, s48
    v_mul_u32_u24 v160, 1152, v156
    v_lshl_add_u32 v160, v157, 4, v160
    v_add_u32 v160, s47, v160
    s_lshl_b32 s47, s36, 2
    s_mul_i32 s47, s47, 144
    s_add_u32 s47, s47, s39
    s_lshl_b32 s47, s47, 10
    s_add_u32 s64, s47, 23502848
    s_mov_b32 s65, s64
    global_load_dwordx4 v[32:35], v160, s[44:45]
    v_add_u32 v14, 9216, v160
    global_load_dwordx4 v[36:39], v14, s[44:45]
    v_add_u32 v14, 18432, v160
    global_load_dwordx4 v[40:43], v14, s[44:45]
    v_add_u32 v14, 27648, v160
    global_load_dwordx4 v[44:47], v14, s[44:45]
    v_add_u32 v14, 36864, v160
    global_load_dwordx4 v[48:51], v14, s[44:45]
    v_add_u32 v14, 46080, v160
    global_load_dwordx4 v[52:55], v14, s[44:45]
    v_add_u32 v14, 55296, v160
    global_load_dwordx4 v[56:59], v14, s[44:45]
    v_add_u32 v14, 64512, v160
    global_load_dwordx4 v[60:63], v14, s[44:45]
    v_add_u32 v14, 73728, v160
    global_load_dwordx4 v[64:67], v14, s[44:45]
    v_add_u32 v14, 82944, v160
    global_load_dwordx4 v[68:71], v14, s[44:45]
    v_add_u32 v14, 92160, v160
    global_load_dwordx4 v[72:75], v14, s[44:45]
    v_add_u32 v14, 101376, v160
    global_load_dwordx4 v[76:79], v14, s[44:45]
    v_add_u32 v14, 110592, v160
    global_load_dwordx4 v[80:83], v14, s[44:45]
    v_add_u32 v14, 119808, v160
    global_load_dwordx4 v[84:87], v14, s[44:45]
    v_add_u32 v14, 129024, v160
    global_load_dwordx4 v[88:91], v14, s[44:45]
    v_add_u32 v14, 138240, v160
    global_load_dwordx4 v[92:95], v14, s[44:45]
    s_cmp_eq_u32 s66, 0
    s_cbranch_scc1 K2_PB4
    v_add_u32 v14, 147456, v160
    global_load_dwordx4 v[96:99], v14, s[44:45]
    v_add_u32 v14, 156672, v160
    global_load_dwordx4 v[100:103], v14, s[44:45]
    v_add_u32 v14, 165888, v160
    global_load_dwordx4 v[104:107], v14, s[44:45]
    v_add_u32 v14, 175104, v160
    global_load_dwordx4 v[108:111], v14, s[44:45]
K2_PB4:
    s_waitcnt vmcnt(16)
    v_mov_b32 v15, 1
    v_mov_b32 v22, 153600
    s_mov_b64 exec, 1
    ds_add_u32 v22, v15 offset:8
    s_mov_b64 exec, -1
    v_lshlrev_b32 v161, 6, v156
    v_and_b32 v14, 3, v157
    v_lshl_add_u32 v161, v14, 4, v161
    v_add_u32 v161, s35, v161
    v_lshrrev_b32 v14, 4, v1
    v_bfe_u32 v15, v1, 2, 2
    v_lshl_add_u32 v14, v14, 2, v15
    v_lshlrev_b32 v14, 6, v14
    v_and_b32 v15, 3, v1
    v_lshl_add_u32 v14, v15, 4, v14
    v_add_u32 v162, s35, v14
    s_waitcnt vmcnt(0)
    s_mov_b32 exec_lo, 0xf0f0f0f
    s_mov_b32 exec_hi, 0xf0f0f0f
    ds_write_b128 v161, v[32:35] offset:0
    ds_write_b128 v161, v[36:39] offset:512
    ds_write_b128 v161, v[40:43] offset:1024
    ds_write_b128 v161, v[44:47] offset:1536
    s_mov_b64 exec, -1
    ds_read_b64_tr_b16 v[112:113], v162 offset:0
    ds_read_b64_tr_b16 v[114:115], v162 offset:1024
    s_waitcnt lgkmcnt(0)
    s_add_u32 s47, s64, 0
    buffer_store_dwordx4 v[112:115], v7, s[16:19], s47 offen sc1
    ds_read_b64_tr_b16 v[116:117], v162 offset:8
    ds_read_b64_tr_b16 v[118:119], v162 offset:1032
    s_waitcnt lgkmcnt(0)
    s_add_u32 s47, s64, 147456
    buffer_store_dwordx4 v[116:119], v7, s[16:19], s47 offen sc1
    s_mov_b32 exec_lo, 0xf0f0f0f0
    s_mov_b32 exec_hi, 0xf0f0f0f0
    ds_write_b128 v161, v[32:35] offset:0
    ds_write_b128 v161, v[36:39] offset:512
    ds_write_b128 v161, v[40:43] offset:1024
    ds_write_b128 v161, v[44:47] offset:1536
    s_mov_b64 exec, -1
    ds_read_b64_tr_b16 v[112:113], v162 offset:0
    ds_read_b64_tr_b16 v[114:115], v162 offset:1024
    s_waitcnt lgkmcnt(0)
    s_add_u32 s47, s64, 294912
    buffer_store_dwordx4 v[112:115], v7, s[16:19], s47 offen sc1
    ds_read_b64_tr_b16 v[116:117], v162 offset:8
    ds_read_b64_tr_b16 v[118:119], v162 offset:1032
    s_waitcnt lgkmcnt(0)
    s_add_u32 s47, s64, 442368
    buffer_store_dwordx4 v[116:119], v7, s[16:19], s47 offen sc1
    s_mov_b32 exec_lo, 0xf0f0f0f
    s_mov_b32 exec_hi, 0xf0f0f0f
    ds_write_b128 v161, v[48:51] offset:0
    ds_write_b128 v161, v[52:55] offset:512
    ds_write_b128 v161, v[56:59] offset:1024
    ds_write_b128 v161, v[60:63] offset:1536
    s_mov_b64 exec, -1
    ds_read_b64_tr_b16 v[112:113], v162 offset:0
    ds_read_b64_tr_b16 v[114:115], v162 offset:1024
    s_waitcnt lgkmcnt(0)
    s_add_u32 s47, s64, 1024
    buffer_store_dwordx4 v[112:115], v7, s[16:19], s47 offen sc1
    ds_read_b64_tr_b16 v[116:117], v162 offset:8
    ds_read_b64_tr_b16 v[118:119], v162 offset:1032
    s_waitcnt lgkmcnt(0)
    s_add_u32 s47, s64, 148480
    buffer_store_dwordx4 v[116:119], v7, s[16:19], s47 offen sc1
    s_mov_b32 exec_lo, 0xf0f0f0f0
    s_mov_b32 exec_hi, 0xf0f0f0f0
    ds_write_b128 v161, v[48:51] offset:0
    ds_write_b128 v161, v[52:55] offset:512
    ds_write_b128 v161, v[56:59] offset:1024
    ds_write_b128 v161, v[60:63] offset:1536
    s_mov_b64 exec, -1
    ds_read_b64_tr_b16 v[112:113], v162 offset:0
    ds_read_b64_tr_b16 v[114:115], v162 offset:1024
    s_waitcnt lgkmcnt(0)
    s_add_u32 s47, s64, 295936
    buffer_store_dwordx4 v[112:115], v7, s[16:19], s47 offen sc1
    ds_read_b64_tr_b16 v[116:117], v162 offset:8
    ds_read_b64_tr_b16 v[118:119], v162 offset:1032
    s_waitcnt lgkmcnt(0)
    s_add_u32 s47, s64, 443392
    buffer_store_dwordx4 v[116:119], v7, s[16:19], s47 offen sc1
    s_mov_b32 exec_lo, 0xf0f0f0f
    s_mov_b32 exec_hi, 0xf0f0f0f
    ds_write_b128 v161, v[64:67] offset:0
    ds_write_b128 v161, v[68:71] offset:512
    ds_write_b128 v161, v[72:75] offset:1024
    ds_write_b128 v161, v[76:79] offset:1536
    s_mov_b64 exec, -1
    ds_read_b64_tr_b16 v[112:113], v162 offset:0
    ds_read_b64_tr_b16 v[114:115], v162 offset:1024
    s_waitcnt lgkmcnt(0)
    s_add_u32 s47, s64, 2048
    buffer_store_dwordx4 v[112:115], v7, s[16:19], s47 offen sc1
    ds_read_b64_tr_b16 v[116:117], v162 offset:8
    ds_read_b64_tr_b16 v[118:119], v162 offset:1032
    s_waitcnt lgkmcnt(0)
    s_add_u32 s47, s64, 149504
    buffer_store_dwordx4 v[116:119], v7, s[16:19], s47 offen sc1
    s_mov_b32 exec_lo, 0xf0f0f0f0
    s_mov_b32 exec_hi, 0xf0f0f0f0
    ds_write_b128 v161, v[64:67] offset:0
    ds_write_b128 v161, v[68:71] offset:512
    ds_write_b128 v161, v[72:75] offset:1024
    ds_write_b128 v161, v[76:79] offset:1536
    s_mov_b64 exec, -1
    ds_read_b64_tr_b16 v[112:113], v162 offset:0
    ds_read_b64_tr_b16 v[114:115], v162 offset:1024
    s_waitcnt lgkmcnt(0)
    s_add_u32 s47, s64, 296960
    buffer_store_dwordx4 v[112:115], v7, s[16:19], s47 offen sc1
    ds_read_b64_tr_b16 v[116:117], v162 offset:8
    ds_read_b64_tr_b16 v[118:119], v162 offset:1032
    s_waitcnt lgkmcnt(0)
    s_add_u32 s47, s64, 444416
    buffer_store_dwordx4 v[116:119], v7, s[16:19], s47 offen sc1
    s_mov_b32 exec_lo, 0xf0f0f0f
    s_mov_b32 exec_hi, 0xf0f0f0f
    ds_write_b128 v161, v[80:83] offset:0
    ds_write_b128 v161, v[84:87] offset:512
    ds_write_b128 v161, v[88:91] offset:1024
    ds_write_b128 v161, v[92:95] offset:1536
    s_mov_b64 exec, -1
    ds_read_b64_tr_b16 v[112:113], v162 offset:0
    ds_read_b64_tr_b16 v[114:115], v162 offset:1024
    s_waitcnt lgkmcnt(0)
    s_add_u32 s47, s64, 3072
    buffer_store_dwordx4 v[112:115], v7, s[16:19], s47 offen sc1
    ds_read_b64_tr_b16 v[116:117], v162 offset:8
    ds_read_b64_tr_b16 v[118:119], v162 offset:1032
    s_waitcnt lgkmcnt(0)
    s_add_u32 s47, s64, 150528
    buffer_store_dwordx4 v[116:119], v7, s[16:19], s47 offen sc1
    s_mov_b32 exec_lo, 0xf0f0f0f0
    s_mov_b32 exec_hi, 0xf0f0f0f0
    ds_write_b128 v161, v[80:83] offset:0
    ds_write_b128 v161, v[84:87] offset:512
    ds_write_b128 v161, v[88:91] offset:1024
    ds_write_b128 v161, v[92:95] offset:1536
    s_mov_b64 exec, -1
    ds_read_b64_tr_b16 v[112:113], v162 offset:0
    ds_read_b64_tr_b16 v[114:115], v162 offset:1024
    s_waitcnt lgkmcnt(0)
    s_add_u32 s47, s64, 297984
    buffer_store_dwordx4 v[112:115], v7, s[16:19], s47 offen sc1
    ds_read_b64_tr_b16 v[116:117], v162 offset:8
    ds_read_b64_tr_b16 v[118:119], v162 offset:1032
    s_waitcnt lgkmcnt(0)
    s_add_u32 s47, s64, 445440
    buffer_store_dwordx4 v[116:119], v7, s[16:19], s47 offen sc1
    s_cmp_eq_u32 s66, 0
    s_cbranch_scc1 K2_PB5
    s_mov_b32 exec_lo, 0xf0f0f0f
    s_mov_b32 exec_hi, 0xf0f0f0f
    ds_write_b128 v161, v[96:99] offset:0
    ds_write_b128 v161, v[100:103] offset:512
    ds_write_b128 v161, v[104:107] offset:1024
    ds_write_b128 v161, v[108:111] offset:1536
    s_mov_b64 exec, -1
    ds_read_b64_tr_b16 v[112:113], v162 offset:0
    ds_read_b64_tr_b16 v[114:115], v162 offset:1024
    s_waitcnt lgkmcnt(0)
    s_add_u32 s47, s64, 4096
    buffer_store_dwordx4 v[112:115], v7, s[16:19], s47 offen sc1
    ds_read_b64_tr_b16 v[116:117], v162 offset:8
    ds_read_b64_tr_b16 v[118:119], v162 offset:1032
    s_waitcnt lgkmcnt(0)
    s_add_u32 s47, s64, 151552
    buffer_store_dwordx4 v[116:119], v7, s[16:19], s47 offen sc1
    s_mov_b32 exec_lo, 0xf0f0f0f0
    s_mov_b32 exec_hi, 0xf0f0f0f0
    ds_write_b128 v161, v[96:99] offset:0
    ds_write_b128 v161, v[100:103] offset:512
    ds_write_b128 v161, v[104:107] offset:1024
    ds_write_b128 v161, v[108:111] offset:1536
    s_mov_b64 exec, -1
    ds_read_b64_tr_b16 v[112:113], v162 offset:0
    ds_read_b64_tr_b16 v[114:115], v162 offset:1024
    s_waitcnt lgkmcnt(0)
    s_add_u32 s47, s64, 299008
    buffer_store_dwordx4 v[112:115], v7, s[16:19], s47 offen sc1
    ds_read_b64_tr_b16 v[116:117], v162 offset:8
    ds_read_b64_tr_b16 v[118:119], v162 offset:1032
    s_waitcnt lgkmcnt(0)
    s_add_u32 s47, s64, 446464
    buffer_store_dwordx4 v[116:119], v7, s[16:19], s47 offen sc1
K2_PB5:
    s_endpgm
    s_waitcnt vmcnt(0)
    s_add_u32 s47, s65, 0
    buffer_load_dwordx4 v[32:35], v7, s[16:19], s47 offen
    s_add_u32 s47, s65, 147456
    buffer_load_dwordx4 v[36:39], v7, s[16:19], s47 offen
    s_add_u32 s47, s65, 294912
    buffer_load_dwordx4 v[40:43], v7, s[16:19], s47 offen
    s_add_u32 s47, s65, 442368
    buffer_load_dwordx4 v[44:47], v7, s[16:19], s47 offen
    s_add_u32 s47, s65, 1024
    buffer_load_dwordx4 v[48:51], v7, s[16:19], s47 offen
    s_add_u32 s47, s65, 148480
    buffer_load_dwordx4 v[52:55], v7, s[16:19], s47 offen
    s_add_u32 s47, s65, 295936
    buffer_load_dwordx4 v[56:59], v7, s[16:19], s47 offen
    s_add_u32 s47, s65, 443392
    buffer_load_dwordx4 v[60:63], v7, s[16:19], s47 offen
    s_add_u32 s47, s65, 2048
    buffer_load_dwordx4 v[64:67], v7, s[16:19], s47 offen
    s_add_u32 s47, s65, 149504
    buffer_load_dwordx4 v[68:71], v7, s[16:19], s47 offen
    s_add_u32 s47, s65, 296960
    buffer_load_dwordx4 v[72:75], v7, s[16:19], s47 offen
    s_add_u32 s47, s65, 444416
    buffer_load_dwordx4 v[76:79], v7, s[16:19], s47 offen
    s_add_u32 s47, s65, 3072
    buffer_load_dwordx4 v[80:83], v7, s[16:19], s47 offen
    s_add_u32 s47, s65, 150528
    buffer_load_dwordx4 v[84:87], v7, s[16:19], s47 offen
    s_add_u32 s47, s65, 297984
    buffer_load_dwordx4 v[88:91], v7, s[16:19], s47 offen
    s_add_u32 s47, s65, 445440
    buffer_load_dwordx4 v[92:95], v7, s[16:19], s47 offen
    s_cmp_eq_u32 s66, 0
    s_cbranch_scc1 K2_END
    s_add_u32 s47, s65, 4096
    buffer_load_dwordx4 v[96:99], v7, s[16:19], s47 offen
    s_add_u32 s47, s65, 151552
    buffer_load_dwordx4 v[100:103], v7, s[16:19], s47 offen
    s_add_u32 s47, s65, 299008
    buffer_load_dwordx4 v[104:107], v7, s[16:19], s47 offen
    s_add_u32 s47, s65, 446464
    buffer_load_dwordx4 v[108:111], v7, s[16:19], s47 offen
    s_endpgm
K2_IDLE:
    s_waitcnt vmcnt(0)
    v_mov_b32 v15, 1
    v_mov_b32 v22, 153600
    s_mov_b64 exec, 1
    ds_add_u32 v22, v15 offset:8
    s_mov_b64 exec, -1
    s_endpgm
K2_PFC:
    s_waitcnt vmcnt(0)
    v_mov_b32 v15, 1
    v_mov_b32 v22, 153600
    s_mov_b64 exec, 1
    ds_add_u32 v22, v15 offset:8
    s_mov_b64 exec, -1
    s_sub_u32 s34, s34, 122
    s_getpc_b64 s[52:53]
PFC_3:
    s_add_u32 s52, s52, k3_wo_kernel - PFC_3
    s_addc_u32 s53, s53, 0
    s_mul_i32 s54, s34, 1
    s_add_u32 s54, s54, 0
    s_min_u32 s54, s54, 2
    s_lshl_b32 s54, s54, 10
    v_add_u32 v36, s54, v7
    global_load_dwordx4 v[32:35], v36, s[52:53]
    s_load_dwordx2 s[56:57], s[0:1], 0
    s_mul_i32 s58, s63, 294912
    s_mul_i32 s59, s34, 49152
    s_add_u32 s58, s58, s59
    s_waitcnt lgkmcnt(0)
    s_mov_b32 s60, s56
    s_and_b32 s61, s57, 0xffff
    s_mov_b32 s62, 2359296
    s_mov_b32 s63, 0x20000
    buffer_load_dwordx4 v[40:43], v7, s[60:63], s58 offen
    s_add_u32 s58, s58, 1024
    buffer_load_dwordx4 v[44:47], v7, s[60:63], s58 offen
    s_add_u32 s58, s58, 1024
    buffer_load_dwordx4 v[48:51], v7, s[60:63], s58 offen
    s_add_u32 s58, s58, 1024
    buffer_load_dwordx4 v[52:55], v7, s[60:63], s58 offen
    s_add_u32 s58, s58, 1024
    buffer_load_dwordx4 v[56:59], v7, s[60:63], s58 offen
    s_add_u32 s58, s58, 1024
    buffer_load_dwordx4 v[60:63], v7, s[60:63], s58 offen
    s_add_u32 s58, s58, 1024
    buffer_load_dwordx4 v[64:67], v7, s[60:63], s58 offen
    s_add_u32 s58, s58, 1024
    buffer_load_dwordx4 v[68:71], v7, s[60:63], s58 offen
    s_add_u32 s58, s58, 1024
    buffer_load_dwordx4 v[72:75], v7, s[60:63], s58 offen
    s_add_u32 s58, s58, 1024
    buffer_load_dwordx4 v[76:79], v7, s[60:63], s58 offen
    s_add_u32 s58, s58, 1024
    buffer_load_dwordx4 v[80:83], v7, s[60:63], s58 offen
    s_add_u32 s58, s58, 1024
    buffer_load_dwordx4 v[84:87], v7, s[60:63], s58 offen
    s_add_u32 s58, s58, 1024
    buffer_load_dwordx4 v[88:91], v7, s[60:63], s58 offen
    s_add_u32 s58, s58, 1024
    buffer_load_dwordx4 v[92:95], v7, s[60:63], s58 offen
    s_add_u32 s58, s58, 1024
    buffer_load_dwordx4 v[96:99], v7, s[60:63], s58 offen
    s_add_u32 s58, s58, 1024
    buffer_load_dwordx4 v[100:103], v7, s[60:63], s58 offen
    s_add_u32 s58, s58, 1024
    buffer_load_dwordx4 v[40:43], v7, s[60:63], s58 offen
    s_add_u32 s58, s58, 1024
    buffer_load_dwordx4 v[44:47], v7, s[60:63], s58 offen
    s_add_u32 s58, s58, 1024
    buffer_load_dwordx4 v[48:51], v7, s[60:63], s58 offen
    s_add_u32 s58, s58, 1024
    buffer_load_dwordx4 v[52:55], v7, s[60:63], s58 offen
    s_add_u32 s58, s58, 1024
    buffer_load_dwordx4 v[56:59], v7, s[60:63], s58 offen
    s_add_u32 s58, s58, 1024
    buffer_load_dwordx4 v[60:63], v7, s[60:63], s58 offen
    s_add_u32 s58, s58, 1024
    buffer_load_dwordx4 v[64:67], v7, s[60:63], s58 offen
    s_add_u32 s58, s58, 1024
    buffer_load_dwordx4 v[68:71], v7, s[60:63], s58 offen
    s_add_u32 s58, s58, 1024
    buffer_load_dwordx4 v[72:75], v7, s[60:63], s58 offen
    s_add_u32 s58, s58, 1024
    buffer_load_dwordx4 v[76:79], v7, s[60:63], s58 offen
    s_add_u32 s58, s58, 1024
    buffer_load_dwordx4 v[80:83], v7, s[60:63], s58 offen
    s_add_u32 s58, s58, 1024
    buffer_load_dwordx4 v[84:87], v7, s[60:63], s58 offen
    s_add_u32 s58, s58, 1024
    buffer_load_dwordx4 v[88:91], v7, s[60:63], s58 offen
    s_add_u32 s58, s58, 1024
    buffer_load_dwordx4 v[92:95], v7, s[60:63], s58 offen
    s_add_u32 s58, s58, 1024
    buffer_load_dwordx4 v[96:99], v7, s[60:63], s58 offen
    s_add_u32 s58, s58, 1024
    buffer_load_dwordx4 v[100:103], v7, s[60:63], s58 offen
    s_add_u32 s58, s58, 1024
    buffer_load_dwordx4 v[40:43], v7, s[60:63], s58 offen
    s_add_u32 s58, s58, 1024
    buffer_load_dwordx4 v[44:47], v7, s[60:63], s58 offen
    s_add_u32 s58, s58, 1024
    buffer_load_dwordx4 v[48:51], v7, s[60:63], s58 offen
    s_add_u32 s58, s58, 1024
    buffer_load_dwordx4 v[52:55], v7, s[60:63], s58 offen
    s_add_u32 s58, s58, 1024
    buffer_load_dwordx4 v[56:59], v7, s[60:63], s58 offen
    s_add_u32 s58, s58, 1024
    buffer_load_dwordx4 v[60:63], v7, s[60:63], s58 offen
    s_add_u32 s58, s58, 1024
    buffer_load_dwordx4 v[64:67], v7, s[60:63], s58 offen
    s_add_u32 s58, s58, 1024
    buffer_load_dwordx4 v[68:71], v7, s[60:63], s58 offen
    s_add_u32 s58, s58, 1024
    buffer_load_dwordx4 v[72:75], v7, s[60:63], s58 offen
    s_add_u32 s58, s58, 1024
    buffer_load_dwordx4 v[76:79], v7, s[60:63], s58 offen
    s_add_u32 s58, s58, 1024
    buffer_load_dwordx4 v[80:83], v7, s[60:63], s58 offen
    s_add_u32 s58, s58, 1024
    buffer_load_dwordx4 v[84:87], v7, s[60:63], s58 offen
    s_add_u32 s58, s58, 1024
    buffer_load_dwordx4 v[88:91], v7, s[60:63], s58 offen
    s_add_u32 s58, s58, 1024
    buffer_load_dwordx4 v[92:95], v7, s[60:63], s58 offen
    s_add_u32 s58, s58, 1024
    buffer_load_dwordx4 v[96:99], v7, s[60:63], s58 offen
    s_add_u32 s58, s58, 1024
    buffer_load_dwordx4 v[100:103], v7, s[60:63], s58 offen
    s_add_u32 s58, s58, 1024
K2_END:
    s_endpgm
.text
.globl k3_wo_kernel
.p2align 8
.type k3_wo_kernel,@function
k3_wo_kernel:
    s_cmp_ge_u32 s2, 256
    s_cbranch_scc1 K3_END
    s_load_dwordx2 s[8:9], s[0:1], 72
    s_load_dwordx2 s[4:5], s[0:1], 0
    v_and_b32 v1, 63, v0
    v_lshrrev_b32 v6, 6, v0
    s_and_b32 s24, s2, 7
    s_lshr_b32 s25, s2, 3
    v_readfirstlane_b32 s26, v6
    v_lshlrev_b32 v2, 4, v1
    s_waitcnt lgkmcnt(0)
    s_mov_b32 s12, s8
    s_and_b32 s13, s9, 0xffff
    s_mov_b32 s14, 48234496
    s_mov_b32 s15, 0x20000
    s_mov_b32 s16, s4
    s_and_b32 s17, s5, 0xffff
    s_mov_b32 s18, 2359296
    s_mov_b32 s19, 0x20000
    s_cmp_ge_u32 s25, 24
    s_cbranch_scc1 K3_SPARE
    s_mul_i32 s31, s25, 43
    s_lshr_b32 s31, s31, 8
    s_mul_i32 s32, s31, 6
    s_sub_u32 s32, s25, s32
    s_lshl_b32 s27, s24, 2
    s_add_u32 s27, s27, s31
    s_lshr_b32 s33, s26, 1
    s_mul_i32 s28, s32, 3
    s_add_u32 s28, s28, s33
    s_and_b32 s29, s26, 1
    s_lshl_b32 s30, s27, 1
    s_add_u32 s30, s30, s29
    s_lshl_b32 s34, s27, 1
    s_add_u32 s34, s34, s29
    s_mul_i32 s34, s34, 36864
    s_mul_i32 s35, s33, 6144
    s_add_u32 s34, s34, s35
    s_add_u32 s34, s34, 7208960
    s_mul_i32 s36, s29, 36864
    s_add_u32 s36, s36, s35
    s_mul_i32 s37, s28, 36864
    s_lshl_b32 s38, s29, 10
    s_add_u32 s37, s37, s38
    s_add_u32 s37, s37, 12222464
    s_add_u32 m0, s36, 0
    s_add_u32 s38, s34, 0
    buffer_load_dwordx4 v2, s[12:15], s38 offen lds
    s_add_u32 m0, s36, 1024
    s_add_u32 s38, s34, 1024
    buffer_load_dwordx4 v2, s[12:15], s38 offen lds
    s_add_u32 m0, s36, 2048
    s_add_u32 s38, s34, 2048
    buffer_load_dwordx4 v2, s[12:15], s38 offen lds
    s_add_u32 m0, s36, 3072
    s_add_u32 s38, s34, 3072
    buffer_load_dwordx4 v2, s[12:15], s38 offen lds
    s_add_u32 m0, s36, 4096
    s_add_u32 s38, s34, 4096
    buffer_load_dwordx4 v2, s[12:15], s38 offen lds
    s_add_u32 m0, s36, 5120
    s_add_u32 s38, s34, 5120
    buffer_load_dwordx4 v2, s[12:15], s38 offen lds
    buffer_load_dwordx4 v[16:19], v2, s[12:15], s37 offen offset:0
    buffer_load_dwordx4 v[20:23], v2, s[12:15], s37 offen offset:2048
    s_add_u32 s37, s37, 4096
    buffer_load_dwordx4 v[24:27], v2, s[12:15], s37 offen offset:0
    buffer_load_dwordx4 v[28:31], v2, s[12:15], s37 offen offset:2048
    s_add_u32 s37, s37, 4096
    buffer_load_dwordx4 v[32:35], v2, s[12:15], s37 offen offset:0
    buffer_load_dwordx4 v[36:39], v2, s[12:15], s37 offen offset:2048
    s_add_u32 s37, s37, 4096
    buffer_load_dwordx4 v[40:43], v2, s[12:15], s37 offen offset:0
    buffer_load_dwordx4 v[44:47], v2, s[12:15], s37 offen offset:2048
    s_add_u32 s37, s37, 4096
    buffer_load_dwordx4 v[48:51], v2, s[12:15], s37 offen offset:0
    s_add_u32 m0, s36, 18432
    s_add_u32 s38, s34, 18432
    buffer_load_dwordx4 v2, s[12:15], s38 offen lds
    s_add_u32 m0, s36, 19456
    s_add_u32 s38, s34, 19456
    buffer_load_dwordx4 v2, s[12:15], s38 offen lds
    s_add_u32 m0, s36, 20480
    s_add_u32 s38, s34, 20480
    buffer_load_dwordx4 v2, s[12:15], s38 offen lds
    s_add_u32 m0, s36, 21504
    s_add_u32 s38, s34, 21504
    buffer_load_dwordx4 v2, s[12:15], s38 offen lds
    s_add_u32 m0, s36, 22528
    s_add_u32 s38, s34, 22528
    buffer_load_dwordx4 v2, s[12:15], s38 offen lds
    s_add_u32 m0, s36, 23552
    s_add_u32 s38, s34, 23552
    buffer_load_dwordx4 v2, s[12:15], s38 offen lds
    buffer_load_dwordx4 v[52:55], v2, s[12:15], s37 offen offset:2048
    s_add_u32 s37, s37, 4096
    buffer_load_dwordx4 v[56:59], v2, s[12:15], s37 offen offset:0
    buffer_load_dwordx4 v[60:63], v2, s[12:15], s37 offen offset:2048
    s_add_u32 s37, s37, 4096
    buffer_load_dwordx4 v[64:67], v2, s[12:15], s37 offen offset:0
    buffer_load_dwordx4 v[68:71], v2, s[12:15], s37 offen offset:2048
    s_add_u32 s37, s37, 4096
    buffer_load_dwordx4 v[72:75], v2, s[12:15], s37 offen offset:0
    buffer_load_dwordx4 v[76:79], v2, s[12:15], s37 offen offset:2048
    s_add_u32 s37, s37, 4096
    buffer_load_dwordx4 v[80:83], v2, s[12:15], s37 offen offset:0
    buffer_load_dwordx4 v[84:87], v2, s[12:15], s37 offen offset:2048
    s_add_u32 s37, s37, 4096
    v_and_b32 v6, 31, v1
    v_mul_u32_u24 v5, 1152, v6
    v_lshrrev_b32 v7, 5, v1
    v_lshl_add_u32 v5, v7, 4, v5
    s_mul_i32 s39, s30, 36864
    s_lshl_b32 s40, s28, 6
    s_add_u32 s39, s39, s40
    buffer_load_dwordx4 v[136:139], v5, s[16:19], s39 offen
    buffer_load_dwordx4 v[140:143], v5, s[16:19], s39 offen offset:32
    s_mul_i32 s40, s29, 36864
    s_lshl_b32 s41, s29, 10
    s_add_u32 s40, s40, s41
    v_add_u32 v3, s40, v2
    s_xor_b32 s42, s29, 1
    s_mul_i32 s40, s42, 36864
    s_add_u32 s40, s40, s41
    v_add_u32 v4, s40, v2
    s_waitcnt vmcnt(17)
    s_barrier
    ds_read_b128 v[88:91], v3 offset:0
    ds_read_b128 v[96:99], v4 offset:0
    ds_read_b128 v[92:95], v3 offset:2048
    ds_read_b128 v[100:103], v4 offset:2048
    s_waitcnt lgkmcnt(2)
    v_mfma_f32_32x32x16_bf16 v[104:119], v[16:19], v[88:91], 0
    v_mfma_f32_32x32x16_bf16 v[120:135], v[16:19], v[96:99], 0
    ds_read_b128 v[88:91], v3 offset:4096
    ds_read_b128 v[96:99], v4 offset:4096
    s_waitcnt lgkmcnt(2)
    v_mfma_f32_32x32x16_bf16 v[104:119], v[20:23], v[92:95], v[104:119]
    v_mfma_f32_32x32x16_bf16 v[120:135], v[20:23], v[100:103], v[120:135]
    ds_read_b128 v[92:95], v3 offset:6144
    ds_read_b128 v[100:103], v4 offset:6144
    s_waitcnt lgkmcnt(2)
    v_mfma_f32_32x32x16_bf16 v[104:119], v[24:27], v[88:91], v[104:119]
    v_mfma_f32_32x32x16_bf16 v[120:135], v[24:27], v[96:99], v[120:135]
    ds_read_b128 v[88:91], v3 offset:8192
    ds_read_b128 v[96:99], v4 offset:8192
    s_waitcnt lgkmcnt(2)
    v_mfma_f32_32x32x16_bf16 v[104:119], v[28:31], v[92:95], v[104:119]
    v_mfma_f32_32x32x16_bf16 v[120:135], v[28:31], v[100:103], v[120:135]
    ds_read_b128 v[92:95], v3 offset:10240
    ds_read_b128 v[100:103], v4 offset:10240
    s_waitcnt lgkmcnt(2)
    v_mfma_f32_32x32x16_bf16 v[104:119], v[32:35], v[88:91], v[104:119]
    v_mfma_f32_32x32x16_bf16 v[120:135], v[32:35], v[96:99], v[120:135]
    ds_read_b128 v[88:91], v3 offset:12288
    ds_read_b128 v[96:99], v4 offset:12288
    s_waitcnt lgkmcnt(2)
    v_mfma_f32_32x32x16_bf16 v[104:119], v[36:39], v[92:95], v[104:119]
    v_mfma_f32_32x32x16_bf16 v[120:135], v[36:39], v[100:103], v[120:135]
    ds_read_b128 v[92:95], v3 offset:14336
    ds_read_b128 v[100:103], v4 offset:14336
    s_waitcnt lgkmcnt(2)
    v_mfma_f32_32x32x16_bf16 v[104:119], v[40:43], v[88:91], v[104:119]
    v_mfma_f32_32x32x16_bf16 v[120:135], v[40:43], v[96:99], v[120:135]
    ds_read_b128 v[88:91], v3 offset:16384
    ds_read_b128 v[96:99], v4 offset:16384
    s_waitcnt lgkmcnt(2)
    v_mfma_f32_32x32x16_bf16 v[104:119], v[44:47], v[92:95], v[104:119]
    v_mfma_f32_32x32x16_bf16 v[120:135], v[44:47], v[100:103], v[120:135]
    s_waitcnt lgkmcnt(0)
    v_mfma_f32_32x32x16_bf16 v[104:119], v[48:51], v[88:91], v[104:119]
    v_mfma_f32_32x32x16_bf16 v[120:135], v[48:51], v[96:99], v[120:135]
    s_waitcnt vmcnt(2)
    s_barrier
    ds_read_b128 v[92:95], v3 offset:18432
    ds_read_b128 v[100:103], v4 offset:18432
    ds_read_b128 v[88:91], v3 offset:20480
    ds_read_b128 v[96:99], v4 offset:20480
    s_waitcnt lgkmcnt(2)
    v_mfma_f32_32x32x16_bf16 v[104:119], v[52:55], v[92:95], v[104:119]
    v_mfma_f32_32x32x16_bf16 v[120:135], v[52:55], v[100:103], v[120:135]
    ds_read_b128 v[92:95], v3 offset:22528
    ds_read_b128 v[100:103], v4 offset:22528
    s_waitcnt lgkmcnt(2)
    v_mfma_f32_32x32x16_bf16 v[104:119], v[56:59], v[88:91], v[104:119]
    v_mfma_f32_32x32x16_bf16 v[120:135], v[56:59], v[96:99], v[120:135]
    ds_read_b128 v[88:91], v3 offset:24576
    ds_read_b128 v[96:99], v4 offset:24576
    s_waitcnt lgkmcnt(2)
    v_mfma_f32_32x32x16_bf16 v[104:119], v[60:63], v[92:95], v[104:119]
    v_mfma_f32_32x32x16_bf16 v[120:135], v[60:63], v[100:103], v[120:135]
    ds_read_b128 v[92:95], v3 offset:26624
    ds_read_b128 v[100:103], v4 offset:26624
    s_waitcnt lgkmcnt(2)
    v_mfma_f32_32x32x16_bf16 v[104:119], v[64:67], v[88:91], v[104:119]
    v_mfma_f32_32x32x16_bf16 v[120:135], v[64:67], v[96:99], v[120:135]
    ds_read_b128 v[88:91], v3 offset:28672
    ds_read_b128 v[96:99], v4 offset:28672
    s_waitcnt lgkmcnt(2)
    v_mfma_f32_32x32x16_bf16 v[104:119], v[68:71], v[92:95], v[104:119]
    v_mfma_f32_32x32x16_bf16 v[120:135], v[68:71], v[100:103], v[120:135]
    ds_read_b128 v[92:95], v3 offset:30720
    ds_read_b128 v[100:103], v4 offset:30720
    s_waitcnt lgkmcnt(2)
    v_mfma_f32_32x32x16_bf16 v[104:119], v[72:75], v[88:91], v[104:119]
    v_mfma_f32_32x32x16_bf16 v[120:135], v[72:75], v[96:99], v[120:135]
    ds_read_b128 v[88:91], v3 offset:32768
    ds_read_b128 v[96:99], v4 offset:32768
    s_waitcnt lgkmcnt(2)
    v_mfma_f32_32x32x16_bf16 v[104:119], v[76:79], v[92:95], v[104:119]
    v_mfma_f32_32x32x16_bf16 v[120:135], v[76:79], v[100:103], v[120:135]
    ds_read_b128 v[92:95], v3 offset:34816
    ds_read_b128 v[100:103], v4 offset:34816
    s_waitcnt lgkmcnt(2)
    v_mfma_f32_32x32x16_bf16 v[104:119], v[80:83], v[88:91], v[104:119]
    v_mfma_f32_32x32x16_bf16 v[120:135], v[80:83], v[96:99], v[120:135]
    s_waitcnt lgkmcnt(0)
    v_mfma_f32_32x32x16_bf16 v[104:119], v[84:87], v[92:95], v[104:119]
    v_mfma_f32_32x32x16_bf16 v[120:135], v[84:87], v[100:103], v[120:135]
    s_lshl_b32 s40, s26, 12
    s_add_u32 s40, s40, 73728
    v_add_u32 v6, s40, v2
    s_xor_b32 s41, s26, 1
    s_lshl_b32 s41, s41, 12
    s_add_u32 s41, s41, 73728
    v_add_u32 v7, s41, v2
    s_nop 7
    ds_write_b128 v6, v[120:123] offset:0
    ds_write_b128 v6, v[124:127] offset:1024
    ds_write_b128 v6, v[128:131] offset:2048
    ds_write_b128 v6, v[132:135] offset:3072
    s_waitcnt lgkmcnt(0)
    s_barrier
    ds_read_b128 v[144:147], v7 offset:0
    ds_read_b128 v[148:151], v7 offset:1024
    ds_read_b128 v[152:155], v7 offset:2048
    ds_read_b128 v[156:159], v7 offset:3072
    s_waitcnt vmcnt(0)
    v_lshlrev_b32 v16, 16, v136
    v_and_b32 v17, 0xffff0000, v136
    v_lshlrev_b32 v18, 16, v137
    v_and_b32 v19, 0xffff0000, v137
    v_lshlrev_b32 v20, 16, v138
    v_and_b32 v21, 0xffff0000, v138
    v_lshlrev_b32 v22, 16, v139
    v_and_b32 v23, 0xffff0000, v139
    v_lshlrev_b32 v24, 16, v140
    v_and_b32 v25, 0xffff0000, v140
    v_lshlrev_b32 v26, 16, v141
    v_and_b32 v27, 0xffff0000, v141
    v_lshlrev_b32 v28, 16, v142
    v_and_b32 v29, 0xffff0000, v142
    v_lshlrev_b32 v30, 16, v143
    v_and_b32 v31, 0xffff0000, v143
    v_pk_add_f32 v[104:105], v[104:105], v[16:17]
    v_pk_add_f32 v[106:107], v[106:107], v[18:19]
    v_pk_add_f32 v[108:109], v[108:109], v[20:21]
    v_pk_add_f32 v[110:111], v[110:111], v[22:23]
    v_pk_add_f32 v[112:113], v[112:113], v[24:25]
    v_pk_add_f32 v[114:115], v[114:115], v[26:27]
    v_pk_add_f32 v[116:117], v[116:117], v[28:29]
    v_pk_add_f32 v[118:119], v[118:119], v[30:31]
    s_waitcnt lgkmcnt(0)
    v_pk_add_f32 v[104:105], v[104:105], v[144:145]
    v_pk_add_f32 v[106:107], v[106:107], v[146:147]
    v_pk_add_f32 v[108:109], v[108:109], v[148:149]
    v_pk_add_f32 v[110:111], v[110:111], v[150:151]
    v_pk_add_f32 v[112:113], v[112:113], v[152:153]
    v_pk_add_f32 v[114:115], v[114:115], v[154:155]
    v_pk_add_f32 v[116:117], v[116:117], v[156:157]
    v_pk_add_f32 v[118:119], v[118:119], v[158:159]
    v_cvt_pk_bf16_f32 v32, v104, v105
    v_cvt_pk_bf16_f32 v33, v106, v107
    v_cvt_pk_bf16_f32 v34, v108, v109
    v_cvt_pk_bf16_f32 v35, v110, v111
    v_cvt_pk_bf16_f32 v36, v112, v113
    v_cvt_pk_bf16_f32 v37, v114, v115
    v_cvt_pk_bf16_f32 v38, v116, v117
    v_cvt_pk_bf16_f32 v39, v118, v119
    v_and_b32 v6, 15, v1
    v_bfe_u32 v7, v1, 4, 1
    v_mul_u32_u24 v7, 18432, v7
    v_lshl_add_u32 v6, v6, 4, v7
    v_lshrrev_b32 v7, 5, v1
    v_lshl_add_u32 v6, v7, 8, v6
    s_mul_i32 s40, s30, 36
    s_add_u32 s40, s40, s28
    s_lshl_b32 s40, s40, 10
    s_add_u32 s40, s40, 9568256
    buffer_store_dwordx4 v[32:35], v6, s[12:15], s40 offen sc1
    buffer_store_dwordx4 v[36:39], v6, s[12:15], s40 offen offset:512 sc1
    v_pk_add_f32 v[40:41], v[104:105], v[106:107]
    v_pk_mul_f32 v[42:43], v[104:105], v[104:105]
    v_pk_fma_f32 v[42:43], v[106:107], v[106:107], v[42:43]
    v_pk_add_f32 v[40:41], v[40:41], v[108:109]
    v_pk_fma_f32 v[42:43], v[108:109], v[108:109], v[42:43]
    v_pk_add_f32 v[40:41], v[40:41], v[110:111]
    v_pk_fma_f32 v[42:43], v[110:111], v[110:111], v[42:43]
    v_pk_add_f32 v[40:41], v[40:41], v[112:113]
    v_pk_fma_f32 v[42:43], v[112:113], v[112:113], v[42:43]
    v_pk_add_f32 v[40:41], v[40:41], v[114:115]
    v_pk_fma_f32 v[42:43], v[114:115], v[114:115], v[42:43]
    v_pk_add_f32 v[40:41], v[40:41], v[116:117]
    v_pk_fma_f32 v[42:43], v[116:117], v[116:117], v[42:43]
    v_pk_add_f32 v[40:41], v[40:41], v[118:119]
    v_pk_fma_f32 v[42:43], v[118:119], v[118:119], v[42:43]
    v_add_f32 v40, v40, v41
    v_add_f32 v41, v42, v43
    v_mov_b32 v42, v40
    v_mov_b32 v43, v41
    s_nop 1
    v_permlane32_swap_b32 v40, v42
    v_permlane32_swap_b32 v41, v43
    s_nop 1
    v_add_f32 v40, v40, v42
    v_add_f32 v41, v41, v43
    v_lshlrev_b32 v6, 3, v1
    s_mul_i32 s40, s30, 18
    s_add_u32 s40, s40, s28
    s_lshl_b32 s40, s40, 8
    s_add_u32 s40, s40, 11927552
    s_mov_b32 exec_hi, 0
    buffer_store_dwordx2 v[40:41], v6, s[12:15], s40 offen sc1
    s_mov_b64 exec, -1
    s_endpgm
K3_SPARE:
    s_sub_u32 s31, s25, 24
    s_lshl_b32 s32, s31, 3
    s_add_u32 s32, s32, s24
    s_mul_i32 s32, s32, 144
    v_add_u32 v6, s32, v0
    v_lshrrev_b32 v7, 5, v6
    v_mul_u32_u24 v7, 1152, v7
    v_bfe_u32 v8, v6, 3, 2
    v_lshl_add_u32 v7, v8, 4, v7
    v_bfe_u32 v8, v6, 2, 1
    v_lshl_add_u32 v7, v8, 6, v7
    v_and_b32 v8, 3, v6
    v_lshl_add_u32 v7, v8, 2, v7
    v_lshlrev_b32 v6, 2, v6
    s_mov_b32 s33, 28811264
    s_mov_b32 s34, 29147136
    v_cmp_gt_u32 vcc, 144, v0
    s_and_saveexec_b64 s[40:41], vcc
    s_cbranch_execz K3_NOCS
    buffer_load_dword v16, v7, s[12:15], s33 offen offset:0
    buffer_load_dword v17, v7, s[12:15], s33 offen offset:128
    buffer_load_dword v18, v7, s[12:15], s33 offen offset:256
    buffer_load_dword v19, v7, s[12:15], s33 offen offset:384
    buffer_load_dword v20, v7, s[12:15], s33 offen offset:512
    buffer_load_dword v21, v7, s[12:15], s33 offen offset:640
    buffer_load_dword v22, v7, s[12:15], s33 offen offset:768
    buffer_load_dword v23, v7, s[12:15], s33 offen offset:896
    buffer_load_dword v24, v7, s[12:15], s33 offen offset:1024
    s_waitcnt vmcnt(0)
    v_add_f32 v16, v16, v17
    v_add_f32 v16, v16, v18
    v_add_f32 v16, v16, v19
    v_add_f32 v16, v16, v20
    v_add_f32 v16, v16, v21
    v_add_f32 v16, v16, v22
    v_add_f32 v16, v16, v23
    v_add_f32 v16, v16, v24
    buffer_store_dword v16, v6, s[12:15], s34 offen sc1
K3_NOCS:
    s_mov_b64 exec, s[40:41]
    s_mul_i32 s42, s31, 6
    s_add_u32 s42, s42, s26
    s_getpc_b64 s[44:45]
PFC_4:
    s_add_u32 s44, s44, k4_ffn_kernel - PFC_4
    s_addc_u32 s45, s45, 0
    s_mul_i32 s46, s42, 1
    s_add_u32 s46, s46, 0
    s_min_u32 s46, s46, 32
    s_lshl_b32 s46, s46, 10
    v_add_u32 v36, s46, v2
    global_load_dwordx4 v[32:35], v36, s[44:45]
    s_getpc_b64 s[44:45]
PFC_5:
    s_add_u32 s44, s44, k5_reduce_kernel - PFC_5
    s_addc_u32 s45, s45, 0
    s_mul_i32 s46, s42, 1
    s_add_u32 s46, s46, 0
    s_min_u32 s46, s46, 0
    s_lshl_b32 s46, s46, 10
    v_add_u32 v36, s46, v2
    global_load_dwordx4 v[32:35], v36, s[44:45]
K3_END:
    s_endpgm
.text
.globl k4_ffn_kernel
.p2align 8
.type k4_ffn_kernel,@function
k4_ffn_kernel:
    s_cmp_ge_u32 s2, 256
    s_cbranch_scc1 K4_END
    s_load_dwordx2 s[8:9], s[0:1], 72
    v_and_b32 v61, 63, v0
    v_lshrrev_b32 v62, 6, v0
    s_and_b32 s24, s2, 7
    s_lshr_b32 s25, s2, 3
    v_readfirstlane_b32 s26, v62
    v_lshlrev_b32 v1, 4, v61
    s_waitcnt lgkmcnt(0)
    s_mov_b32 s12, s8
    s_and_b32 s13, s9, 0xffff
    s_mov_b32 s14, 48234496
    s_mov_b32 s15, 0x20000
    s_mul_i32 s36, s26, 18432
    s_mul_i32 s35, s25, 73728
    s_add_u32 s35, s35, s36
    s_add_u32 s35, s35, 9568256
    s_add_u32 m0, s36, 0
    s_add_u32 s37, s35, 0
    buffer_load_dwordx4 v1, s[12:15], s37 offen lds
    s_add_u32 m0, s36, 1024
    s_add_u32 s37, s35, 1024
    buffer_load_dwordx4 v1, s[12:15], s37 offen lds
    s_mul_i32 s28, s24, 36
    s_mul_i32 s38, s26, 3
    s_add_u32 s28, s28, s38
    s_mul_i32 s28, s28, 36864
    s_add_u32 s28, s28, 12886016
    s_mul_i32 s29, s24, 18432
    s_add_u32 s29, s29, 23502848
    v_add_u32 v46, 0, v1
    v_add_u32 v47, 18432, v1
    v_add_u32 v48, 36864, v1
    v_add_u32 v49, 55296, v1
    v_add_u32 v50, 73728, v1
    v_add_u32 v51, 92160, v1
    buffer_load_dwordx4 a[0:3], v46, s[12:15], s28 offen offset:0
    buffer_load_dwordx4 a[4:7], v47, s[12:15], s28 offen offset:0
    buffer_load_dwordx4 a[8:11], v48, s[12:15], s28 offen offset:0
    buffer_load_dwordx4 a[12:15], v49, s[12:15], s28 offen offset:0
    buffer_load_dwordx4 a[16:19], v50, s[12:15], s28 offen offset:0
    buffer_load_dwordx4 a[20:23], v51, s[12:15], s28 offen offset:0
    s_add_u32 m0, s36, 2048
    s_add_u32 s37, s35, 2048
    buffer_load_dwordx4 v1, s[12:15], s37 offen lds
    s_add_u32 m0, s36, 3072
    s_add_u32 s37, s35, 3072
    buffer_load_dwordx4 v1, s[12:15], s37 offen lds
    s_add_u32 m0, s36, 4096
    s_add_u32 s37, s35, 4096
    buffer_load_dwordx4 v1, s[12:15], s37 offen lds
    s_add_u32 m0, s36, 5120
    s_add_u32 s37, s35, 5120
    buffer_load_dwordx4 v1, s[12:15], s37 offen lds
    buffer_load_dwordx4 a[24:27], v46, s[12:15], s28 offen offset:1024
    buffer_load_dwordx4 a[28:31], v47, s[12:15], s28 offen offset:1024
    buffer_load_dwordx4 a[32:35], v48, s[12:15], s28 offen offset:1024
    buffer_load_dwordx4 a[36:39], v49, s[12:15], s28 offen offset:1024
    buffer_load_dwordx4 a[40:43], v50, s[12:15], s28 offen offset:1024
    buffer_load_dwordx4 a[44:47], v51, s[12:15], s28 offen offset:1024
    buffer_load_dwordx4 a[48:51], v46, s[12:15], s28 offen offset:2048
    buffer_load_dwordx4 a[52:55], v47, s[12:15], s28 offen offset:2048
    buffer_load_dwordx4 a[56:59], v48, s[12:15], s28 offen offset:2048
    buffer_load_dwordx4 a[60:63], v49, s[12:15], s28 offen offset:2048
    buffer_load_dwordx4 a[64:67], v50, s[12:15], s28 offen offset:2048
    buffer_load_dwordx4 a[68:71], v51, s[12:15], s28 offen offset:2048
    s_mul_i32 s39, s26, 1327104
    v_add_u32 v52, s39, v1
    v_add_u32 v53, 147456, v52
    v_add_u32 v54, 294912, v52
    v_add_u32 v55, 442368, v52
    v_add_u32 v56, 589824, v52
    v_add_u32 v57, 737280, v52
    v_add_u32 v58, 884736, v52
    v_add_u32 v59, 1032192, v52
    v_add_u32 v60, 1179648, v52
    v_add_u32 v2, 0, v1
    v_add_u32 v3, 36864, v1
    v_add_u32 v4, 73728, v1
    v_add_u32 v5, 110592, v1
    s_mul_i32 s43, s26, 3
    s_lshr_b32 s43, s43, 1
    s_lshl_b32 s43, s43, 10
    s_and_b32 s44, s26, 1
    s_cmp_eq_u32 s44, 1
    s_cselect_b32 s45, 8, 0
    s_cselect_b32 s46, 1024, 8
    s_add_u32 s45, s45, s43
    s_add_u32 s46, s46, s43
    v_add_u32 v6, s45, v4
    v_add_u32 v7, s46, v4
    s_mul_i32 s43, s26, 384
    s_add_u32 s43, s43, 147456
    v_lshrrev_b32 v63, 4, v61
    v_lshlrev_b32 v62, 5, v63
    v_add_u32 v8, s43, v62
    v_and_b32 v62, 15, v61
    v_lshlrev_b32 v62, 3, v62
    v_lshl_add_u32 v9, v63, 8, v62
    v_cmp_gt_u32 vcc, 2, v63
    v_mov_b32 v62, 0x7ff00000
    s_nop 0
    v_cndmask_b32 v63, v62, v9, vcc
    s_mul_i32 s33, s25, 9216
    s_add_u32 s33, s33, 11927552
    s_add_u32 s34, s33, 4608
    s_mul_i32 s41, s24, 4608
    s_add_u32 s41, s41, 29147136
    s_lshl_b32 s47, s26, 10
    s_lshl_b32 s44, s24, 6
    s_lshl_b32 s45, s25, 1
    s_add_u32 s44, s44, s45
    s_mul_i32 s44, s44, 36
    s_mul_i32 s45, s26, 9
    s_add_u32 s44, s44, s45
    s_lshl_b32 s30, s44, 10
    s_add_u32 s30, s30, 29360128
    s_waitcnt vmcnt(22)
    s_barrier
    ds_read_b128 a[72:75], v2 offset:0
    ds_read_b128 a[76:79], v2 offset:18432
    ds_read_b128 a[80:83], v3 offset:0
    ds_read_b128 a[84:87], v3 offset:18432
    s_waitcnt vmcnt(16) lgkmcnt(0)
    s_add_u32 m0, s36, 6144
    s_add_u32 s37, s35, 6144
    buffer_load_dwordx4 v1, s[12:15], s37 offen lds
    v_mfma_f32_16x16x32_bf16 v[64:67], a[0:3], a[72:75], 0
    v_mfma_f32_16x16x32_bf16 v[68:71], a[0:3], a[76:79], 0
    ds_read_b128 a[88:91], v2 offset:1024
    v_mfma_f32_16x16x32_bf16 v[72:75], a[0:3], a[80:83], 0
    v_mfma_f32_16x16x32_bf16 v[76:79], a[0:3], a[84:87], 0
    buffer_load_dwordx4 a[0:3], v46, s[12:15], s28 offen offset:3072
    s_add_u32 s42, s41, s47
    s_add_u32 m0, s47, 147456
    s_nop 0
    buffer_load_dwordx4 v1, s[12:15], s42 offen lds
    v_mfma_f32_16x16x32_bf16 v[80:83], a[4:7], a[72:75], 0
    v_mfma_f32_16x16x32_bf16 v[84:87], a[4:7], a[76:79], 0
    ds_read_b128 a[92:95], v2 offset:19456
    v_mfma_f32_16x16x32_bf16 v[88:91], a[4:7], a[80:83], 0
    v_mfma_f32_16x16x32_bf16 v[92:95], a[4:7], a[84:87], 0
    buffer_load_dwordx4 a[4:7], v47, s[12:15], s28 offen offset:3072
    s_add_u32 s42, s41, 4096
    s_mov_b32 m0, 151552
    s_nop 0
    buffer_load_dwordx4 v1, s[12:15], s42 offen lds
    v_mfma_f32_16x16x32_bf16 v[96:99], a[8:11], a[72:75], 0
    v_mfma_f32_16x16x32_bf16 v[100:103], a[8:11], a[76:79], 0
    ds_read_b128 a[96:99], v3 offset:1024
    v_mfma_f32_16x16x32_bf16 v[104:107], a[8:11], a[80:83], 0
    v_mfma_f32_16x16x32_bf16 v[108:111], a[8:11], a[84:87], 0
    buffer_load_dwordx4 a[8:11], v48, s[12:15], s28 offen offset:3072
    buffer_load_dwordx2 v[160:161], v9, s[12:15], s33 offen offset:0
    v_mfma_f32_16x16x32_bf16 v[112:115], a[12:15], a[72:75], 0
    v_mfma_f32_16x16x32_bf16 v[116:119], a[12:15], a[76:79], 0
    ds_read_b128 a[100:103], v3 offset:19456
    v_mfma_f32_16x16x32_bf16 v[120:123], a[12:15], a[80:83], 0
    v_mfma_f32_16x16x32_bf16 v[124:127], a[12:15], a[84:87], 0
    buffer_load_dwordx4 a[12:15], v49, s[12:15], s28 offen offset:3072
    buffer_load_dwordx2 v[162:163], v9, s[12:15], s33 offen offset:1024
    v_mfma_f32_16x16x32_bf16 v[128:131], a[16:19], a[72:75], 0
    v_mfma_f32_16x16x32_bf16 v[132:135], a[16:19], a[76:79], 0
    v_mfma_f32_16x16x32_bf16 v[136:139], a[16:19], a[80:83], 0
    v_mfma_f32_16x16x32_bf16 v[140:143], a[16:19], a[84:87], 0
    buffer_load_dwordx4 a[16:19], v50, s[12:15], s28 offen offset:3072
    buffer_load_dwordx2 v[164:165], v9, s[12:15], s33 offen offset:2048
    v_mfma_f32_16x16x32_bf16 v[144:147], a[20:23], a[72:75], 0
    v_mfma_f32_16x16x32_bf16 v[148:151], a[20:23], a[76:79], 0
    v_mfma_f32_16x16x32_bf16 v[152:155], a[20:23], a[80:83], 0
    v_mfma_f32_16x16x32_bf16 v[156:159], a[20:23], a[84:87], 0
    buffer_load_dwordx4 a[20:23], v51, s[12:15], s28 offen offset:3072
    buffer_load_dwordx2 v[166:167], v9, s[12:15], s33 offen offset:3072
    s_waitcnt vmcnt(19) lgkmcnt(0)
    s_barrier
    s_add_u32 m0, s36, 7168
    s_add_u32 s37, s35, 7168
    buffer_load_dwordx4 v1, s[12:15], s37 offen lds
    v_mfma_f32_16x16x32_bf16 v[64:67], a[24:27], a[88:91], v[64:67]
    v_mfma_f32_16x16x32_bf16 v[68:71], a[24:27], a[92:95], v[68:71]
    ds_read_b128 a[72:75], v2 offset:2048
    v_mfma_f32_16x16x32_bf16 v[72:75], a[24:27], a[96:99], v[72:75]
    v_mfma_f32_16x16x32_bf16 v[76:79], a[24:27], a[100:103], v[76:79]
    s_add_u32 s28, s28, 4096
    buffer_load_dwordx4 a[24:27], v46, s[12:15], s28 offen offset:0
    s_add_u32 s40, s33, 4096
    buffer_load_dwordx2 v[168:169], v63, s[12:15], s40 offen
    v_mfma_f32_16x16x32_bf16 v[80:83], a[28:31], a[88:91], v[80:83]
    v_mfma_f32_16x16x32_bf16 v[84:87], a[28:31], a[92:95], v[84:87]
    ds_read_b128 a[76:79], v2 offset:20480
    v_mfma_f32_16x16x32_bf16 v[88:91], a[28:31], a[96:99], v[88:91]
    v_mfma_f32_16x16x32_bf16 v[92:95], a[28:31], a[100:103], v[92:95]
    buffer_load_dwordx4 a[28:31], v47, s[12:15], s28 offen offset:0
    buffer_load_dwordx2 v[170:171], v9, s[12:15], s33 offen offset:128
    v_mfma_f32_16x16x32_bf16 v[96:99], a[32:35], a[88:91], v[96:99]
    v_mfma_f32_16x16x32_bf16 v[100:103], a[32:35], a[92:95], v[100:103]
    ds_read_b128 a[80:83], v3 offset:2048
    v_mfma_f32_16x16x32_bf16 v[104:107], a[32:35], a[96:99], v[104:107]
    v_mfma_f32_16x16x32_bf16 v[108:111], a[32:35], a[100:103], v[108:111]
    buffer_load_dwordx4 a[32:35], v48, s[12:15], s28 offen offset:0
    buffer_load_dwordx2 v[172:173], v9, s[12:15], s33 offen offset:1152
    v_mfma_f32_16x16x32_bf16 v[112:115], a[36:39], a[88:91], v[112:115]
    v_mfma_f32_16x16x32_bf16 v[116:119], a[36:39], a[92:95], v[116:119]
    ds_read_b128 a[84:87], v3 offset:20480
    v_mfma_f32_16x16x32_bf16 v[120:123], a[36:39], a[96:99], v[120:123]
    v_mfma_f32_16x16x32_bf16 v[124:127], a[36:39], a[100:103], v[124:127]
    buffer_load_dwordx4 a[36:39], v49, s[12:15], s28 offen offset:0
    buffer_load_dwordx2 v[174:175], v9, s[12:15], s33 offen offset:2176
    v_mfma_f32_16x16x32_bf16 v[128:131], a[40:43], a[88:91], v[128:131]
    v_mfma_f32_16x16x32_bf16 v[132:135], a[40:43], a[92:95], v[132:135]
    v_mfma_f32_16x16x32_bf16 v[136:139], a[40:43], a[96:99], v[136:139]
    v_mfma_f32_16x16x32_bf16 v[140:143], a[40:43], a[100:103], v[140:143]
    buffer_load_dwordx4 a[40:43], v50, s[12:15], s28 offen offset:0
    buffer_load_dwordx2 v[176:177], v9, s[12:15], s33 offen offset:3200
    v_mfma_f32_16x16x32_bf16 v[144:147], a[44:47], a[88:91], v[144:147]
    v_mfma_f32_16x16x32_bf16 v[148:151], a[44:47], a[92:95], v[148:151]
    v_mfma_f32_16x16x32_bf16 v[152:155], a[44:47], a[96:99], v[152:155]
    v_mfma_f32_16x16x32_bf16 v[156:159], a[44:47], a[100:103], v[156:159]
    buffer_load_dwordx4 a[44:47], v51, s[12:15], s28 offen offset:0
    s_add_u32 s40, s33, 4224
    buffer_load_dwordx2 v[178:179], v63, s[12:15], s40 offen
    s_waitcnt vmcnt(26) lgkmcnt(0)
    s_add_u32 m0, s36, 8192
    s_add_u32 s37, s35, 8192
    buffer_load_dwordx4 v1, s[12:15], s37 offen lds
    v_mfma_f32_16x16x32_bf16 v[64:67], a[48:51], a[72:75], v[64:67]
    v_mfma_f32_16x16x32_bf16 v[68:71], a[48:51], a[76:79], v[68:71]
    ds_read_b128 a[88:91], v2 offset:3072
    v_mfma_f32_16x16x32_bf16 v[72:75], a[48:51], a[80:83], v[72:75]
    v_mfma_f32_16x16x32_bf16 v[76:79], a[48:51], a[84:87], v[76:79]
    buffer_load_dwordx4 a[48:51], v46, s[12:15], s28 offen offset:1024
    buffer_load_dwordx2 v[180:181], v9, s[12:15], s34 offen offset:0
    v_mfma_f32_16x16x32_bf16 v[80:83], a[52:55], a[72:75], v[80:83]
    v_mfma_f32_16x16x32_bf16 v[84:87], a[52:55], a[76:79], v[84:87]
    ds_read_b128 a[92:95], v2 offset:21504
    v_mfma_f32_16x16x32_bf16 v[88:91], a[52:55], a[80:83], v[88:91]
    v_mfma_f32_16x16x32_bf16 v[92:95], a[52:55], a[84:87], v[92:95]
    buffer_load_dwordx4 a[52:55], v47, s[12:15], s28 offen offset:1024
    buffer_load_dwordx2 v[182:183], v9, s[12:15], s34 offen offset:1024
    v_mfma_f32_16x16x32_bf16 v[96:99], a[56:59], a[72:75], v[96:99]
    v_mfma_f32_16x16x32_bf16 v[100:103], a[56:59], a[76:79], v[100:103]
    ds_read_b128 a[96:99], v3 offset:3072
    v_mfma_f32_16x16x32_bf16 v[104:107], a[56:59], a[80:83], v[104:107]
    v_mfma_f32_16x16x32_bf16 v[108:111], a[56:59], a[84:87], v[108:111]
    buffer_load_dwordx4 a[56:59], v48, s[12:15], s28 offen offset:1024
    buffer_load_dwordx2 v[184:185], v9, s[12:15], s34 offen offset:2048
    v_mfma_f32_16x16x32_bf16 v[112:115], a[60:63], a[72:75], v[112:115]
    v_mfma_f32_16x16x32_bf16 v[116:119], a[60:63], a[76:79], v[116:119]
    ds_read_b128 a[100:103], v3 offset:21504
    v_mfma_f32_16x16x32_bf16 v[120:123], a[60:63], a[80:83], v[120:123]
    v_mfma_f32_16x16x32_bf16 v[124:127], a[60:63], a[84:87], v[124:127]
    buffer_load_dwordx4 a[60:63], v49, s[12:15], s28 offen offset:1024
    buffer_load_dwordx2 v[186:187], v9, s[12:15], s34 offen offset:3072
    v_mfma_f32_16x16x32_bf16 v[128:131], a[64:67], a[72:75], v[128:131]
    v_mfma_f32_16x16x32_bf16 v[132:135], a[64:67], a[76:79], v[132:135]
    v_mfma_f32_16x16x32_bf16 v[136:139], a[64:67], a[80:83], v[136:139]
    v_mfma_f32_16x16x32_bf16 v[140:143], a[64:67], a[84:87], v[140:143]
    buffer_load_dwordx4 a[64:67], v50, s[12:15], s28 offen offset:1024
    s_add_u32 s40, s34, 4096
    buffer_load_dwordx2 v[188:189], v63, s[12:15], s40 offen
    v_mfma_f32_16x16x32_bf16 v[144:147], a[68:71], a[72:75], v[144:147]
    v_mfma_f32_16x16x32_bf16 v[148:151], a[68:71], a[76:79], v[148:151]
    v_mfma_f32_16x16x32_bf16 v[152:155], a[68:71], a[80:83], v[152:155]
    v_mfma_f32_16x16x32_bf16 v[156:159], a[68:71], a[84:87], v[156:159]
    buffer_load_dwordx4 a[68:71], v51, s[12:15], s28 offen offset:1024
    buffer_load_dwordx2 v[190:191], v9, s[12:15], s34 offen offset:128
    s_waitcnt vmcnt(27) lgkmcnt(0)
    s_add_u32 m0, s36, 9216
    s_add_u32 s37, s35, 9216
    buffer_load_dwordx4 v1, s[12:15], s37 offen lds
    v_mfma_f32_16x16x32_bf16 v[64:67], a[0:3], a[88:91], v[64:67]
    v_mfma_f32_16x16x32_bf16 v[68:71], a[0:3], a[92:95], v[68:71]
    ds_read_b128 a[72:75], v2 offset:4096
    v_mfma_f32_16x16x32_bf16 v[72:75], a[0:3], a[96:99], v[72:75]
    v_mfma_f32_16x16x32_bf16 v[76:79], a[0:3], a[100:103], v[76:79]
    buffer_load_dwordx4 a[0:3], v46, s[12:15], s28 offen offset:2048
    buffer_load_dwordx2 v[192:193], v9, s[12:15], s34 offen offset:1152
    v_mfma_f32_16x16x32_bf16 v[80:83], a[4:7], a[88:91], v[80:83]
    v_mfma_f32_16x16x32_bf16 v[84:87], a[4:7], a[92:95], v[84:87]
    ds_read_b128 a[76:79], v2 offset:22528
    v_mfma_f32_16x16x32_bf16 v[88:91], a[4:7], a[96:99], v[88:91]
    v_mfma_f32_16x16x32_bf16 v[92:95], a[4:7], a[100:103], v[92:95]
    buffer_load_dwordx4 a[4:7], v47, s[12:15], s28 offen offset:2048
    buffer_load_dwordx2 v[194:195], v9, s[12:15], s34 offen offset:2176
    v_mfma_f32_16x16x32_bf16 v[96:99], a[8:11], a[88:91], v[96:99]
    v_mfma_f32_16x16x32_bf16 v[100:103], a[8:11], a[92:95], v[100:103]
    ds_read_b128 a[80:83], v3 offset:4096
    v_mfma_f32_16x16x32_bf16 v[104:107], a[8:11], a[96:99], v[104:107]
    v_mfma_f32_16x16x32_bf16 v[108:111], a[8:11], a[100:103], v[108:111]
    buffer_load_dwordx4 a[8:11], v48, s[12:15], s28 offen offset:2048
    buffer_load_dwordx2 v[196:197], v9, s[12:15], s34 offen offset:3200
    v_mfma_f32_16x16x32_bf16 v[112:115], a[12:15], a[88:91], v[112:115]
    v_mfma_f32_16x16x32_bf16 v[116:119], a[12:15], a[92:95], v[116:119]
    ds_read_b128 a[84:87], v3 offset:22528
    v_mfma_f32_16x16x32_bf16 v[120:123], a[12:15], a[96:99], v[120:123]
    v_mfma_f32_16x16x32_bf16 v[124:127], a[12:15], a[100:103], v[124:127]
    buffer_load_dwordx4 a[12:15], v49, s[12:15], s28 offen offset:2048
    s_add_u32 s40, s34, 4224
    buffer_load_dwordx2 v[198:199], v63, s[12:15], s40 offen
    v_mfma_f32_16x16x32_bf16 v[128:131], a[16:19], a[88:91], v[128:131]
    v_mfma_f32_16x16x32_bf16 v[132:135], a[16:19], a[92:95], v[132:135]
    v_mfma_f32_16x16x32_bf16 v[136:139], a[16:19], a[96:99], v[136:139]
    v_mfma_f32_16x16x32_bf16 v[140:143], a[16:19], a[100:103], v[140:143]
    buffer_load_dwordx4 a[16:19], v50, s[12:15], s28 offen offset:2048
    v_mfma_f32_16x16x32_bf16 v[144:147], a[20:23], a[88:91], v[144:147]
    v_mfma_f32_16x16x32_bf16 v[148:151], a[20:23], a[92:95], v[148:151]
    v_mfma_f32_16x16x32_bf16 v[152:155], a[20:23], a[96:99], v[152:155]
    v_mfma_f32_16x16x32_bf16 v[156:159], a[20:23], a[100:103], v[156:159]
    buffer_load_dwordx4 a[20:23], v51, s[12:15], s28 offen offset:2048
    s_waitcnt vmcnt(25) lgkmcnt(0)
    s_add_u32 m0, s36, 10240
    s_add_u32 s37, s35, 10240
    buffer_load_dwordx4 v1, s[12:15], s37 offen lds
    v_mfma_f32_16x16x32_bf16 v[64:67], a[24:27], a[72:75], v[64:67]
    v_mfma_f32_16x16x32_bf16 v[68:71], a[24:27], a[76:79], v[68:71]
    ds_read_b128 a[88:91], v2 offset:5120
    v_mfma_f32_16x16x32_bf16 v[72:75], a[24:27], a[80:83], v[72:75]
    v_mfma_f32_16x16x32_bf16 v[76:79], a[24:27], a[84:87], v[76:79]
    buffer_load_dwordx4 a[24:27], v46, s[12:15], s28 offen offset:3072
    v_mfma_f32_16x16x32_bf16 v[80:83], a[28:31], a[72:75], v[80:83]
    v_mfma_f32_16x16x32_bf16 v[84:87], a[28:31], a[76:79], v[84:87]
    ds_read_b128 a[92:95], v2 offset:23552
    v_mfma_f32_16x16x32_bf16 v[88:91], a[28:31], a[80:83], v[88:91]
    v_mfma_f32_16x16x32_bf16 v[92:95], a[28:31], a[84:87], v[92:95]
    buffer_load_dwordx4 a[28:31], v47, s[12:15], s28 offen offset:3072
    v_mfma_f32_16x16x32_bf16 v[96:99], a[32:35], a[72:75], v[96:99]
    v_mfma_f32_16x16x32_bf16 v[100:103], a[32:35], a[76:79], v[100:103]
    ds_read_b128 a[96:99], v3 offset:5120
    v_mfma_f32_16x16x32_bf16 v[104:107], a[32:35], a[80:83], v[104:107]
    v_mfma_f32_16x16x32_bf16 v[108:111], a[32:35], a[84:87], v[108:111]
    buffer_load_dwordx4 a[32:35], v48, s[12:15], s28 offen offset:3072
    v_mfma_f32_16x16x32_bf16 v[112:115], a[36:39], a[72:75], v[112:115]
    v_mfma_f32_16x16x32_bf16 v[116:119], a[36:39], a[76:79], v[116:119]
    ds_read_b128 a[100:103], v3 offset:23552
    v_mfma_f32_16x16x32_bf16 v[120:123], a[36:39], a[80:83], v[120:123]
    v_mfma_f32_16x16x32_bf16 v[124:127], a[36:39], a[84:87], v[124:127]
    buffer_load_dwordx4 a[36:39], v49, s[12:15], s28 offen offset:3072
    v_mfma_f32_16x16x32_bf16 v[128:131], a[40:43], a[72:75], v[128:131]
    v_mfma_f32_16x16x32_bf16 v[132:135], a[40:43], a[76:79], v[132:135]
    v_mfma_f32_16x16x32_bf16 v[136:139], a[40:43], a[80:83], v[136:139]
    v_mfma_f32_16x16x32_bf16 v[140:143], a[40:43], a[84:87], v[140:143]
    buffer_load_dwordx4 a[40:43], v50, s[12:15], s28 offen offset:3072
    v_mfma_f32_16x16x32_bf16 v[144:147], a[44:47], a[72:75], v[144:147]
    v_mfma_f32_16x16x32_bf16 v[148:151], a[44:47], a[76:79], v[148:151]
    v_mfma_f32_16x16x32_bf16 v[152:155], a[44:47], a[80:83], v[152:155]
    v_mfma_f32_16x16x32_bf16 v[156:159], a[44:47], a[84:87], v[156:159]
    buffer_load_dwordx4 a[44:47], v51, s[12:15], s28 offen offset:3072
    s_waitcnt vmcnt(19) lgkmcnt(0)
    s_barrier
    s_add_u32 m0, s36, 11264
    s_add_u32 s37, s35, 11264
    buffer_load_dwordx4 v1, s[12:15], s37 offen lds
    v_mfma_f32_16x16x32_bf16 v[64:67], a[48:51], a[88:91], v[64:67]
    v_mfma_f32_16x16x32_bf16 v[68:71], a[48:51], a[92:95], v[68:71]
    ds_read_b128 a[72:75], v2 offset:6144
    v_mfma_f32_16x16x32_bf16 v[72:75], a[48:51], a[96:99], v[72:75]
    v_mfma_f32_16x16x32_bf16 v[76:79], a[48:51], a[100:103], v[76:79]
    s_add_u32 s28, s28, 4096
    buffer_load_dwordx4 a[48:51], v46, s[12:15], s28 offen offset:0
    v_mfma_f32_16x16x32_bf16 v[80:83], a[52:55], a[88:91], v[80:83]
    v_mfma_f32_16x16x32_bf16 v[84:87], a[52:55], a[92:95], v[84:87]
    ds_read_b128 a[76:79], v2 offset:24576
    v_mfma_f32_16x16x32_bf16 v[88:91], a[52:55], a[96:99], v[88:91]
    v_mfma_f32_16x16x32_bf16 v[92:95], a[52:55], a[100:103], v[92:95]
    buffer_load_dwordx4 a[52:55], v47, s[12:15], s28 offen offset:0
    v_mfma_f32_16x16x32_bf16 v[96:99], a[56:59], a[88:91], v[96:99]
    v_mfma_f32_16x16x32_bf16 v[100:103], a[56:59], a[92:95], v[100:103]
    ds_read_b128 a[80:83], v3 offset:6144
    v_mfma_f32_16x16x32_bf16 v[104:107], a[56:59], a[96:99], v[104:107]
    v_mfma_f32_16x16x32_bf16 v[108:111], a[56:59], a[100:103], v[108:111]
    buffer_load_dwordx4 a[56:59], v48, s[12:15], s28 offen offset:0
    v_mfma_f32_16x16x32_bf16 v[112:115], a[60:63], a[88:91], v[112:115]
    v_mfma_f32_16x16x32_bf16 v[116:119], a[60:63], a[92:95], v[116:119]
    ds_read_b128 a[84:87], v3 offset:24576
    v_mfma_f32_16x16x32_bf16 v[120:123], a[60:63], a[96:99], v[120:123]
    v_mfma_f32_16x16x32_bf16 v[124:127], a[60:63], a[100:103], v[124:127]
    buffer_load_dwordx4 a[60:63], v49, s[12:15], s28 offen offset:0
    v_mfma_f32_16x16x32_bf16 v[128:131], a[64:67], a[88:91], v[128:131]
    v_mfma_f32_16x16x32_bf16 v[132:135], a[64:67], a[92:95], v[132:135]
    v_mfma_f32_16x16x32_bf16 v[136:139], a[64:67], a[96:99], v[136:139]
    v_mfma_f32_16x16x32_bf16 v[140:143], a[64:67], a[100:103], v[140:143]
    buffer_load_dwordx4 a[64:67], v50, s[12:15], s28 offen offset:0
    v_mfma_f32_16x16x32_bf16 v[144:147], a[68:71], a[88:91], v[144:147]
    v_mfma_f32_16x16x32_bf16 v[148:151], a[68:71], a[92:95], v[148:151]
    v_mfma_f32_16x16x32_bf16 v[152:155], a[68:71], a[96:99], v[152:155]
    v_mfma_f32_16x16x32_bf16 v[156:159], a[68:71], a[100:103], v[156:159]
    buffer_load_dwordx4 a[68:71], v51, s[12:15], s28 offen offset:0
    s_waitcnt vmcnt(14) lgkmcnt(0)
    s_add_u32 m0, s36, 12288
    s_add_u32 s37, s35, 12288
    buffer_load_dwordx4 v1, s[12:15], s37 offen lds
    v_mfma_f32_16x16x32_bf16 v[64:67], a[0:3], a[72:75], v[64:67]
    v_mfma_f32_16x16x32_bf16 v[68:71], a[0:3], a[76:79], v[68:71]
    ds_read_b128 a[88:91], v2 offset:7168
    v_mfma_f32_16x16x32_bf16 v[72:75], a[0:3], a[80:83], v[72:75]
    v_mfma_f32_16x16x32_bf16 v[76:79], a[0:3], a[84:87], v[76:79]
    buffer_load_dwordx4 a[0:3], v46, s[12:15], s28 offen offset:1024
    v_mfma_f32_16x16x32_bf16 v[80:83], a[4:7], a[72:75], v[80:83]
    v_mfma_f32_16x16x32_bf16 v[84:87], a[4:7], a[76:79], v[84:87]
    ds_read_b128 a[92:95], v2 offset:25600
    v_mfma_f32_16x16x32_bf16 v[88:91], a[4:7], a[80:83], v[88:91]
    v_mfma_f32_16x16x32_bf16 v[92:95], a[4:7], a[84:87], v[92:95]
    buffer_load_dwordx4 a[4:7], v47, s[12:15], s28 offen offset:1024
    v_mfma_f32_16x16x32_bf16 v[96:99], a[8:11], a[72:75], v[96:99]
    v_mfma_f32_16x16x32_bf16 v[100:103], a[8:11], a[76:79], v[100:103]
    ds_read_b128 a[96:99], v3 offset:7168
    v_mfma_f32_16x16x32_bf16 v[104:107], a[8:11], a[80:83], v[104:107]
    v_mfma_f32_16x16x32_bf16 v[108:111], a[8:11], a[84:87], v[108:111]
    buffer_load_dwordx4 a[8:11], v48, s[12:15], s28 offen offset:1024
    v_mfma_f32_16x16x32_bf16 v[112:115], a[12:15], a[72:75], v[112:115]
    v_mfma_f32_16x16x32_bf16 v[116:119], a[12:15], a[76:79], v[116:119]
    ds_read_b128 a[100:103], v3 offset:25600
    v_mfma_f32_16x16x32_bf16 v[120:123], a[12:15], a[80:83], v[120:123]
    v_mfma_f32_16x16x32_bf16 v[124:127], a[12:15], a[84:87], v[124:127]
    buffer_load_dwordx4 a[12:15], v49, s[12:15], s28 offen offset:1024
    v_mfma_f32_16x16x32_bf16 v[128:131], a[16:19], a[72:75], v[128:131]
    v_mfma_f32_16x16x32_bf16 v[132:135], a[16:19], a[76:79], v[132:135]
    v_mfma_f32_16x16x32_bf16 v[136:139], a[16:19], a[80:83], v[136:139]
    v_mfma_f32_16x16x32_bf16 v[140:143], a[16:19], a[84:87], v[140:143]
    buffer_load_dwordx4 a[16:19], v50, s[12:15], s28 offen offset:1024
    v_mfma_f32_16x16x32_bf16 v[144:147], a[20:23], a[72:75], v[144:147]
    v_mfma_f32_16x16x32_bf16 v[148:151], a[20:23], a[76:79], v[148:151]
    v_mfma_f32_16x16x32_bf16 v[152:155], a[20:23], a[80:83], v[152:155]
    v_mfma_f32_16x16x32_bf16 v[156:159], a[20:23], a[84:87], v[156:159]
    buffer_load_dwordx4 a[20:23], v51, s[12:15], s28 offen offset:1024
    s_waitcnt vmcnt(14) lgkmcnt(0)
    s_add_u32 m0, s36, 13312
    s_add_u32 s37, s35, 13312
    buffer_load_dwordx4 v1, s[12:15], s37 offen lds
    v_mfma_f32_16x16x32_bf16 v[64:67], a[24:27], a[88:91], v[64:67]
    v_mfma_f32_16x16x32_bf16 v[68:71], a[24:27], a[92:95], v[68:71]
    ds_read_b128 a[72:75], v2 offset:8192
    v_mfma_f32_16x16x32_bf16 v[72:75], a[24:27], a[96:99], v[72:75]
    v_mfma_f32_16x16x32_bf16 v[76:79], a[24:27], a[100:103], v[76:79]
    buffer_load_dwordx4 a[24:27], v46, s[12:15], s28 offen offset:2048
    v_mfma_f32_16x16x32_bf16 v[80:83], a[28:31], a[88:91], v[80:83]
    v_mfma_f32_16x16x32_bf16 v[84:87], a[28:31], a[92:95], v[84:87]
    ds_read_b128 a[76:79], v2 offset:26624
    v_mfma_f32_16x16x32_bf16 v[88:91], a[28:31], a[96:99], v[88:91]
    v_mfma_f32_16x16x32_bf16 v[92:95], a[28:31], a[100:103], v[92:95]
    buffer_load_dwordx4 a[28:31], v47, s[12:15], s28 offen offset:2048
    v_mfma_f32_16x16x32_bf16 v[96:99], a[32:35], a[88:91], v[96:99]
    v_mfma_f32_16x16x32_bf16 v[100:103], a[32:35], a[92:95], v[100:103]
    ds_read_b128 a[80:83], v3 offset:8192
    v_mfma_f32_16x16x32_bf16 v[104:107], a[32:35], a[96:99], v[104:107]
    v_mfma_f32_16x16x32_bf16 v[108:111], a[32:35], a[100:103], v[108:111]
    buffer_load_dwordx4 a[32:35], v48, s[12:15], s28 offen offset:2048
    v_mfma_f32_16x16x32_bf16 v[112:115], a[36:39], a[88:91], v[112:115]
    v_mfma_f32_16x16x32_bf16 v[116:119], a[36:39], a[92:95], v[116:119]
    ds_read_b128 a[84:87], v3 offset:26624
    v_mfma_f32_16x16x32_bf16 v[120:123], a[36:39], a[96:99], v[120:123]
    v_mfma_f32_16x16x32_bf16 v[124:127], a[36:39], a[100:103], v[124:127]
    buffer_load_dwordx4 a[36:39], v49, s[12:15], s28 offen offset:2048
    v_mfma_f32_16x16x32_bf16 v[128:131], a[40:43], a[88:91], v[128:131]
    v_mfma_f32_16x16x32_bf16 v[132:135], a[40:43], a[92:95], v[132:135]
    v_mfma_f32_16x16x32_bf16 v[136:139], a[40:43], a[96:99], v[136:139]
    v_mfma_f32_16x16x32_bf16 v[140:143], a[40:43], a[100:103], v[140:143]
    buffer_load_dwordx4 a[40:43], v50, s[12:15], s28 offen offset:2048
    v_mfma_f32_16x16x32_bf16 v[144:147], a[44:47], a[88:91], v[144:147]
    v_mfma_f32_16x16x32_bf16 v[148:151], a[44:47], a[92:95], v[148:151]
    v_mfma_f32_16x16x32_bf16 v[152:155], a[44:47], a[96:99], v[152:155]
    v_mfma_f32_16x16x32_bf16 v[156:159], a[44:47], a[100:103], v[156:159]
    buffer_load_dwordx4 a[44:47], v51, s[12:15], s28 offen offset:2048
    s_waitcnt vmcnt(14) lgkmcnt(0)
    s_barrier
    s_add_u32 m0, s36, 14336
    s_add_u32 s37, s35, 14336
    buffer_load_dwordx4 v1, s[12:15], s37 offen lds
    v_mfma_f32_16x16x32_bf16 v[64:67], a[48:51], a[72:75], v[64:67]
    v_mfma_f32_16x16x32_bf16 v[68:71], a[48:51], a[76:79], v[68:71]
    ds_read_b128 a[88:91], v2 offset:9216
    v_mfma_f32_16x16x32_bf16 v[72:75], a[48:51], a[80:83], v[72:75]
    v_mfma_f32_16x16x32_bf16 v[76:79], a[48:51], a[84:87], v[76:79]
    buffer_load_dwordx4 a[48:51], v46, s[12:15], s28 offen offset:3072
    v_mfma_f32_16x16x32_bf16 v[80:83], a[52:55], a[72:75], v[80:83]
    v_mfma_f32_16x16x32_bf16 v[84:87], a[52:55], a[76:79], v[84:87]
    ds_read_b128 a[92:95], v2 offset:27648
    v_mfma_f32_16x16x32_bf16 v[88:91], a[52:55], a[80:83], v[88:91]
    v_mfma_f32_16x16x32_bf16 v[92:95], a[52:55], a[84:87], v[92:95]
    buffer_load_dwordx4 a[52:55], v47, s[12:15], s28 offen offset:3072
    v_mfma_f32_16x16x32_bf16 v[96:99], a[56:59], a[72:75], v[96:99]
    v_mfma_f32_16x16x32_bf16 v[100:103], a[56:59], a[76:79], v[100:103]
    ds_read_b128 a[96:99], v3 offset:9216
    v_mfma_f32_16x16x32_bf16 v[104:107], a[56:59], a[80:83], v[104:107]
    v_mfma_f32_16x16x32_bf16 v[108:111], a[56:59], a[84:87], v[108:111]
    buffer_load_dwordx4 a[56:59], v48, s[12:15], s28 offen offset:3072
    v_mfma_f32_16x16x32_bf16 v[112:115], a[60:63], a[72:75], v[112:115]
    v_mfma_f32_16x16x32_bf16 v[116:119], a[60:63], a[76:79], v[116:119]
    ds_read_b128 a[100:103], v3 offset:27648
    v_mfma_f32_16x16x32_bf16 v[120:123], a[60:63], a[80:83], v[120:123]
    v_mfma_f32_16x16x32_bf16 v[124:127], a[60:63], a[84:87], v[124:127]
    buffer_load_dwordx4 a[60:63], v49, s[12:15], s28 offen offset:3072
    v_mfma_f32_16x16x32_bf16 v[128:131], a[64:67], a[72:75], v[128:131]
    v_mfma_f32_16x16x32_bf16 v[132:135], a[64:67], a[76:79], v[132:135]
    v_mfma_f32_16x16x32_bf16 v[136:139], a[64:67], a[80:83], v[136:139]
    v_mfma_f32_16x16x32_bf16 v[140:143], a[64:67], a[84:87], v[140:143]
    buffer_load_dwordx4 a[64:67], v50, s[12:15], s28 offen offset:3072
    v_mfma_f32_16x16x32_bf16 v[144:147], a[68:71], a[72:75], v[144:147]
    v_mfma_f32_16x16x32_bf16 v[148:151], a[68:71], a[76:79], v[148:151]
    v_mfma_f32_16x16x32_bf16 v[152:155], a[68:71], a[80:83], v[152:155]
    v_mfma_f32_16x16x32_bf16 v[156:159], a[68:71], a[84:87], v[156:159]
    buffer_load_dwordx4 a[68:71], v51, s[12:15], s28 offen offset:3072
    s_waitcnt vmcnt(14) lgkmcnt(0)
    s_add_u32 m0, s36, 15360
    s_add_u32 s37, s35, 15360
    buffer_load_dwordx4 v1, s[12:15], s37 offen lds
    v_mfma_f32_16x16x32_bf16 v[64:67], a[0:3], a[88:91], v[64:67]
    v_mfma_f32_16x16x32_bf16 v[68:71], a[0:3], a[92:95], v[68:71]
    ds_read_b128 a[72:75], v2 offset:10240
    v_mfma_f32_16x16x32_bf16 v[72:75], a[0:3], a[96:99], v[72:75]
    v_mfma_f32_16x16x32_bf16 v[76:79], a[0:3], a[100:103], v[76:79]
    s_add_u32 s28, s28, 4096
    buffer_load_dwordx4 a[0:3], v46, s[12:15], s28 offen offset:0
    v_mfma_f32_16x16x32_bf16 v[80:83], a[4:7], a[88:91], v[80:83]
    v_mfma_f32_16x16x32_bf16 v[84:87], a[4:7], a[92:95], v[84:87]
    ds_read_b128 a[76:79], v2 offset:28672
    v_mfma_f32_16x16x32_bf16 v[88:91], a[4:7], a[96:99], v[88:91]
    v_mfma_f32_16x16x32_bf16 v[92:95], a[4:7], a[100:103], v[92:95]
    buffer_load_dwordx4 a[4:7], v47, s[12:15], s28 offen offset:0
    v_mfma_f32_16x16x32_bf16 v[96:99], a[8:11], a[88:91], v[96:99]
    v_mfma_f32_16x16x32_bf16 v[100:103], a[8:11], a[92:95], v[100:103]
    ds_read_b128 a[80:83], v3 offset:10240
    v_mfma_f32_16x16x32_bf16 v[104:107], a[8:11], a[96:99], v[104:107]
    v_mfma_f32_16x16x32_bf16 v[108:111], a[8:11], a[100:103], v[108:111]
    buffer_load_dwordx4 a[8:11], v48, s[12:15], s28 offen offset:0
    v_mfma_f32_16x16x32_bf16 v[112:115], a[12:15], a[88:91], v[112:115]
    v_mfma_f32_16x16x32_bf16 v[116:119], a[12:15], a[92:95], v[116:119]
    ds_read_b128 a[84:87], v3 offset:28672
    v_mfma_f32_16x16x32_bf16 v[120:123], a[12:15], a[96:99], v[120:123]
    v_mfma_f32_16x16x32_bf16 v[124:127], a[12:15], a[100:103], v[124:127]
    buffer_load_dwordx4 a[12:15], v49, s[12:15], s28 offen offset:0
    v_mfma_f32_16x16x32_bf16 v[128:131], a[16:19], a[88:91], v[128:131]
    v_mfma_f32_16x16x32_bf16 v[132:135], a[16:19], a[92:95], v[132:135]
    v_mfma_f32_16x16x32_bf16 v[136:139], a[16:19], a[96:99], v[136:139]
    v_mfma_f32_16x16x32_bf16 v[140:143], a[16:19], a[100:103], v[140:143]
    buffer_load_dwordx4 a[16:19], v50, s[12:15], s28 offen offset:0
    v_mfma_f32_16x16x32_bf16 v[144:147], a[20:23], a[88:91], v[144:147]
    v_mfma_f32_16x16x32_bf16 v[148:151], a[20:23], a[92:95], v[148:151]
    v_mfma_f32_16x16x32_bf16 v[152:155], a[20:23], a[96:99], v[152:155]
    v_mfma_f32_16x16x32_bf16 v[156:159], a[20:23], a[100:103], v[156:159]
    buffer_load_dwordx4 a[20:23], v51, s[12:15], s28 offen offset:0
    s_waitcnt vmcnt(14) lgkmcnt(0)
    s_add_u32 m0, s36, 16384
    s_add_u32 s37, s35, 16384
    buffer_load_dwordx4 v1, s[12:15], s37 offen lds
    v_mfma_f32_16x16x32_bf16 v[64:67], a[24:27], a[72:75], v[64:67]
    v_mfma_f32_16x16x32_bf16 v[68:71], a[24:27], a[76:79], v[68:71]
    ds_read_b128 a[88:91], v2 offset:11264
    v_mfma_f32_16x16x32_bf16 v[72:75], a[24:27], a[80:83], v[72:75]
    v_mfma_f32_16x16x32_bf16 v[76:79], a[24:27], a[84:87], v[76:79]
    buffer_load_dwordx4 a[24:27], v46, s[12:15], s28 offen offset:1024
    v_mfma_f32_16x16x32_bf16 v[80:83], a[28:31], a[72:75], v[80:83]
    v_mfma_f32_16x16x32_bf16 v[84:87], a[28:31], a[76:79], v[84:87]
    ds_read_b128 a[92:95], v2 offset:29696
    v_mfma_f32_16x16x32_bf16 v[88:91], a[28:31], a[80:83], v[88:91]
    v_mfma_f32_16x16x32_bf16 v[92:95], a[28:31], a[84:87], v[92:95]
    buffer_load_dwordx4 a[28:31], v47, s[12:15], s28 offen offset:1024
    v_mfma_f32_16x16x32_bf16 v[96:99], a[32:35], a[72:75], v[96:99]
    v_mfma_f32_16x16x32_bf16 v[100:103], a[32:35], a[76:79], v[100:103]
    ds_read_b128 a[96:99], v3 offset:11264
    v_mfma_f32_16x16x32_bf16 v[104:107], a[32:35], a[80:83], v[104:107]
    v_mfma_f32_16x16x32_bf16 v[108:111], a[32:35], a[84:87], v[108:111]
    buffer_load_dwordx4 a[32:35], v48, s[12:15], s28 offen offset:1024
    v_mfma_f32_16x16x32_bf16 v[112:115], a[36:39], a[72:75], v[112:115]
    v_mfma_f32_16x16x32_bf16 v[116:119], a[36:39], a[76:79], v[116:119]
    ds_read_b128 a[100:103], v3 offset:29696
    v_mfma_f32_16x16x32_bf16 v[120:123], a[36:39], a[80:83], v[120:123]
    v_mfma_f32_16x16x32_bf16 v[124:127], a[36:39], a[84:87], v[124:127]
    buffer_load_dwordx4 a[36:39], v49, s[12:15], s28 offen offset:1024
    v_mfma_f32_16x16x32_bf16 v[128:131], a[40:43], a[72:75], v[128:131]
    v_mfma_f32_16x16x32_bf16 v[132:135], a[40:43], a[76:79], v[132:135]
    v_mfma_f32_16x16x32_bf16 v[136:139], a[40:43], a[80:83], v[136:139]
    v_mfma_f32_16x16x32_bf16 v[140:143], a[40:43], a[84:87], v[140:143]
    buffer_load_dwordx4 a[40:43], v50, s[12:15], s28 offen offset:1024
    v_mfma_f32_16x16x32_bf16 v[144:147], a[44:47], a[72:75], v[144:147]
    v_mfma_f32_16x16x32_bf16 v[148:151], a[44:47], a[76:79], v[148:151]
    v_mfma_f32_16x16x32_bf16 v[152:155], a[44:47], a[80:83], v[152:155]
    v_mfma_f32_16x16x32_bf16 v[156:159], a[44:47], a[84:87], v[156:159]
    buffer_load_dwordx4 a[44:47], v51, s[12:15], s28 offen offset:1024
    s_waitcnt vmcnt(14) lgkmcnt(0)
    s_barrier
    s_add_u32 m0, s36, 17408
    s_add_u32 s37, s35, 17408
    buffer_load_dwordx4 v1, s[12:15], s37 offen lds
    v_mfma_f32_16x16x32_bf16 v[64:67], a[48:51], a[88:91], v[64:67]
    v_mfma_f32_16x16x32_bf16 v[68:71], a[48:51], a[92:95], v[68:71]
    ds_read_b128 a[72:75], v2 offset:12288
    v_add_u32 v9, 36864, v6
    v_mfma_f32_16x16x32_bf16 v[72:75], a[48:51], a[96:99], v[72:75]
    v_add_u32 v0, 36864, v7
    v_mfma_f32_16x16x32_bf16 v[76:79], a[48:51], a[100:103], v[76:79]
    buffer_load_dwordx4 a[48:51], v46, s[12:15], s28 offen offset:2048
    v_pk_add_f32 v[160:161], v[160:161], v[162:163]
    v_mfma_f32_16x16x32_bf16 v[80:83], a[52:55], a[88:91], v[80:83]
    v_pk_add_f32 v[160:161], v[160:161], v[164:165]
    v_mfma_f32_16x16x32_bf16 v[84:87], a[52:55], a[92:95], v[84:87]
    ds_read_b128 a[76:79], v2 offset:30720
    v_pk_add_f32 v[160:161], v[160:161], v[166:167]
    v_mfma_f32_16x16x32_bf16 v[88:91], a[52:55], a[96:99], v[88:91]
    v_pk_add_f32 v[160:161], v[160:161], v[168:169]
    v_mfma_f32_16x16x32_bf16 v[92:95], a[52:55], a[100:103], v[92:95]
    buffer_load_dwordx4 a[52:55], v47, s[12:15], s28 offen offset:2048
    v_mov_b32 v61, v160
    v_mfma_f32_16x16x32_bf16 v[96:99], a[56:59], a[88:91], v[96:99]
    v_mov_b32 v62, v161
    v_mfma_f32_16x16x32_bf16 v[100:103], a[56:59], a[92:95], v[100:103]
    ds_read_b128 a[80:83], v3 offset:12288
    s_nop 1
    v_mfma_f32_16x16x32_bf16 v[104:107], a[56:59], a[96:99], v[104:107]
    v_permlane16_swap_b32 v160, v61
    v_mfma_f32_16x16x32_bf16 v[108:111], a[56:59], a[100:103], v[108:111]
    buffer_load_dwordx4 a[56:59], v48, s[12:15], s28 offen offset:2048
    v_mfma_f32_16x16x32_bf16 v[112:115], a[60:63], a[88:91], v[112:115]
    v_permlane16_swap_b32 v161, v62
    v_mfma_f32_16x16x32_bf16 v[116:119], a[60:63], a[92:95], v[116:119]
    ds_read_b128 a[84:87], v3 offset:30720
    s_nop 1
    v_mfma_f32_16x16x32_bf16 v[120:123], a[60:63], a[96:99], v[120:123]
    v_add_f32 v160, v160, v61
    v_mfma_f32_16x16x32_bf16 v[124:127], a[60:63], a[100:103], v[124:127]
    buffer_load_dwordx4 a[60:63], v49, s[12:15], s28 offen offset:2048
    v_add_f32 v161, v161, v62
    v_mfma_f32_16x16x32_bf16 v[128:131], a[64:67], a[88:91], v[128:131]
    v_mov_b32 v61, v160
    v_mfma_f32_16x16x32_bf16 v[132:135], a[64:67], a[92:95], v[132:135]
    v_mov_b32 v62, v161
    v_mfma_f32_16x16x32_bf16 v[136:139], a[64:67], a[96:99], v[136:139]
    s_nop 1
    v_mfma_f32_16x16x32_bf16 v[140:143], a[64:67], a[100:103], v[140:143]
    buffer_load_dwordx4 a[64:67], v50, s[12:15], s28 offen offset:2048
    v_permlane32_swap_b32 v160, v61
    v_mfma_f32_16x16x32_bf16 v[144:147], a[68:71], a[88:91], v[144:147]
    v_permlane32_swap_b32 v161, v62
    v_mfma_f32_16x16x32_bf16 v[148:151], a[68:71], a[92:95], v[148:151]
    s_nop 1
    v_mfma_f32_16x16x32_bf16 v[152:155], a[68:71], a[96:99], v[152:155]
    v_mfma_f32_16x16x32_bf16 v[156:159], a[68:71], a[100:103], v[156:159]
    buffer_load_dwordx4 a[68:71], v51, s[12:15], s28 offen offset:2048
    v_add_f32 v160, v160, v61
    s_waitcnt vmcnt(14) lgkmcnt(0)
    v_mfma_f32_16x16x32_bf16 v[64:67], a[0:3], a[72:75], v[64:67]
    v_add_f32 v161, v161, v62
    v_mfma_f32_16x16x32_bf16 v[68:71], a[0:3], a[76:79], v[68:71]
    ds_read_b128 a[88:91], v2 offset:13312
    v_mul_f32 v10, 0xbae38e39, v160
    v_mfma_f32_16x16x32_bf16 v[72:75], a[0:3], a[80:83], v[72:75]
    v_mul_f32 v61, v10, v10
    v_mfma_f32_16x16x32_bf16 v[76:79], a[0:3], a[84:87], v[76:79]
    buffer_load_dwordx4 a[0:3], v46, s[12:15], s28 offen offset:3072
    v_mul_f32 v62, 0x3ae38e39, v161
    v_mfma_f32_16x16x32_bf16 v[80:83], a[4:7], a[72:75], v[80:83]
    v_sub_f32 v62, v62, v61
    v_mfma_f32_16x16x32_bf16 v[84:87], a[4:7], a[76:79], v[84:87]
    ds_read_b128 a[92:95], v2 offset:31744
    v_max_f32 v62, 0, v62
    v_mfma_f32_16x16x32_bf16 v[88:91], a[4:7], a[80:83], v[88:91]
    v_add_f32 v22, 0x3727c5ac, v62
    v_mfma_f32_16x16x32_bf16 v[92:95], a[4:7], a[84:87], v[92:95]
    buffer_load_dwordx4 a[4:7], v47, s[12:15], s28 offen offset:3072
    v_rsq_f32 v61, v22
    v_mfma_f32_16x16x32_bf16 v[96:99], a[8:11], a[72:75], v[96:99]
    s_nop 0
    v_mfma_f32_16x16x32_bf16 v[100:103], a[8:11], a[76:79], v[100:103]
    ds_read_b128 a[96:99], v3 offset:13312
    v_mfma_f32_16x16x32_bf16 v[104:107], a[8:11], a[80:83], v[104:107]
    v_mul_f32 v18, 0xc0135761, v61
    v_mfma_f32_16x16x32_bf16 v[108:111], a[8:11], a[84:87], v[108:111]
    buffer_load_dwordx4 a[8:11], v48, s[12:15], s28 offen offset:3072
    v_mul_f32 v62, v61, v61
    v_mfma_f32_16x16x32_bf16 v[112:115], a[12:15], a[72:75], v[112:115]
    v_mul_f32 v14, 0xbdd2d3e8, v61
    v_mfma_f32_16x16x32_bf16 v[116:119], a[12:15], a[76:79], v[116:119]
    ds_read_b128 a[100:103], v3 offset:31744
    v_mul_f32 v14, v14, v62
    v_mfma_f32_16x16x32_bf16 v[120:123], a[12:15], a[80:83], v[120:123]
    v_pk_add_f32 v[170:171], v[170:171], v[172:173]
    v_mfma_f32_16x16x32_bf16 v[124:127], a[12:15], a[84:87], v[124:127]
    buffer_load_dwordx4 a[12:15], v49, s[12:15], s28 offen offset:3072
    v_pk_add_f32 v[170:171], v[170:171], v[174:175]
    v_mfma_f32_16x16x32_bf16 v[128:131], a[16:19], a[72:75], v[128:131]
    v_pk_add_f32 v[170:171], v[170:171], v[176:177]
    v_mfma_f32_16x16x32_bf16 v[132:135], a[16:19], a[76:79], v[132:135]
    v_pk_add_f32 v[170:171], v[170:171], v[178:179]
    v_mfma_f32_16x16x32_bf16 v[136:139], a[16:19], a[80:83], v[136:139]
    v_mov_b32 v61, v170
    v_mfma_f32_16x16x32_bf16 v[140:143], a[16:19], a[84:87], v[140:143]
    buffer_load_dwordx4 a[16:19], v50, s[12:15], s28 offen offset:3072
    v_mov_b32 v62, v171
    v_mfma_f32_16x16x32_bf16 v[144:147], a[20:23], a[72:75], v[144:147]
    v_mfma_f32_16x16x32_bf16 v[148:151], a[20:23], a[76:79], v[148:151]
    s_nop 1
    v_mfma_f32_16x16x32_bf16 v[152:155], a[20:23], a[80:83], v[152:155]
    v_permlane16_swap_b32 v170, v61
    v_mfma_f32_16x16x32_bf16 v[156:159], a[20:23], a[84:87], v[156:159]
    buffer_load_dwordx4 a[20:23], v51, s[12:15], s28 offen offset:3072
    v_permlane16_swap_b32 v171, v62
    s_waitcnt vmcnt(13) lgkmcnt(0)
    v_mfma_f32_16x16x32_bf16 v[64:67], a[24:27], a[88:91], v[64:67]
    s_nop 1
    v_mfma_f32_16x16x32_bf16 v[68:71], a[24:27], a[92:95], v[68:71]
    ds_read_b128 a[72:75], v2 offset:14336
    v_add_f32 v170, v170, v61
    v_mfma_f32_16x16x32_bf16 v[72:75], a[24:27], a[96:99], v[72:75]
    v_add_f32 v171, v171, v62
    v_mfma_f32_16x16x32_bf16 v[76:79], a[24:27], a[100:103], v[76:79]
    s_add_u32 s28, s28, 4096
    buffer_load_dwordx4 a[24:27], v46, s[12:15], s28 offen offset:0
    v_mov_b32 v61, v170
    v_mfma_f32_16x16x32_bf16 v[80:83], a[28:31], a[88:91], v[80:83]
    v_mov_b32 v62, v171
    v_mfma_f32_16x16x32_bf16 v[84:87], a[28:31], a[92:95], v[84:87]
    ds_read_b128 a[76:79], v2 offset:32768
    s_nop 1
    v_mfma_f32_16x16x32_bf16 v[88:91], a[28:31], a[96:99], v[88:91]
    v_permlane32_swap_b32 v170, v61
    v_mfma_f32_16x16x32_bf16 v[92:95], a[28:31], a[100:103], v[92:95]
    buffer_load_dwordx4 a[28:31], v47, s[12:15], s28 offen offset:0
    v_mfma_f32_16x16x32_bf16 v[96:99], a[32:35], a[88:91], v[96:99]
    v_permlane32_swap_b32 v171, v62
    v_mfma_f32_16x16x32_bf16 v[100:103], a[32:35], a[92:95], v[100:103]
    ds_read_b128 a[80:83], v3 offset:14336
    s_nop 1
    v_mfma_f32_16x16x32_bf16 v[104:107], a[32:35], a[96:99], v[104:107]
    v_add_f32 v170, v170, v61
    v_mfma_f32_16x16x32_bf16 v[108:111], a[32:35], a[100:103], v[108:111]
    buffer_load_dwordx4 a[32:35], v48, s[12:15], s28 offen offset:0
    v_add_f32 v171, v171, v62
    v_mfma_f32_16x16x32_bf16 v[112:115], a[36:39], a[88:91], v[112:115]
    v_mul_f32 v11, 0xbae38e39, v170
    v_mfma_f32_16x16x32_bf16 v[116:119], a[36:39], a[92:95], v[116:119]
    ds_read_b128 a[84:87], v3 offset:32768
    v_mul_f32 v61, v11, v11
    v_mfma_f32_16x16x32_bf16 v[120:123], a[36:39], a[96:99], v[120:123]
    v_mul_f32 v62, 0x3ae38e39, v171
    v_mfma_f32_16x16x32_bf16 v[124:127], a[36:39], a[100:103], v[124:127]
    buffer_load_dwordx4 a[36:39], v49, s[12:15], s28 offen offset:0
    v_sub_f32 v62, v62, v61
    v_mfma_f32_16x16x32_bf16 v[128:131], a[40:43], a[88:91], v[128:131]
    v_max_f32 v62, 0, v62
    v_mfma_f32_16x16x32_bf16 v[132:135], a[40:43], a[92:95], v[132:135]
    v_add_f32 v23, 0x3727c5ac, v62
    v_mfma_f32_16x16x32_bf16 v[136:139], a[40:43], a[96:99], v[136:139]
    v_mfma_f32_16x16x32_bf16 v[140:143], a[40:43], a[100:103], v[140:143]
    buffer_load_dwordx4 a[40:43], v50, s[12:15], s28 offen offset:0
    v_rsq_f32 v61, v23
    v_mfma_f32_16x16x32_bf16 v[144:147], a[44:47], a[88:91], v[144:147]
    s_nop 0
    v_mfma_f32_16x16x32_bf16 v[148:151], a[44:47], a[92:95], v[148:151]
    v_mul_f32 v19, 0xc0135761, v61
    v_mfma_f32_16x16x32_bf16 v[152:155], a[44:47], a[96:99], v[152:155]
    v_mul_f32 v62, v61, v61
    v_mfma_f32_16x16x32_bf16 v[156:159], a[44:47], a[100:103], v[156:159]
    buffer_load_dwordx4 a[44:47], v51, s[12:15], s28 offen offset:0
    v_mul_f32 v15, 0xbdd2d3e8, v61
    s_waitcnt vmcnt(12) lgkmcnt(0)
    s_barrier
    v_mfma_f32_16x16x32_bf16 v[64:67], a[48:51], a[72:75], v[64:67]
    v_mul_f32 v15, v15, v62
    v_mfma_f32_16x16x32_bf16 v[68:71], a[48:51], a[76:79], v[68:71]
    ds_read_b128 a[88:91], v2 offset:15360
    v_pk_add_f32 v[180:181], v[180:181], v[182:183]
    v_mfma_f32_16x16x32_bf16 v[72:75], a[48:51], a[80:83], v[72:75]
    v_pk_add_f32 v[180:181], v[180:181], v[184:185]
    v_mfma_f32_16x16x32_bf16 v[76:79], a[48:51], a[84:87], v[76:79]
    buffer_load_dwordx4 a[48:51], v46, s[12:15], s28 offen offset:1024
    v_pk_add_f32 v[180:181], v[180:181], v[186:187]
    v_mfma_f32_16x16x32_bf16 v[80:83], a[52:55], a[72:75], v[80:83]
    v_pk_add_f32 v[180:181], v[180:181], v[188:189]
    v_mfma_f32_16x16x32_bf16 v[84:87], a[52:55], a[76:79], v[84:87]
    ds_read_b128 a[92:95], v2 offset:33792
    v_mfma_f32_16x16x32_bf16 v[88:91], a[52:55], a[80:83], v[88:91]
    v_mov_b32 v61, v180
    v_mfma_f32_16x16x32_bf16 v[92:95], a[52:55], a[84:87], v[92:95]
    buffer_load_dwordx4 a[52:55], v47, s[12:15], s28 offen offset:1024
    v_mov_b32 v62, v181
    v_mfma_f32_16x16x32_bf16 v[96:99], a[56:59], a[72:75], v[96:99]
    s_nop 1
    v_mfma_f32_16x16x32_bf16 v[100:103], a[56:59], a[76:79], v[100:103]
    ds_read_b128 a[96:99], v3 offset:15360
    v_permlane16_swap_b32 v180, v61
    v_mfma_f32_16x16x32_bf16 v[104:107], a[56:59], a[80:83], v[104:107]
    v_permlane16_swap_b32 v181, v62
    v_mfma_f32_16x16x32_bf16 v[108:111], a[56:59], a[84:87], v[108:111]
    buffer_load_dwordx4 a[56:59], v48, s[12:15], s28 offen offset:1024
    s_nop 1
    v_mfma_f32_16x16x32_bf16 v[112:115], a[60:63], a[72:75], v[112:115]
    v_add_f32 v180, v180, v61
    v_mfma_f32_16x16x32_bf16 v[116:119], a[60:63], a[76:79], v[116:119]
    ds_read_b128 a[100:103], v3 offset:33792
    v_add_f32 v181, v181, v62
    v_mfma_f32_16x16x32_bf16 v[120:123], a[60:63], a[80:83], v[120:123]
    v_mov_b32 v61, v180
    v_mfma_f32_16x16x32_bf16 v[124:127], a[60:63], a[84:87], v[124:127]
    buffer_load_dwordx4 a[60:63], v49, s[12:15], s28 offen offset:1024
    v_mov_b32 v62, v181
    v_mfma_f32_16x16x32_bf16 v[128:131], a[64:67], a[72:75], v[128:131]
    v_mfma_f32_16x16x32_bf16 v[132:135], a[64:67], a[76:79], v[132:135]
    s_nop 1
    v_mfma_f32_16x16x32_bf16 v[136:139], a[64:67], a[80:83], v[136:139]
    v_permlane32_swap_b32 v180, v61
    v_mfma_f32_16x16x32_bf16 v[140:143], a[64:67], a[84:87], v[140:143]
    buffer_load_dwordx4 a[64:67], v50, s[12:15], s28 offen offset:1024
    v_permlane32_swap_b32 v181, v62
    v_mfma_f32_16x16x32_bf16 v[144:147], a[68:71], a[72:75], v[144:147]
    s_nop 1
    v_mfma_f32_16x16x32_bf16 v[148:151], a[68:71], a[76:79], v[148:151]
    v_add_f32 v180, v180, v61
    v_mfma_f32_16x16x32_bf16 v[152:155], a[68:71], a[80:83], v[152:155]
    v_add_f32 v181, v181, v62
    v_mfma_f32_16x16x32_bf16 v[156:159], a[68:71], a[84:87], v[156:159]
    buffer_load_dwordx4 a[68:71], v51, s[12:15], s28 offen offset:1024
    v_mul_f32 v12, 0xbae38e39, v180
    s_waitcnt vmcnt(12) lgkmcnt(0)
    v_mfma_f32_16x16x32_bf16 v[64:67], a[0:3], a[88:91], v[64:67]
    v_mul_f32 v61, v12, v12
    v_mfma_f32_16x16x32_bf16 v[68:71], a[0:3], a[92:95], v[68:71]
    ds_read_b128 a[72:75], v2 offset:16384
    v_mul_f32 v62, 0x3ae38e39, v181
    v_mfma_f32_16x16x32_bf16 v[72:75], a[0:3], a[96:99], v[72:75]
    v_sub_f32 v62, v62, v61
    v_mfma_f32_16x16x32_bf16 v[76:79], a[0:3], a[100:103], v[76:79]
    s_add_u32 s28, s28, 425984
    buffer_load_dwordx4 a[0:3], v46, s[12:15], s28 offen offset:0
    v_mfma_f32_16x16x32_bf16 v[80:83], a[4:7], a[88:91], v[80:83]
    v_max_f32 v62, 0, v62
    v_mfma_f32_16x16x32_bf16 v[84:87], a[4:7], a[92:95], v[84:87]
    ds_read_b128 a[76:79], v2 offset:34816
    v_add_f32 v24, 0x3727c5ac, v62
    v_mfma_f32_16x16x32_bf16 v[88:91], a[4:7], a[96:99], v[88:91]
    v_rsq_f32 v61, v24
    v_mfma_f32_16x16x32_bf16 v[92:95], a[4:7], a[100:103], v[92:95]
    buffer_load_dwordx4 a[4:7], v47, s[12:15], s28 offen offset:0
    s_nop 0
    v_mfma_f32_16x16x32_bf16 v[96:99], a[8:11], a[88:91], v[96:99]
    v_mul_f32 v20, 0xc0135761, v61
    v_mfma_f32_16x16x32_bf16 v[100:103], a[8:11], a[92:95], v[100:103]
    ds_read_b128 a[80:83], v3 offset:16384
    v_mul_f32 v62, v61, v61
    v_mfma_f32_16x16x32_bf16 v[104:107], a[8:11], a[96:99], v[104:107]
    v_mul_f32 v16, 0xbdd2d3e8, v61
    v_mfma_f32_16x16x32_bf16 v[108:111], a[8:11], a[100:103], v[108:111]
    buffer_load_dwordx4 a[8:11], v48, s[12:15], s28 offen offset:0
    v_mul_f32 v16, v16, v62
    v_mfma_f32_16x16x32_bf16 v[112:115], a[12:15], a[88:91], v[112:115]
    v_pk_add_f32 v[190:191], v[190:191], v[192:193]
    v_mfma_f32_16x16x32_bf16 v[116:119], a[12:15], a[92:95], v[116:119]
    ds_read_b128 a[84:87], v3 offset:34816
    v_pk_add_f32 v[190:191], v[190:191], v[194:195]
    v_mfma_f32_16x16x32_bf16 v[120:123], a[12:15], a[96:99], v[120:123]
    v_mfma_f32_16x16x32_bf16 v[124:127], a[12:15], a[100:103], v[124:127]
    buffer_load_dwordx4 a[12:15], v49, s[12:15], s28 offen offset:0
    v_pk_add_f32 v[190:191], v[190:191], v[196:197]
    v_mfma_f32_16x16x32_bf16 v[128:131], a[16:19], a[88:91], v[128:131]
    v_pk_add_f32 v[190:191], v[190:191], v[198:199]
    v_mfma_f32_16x16x32_bf16 v[132:135], a[16:19], a[92:95], v[132:135]
    v_mov_b32 v61, v190
    v_mfma_f32_16x16x32_bf16 v[136:139], a[16:19], a[96:99], v[136:139]
    v_mov_b32 v62, v191
    v_mfma_f32_16x16x32_bf16 v[140:143], a[16:19], a[100:103], v[140:143]
    buffer_load_dwordx4 a[16:19], v50, s[12:15], s28 offen offset:0
    s_nop 1
    v_mfma_f32_16x16x32_bf16 v[144:147], a[20:23], a[88:91], v[144:147]
    v_permlane16_swap_b32 v190, v61
    v_mfma_f32_16x16x32_bf16 v[148:151], a[20:23], a[92:95], v[148:151]
    v_permlane16_swap_b32 v191, v62
    v_mfma_f32_16x16x32_bf16 v[152:155], a[20:23], a[96:99], v[152:155]
    s_nop 1
    v_mfma_f32_16x16x32_bf16 v[156:159], a[20:23], a[100:103], v[156:159]
    buffer_load_dwordx4 a[20:23], v51, s[12:15], s28 offen offset:0
    v_add_f32 v190, v190, v61
    s_waitcnt vmcnt(12) lgkmcnt(0)
    v_mfma_f32_16x16x32_bf16 v[64:67], a[24:27], a[72:75], v[64:67]
    v_add_f32 v191, v191, v62
    v_mfma_f32_16x16x32_bf16 v[68:71], a[24:27], a[76:79], v[68:71]
    ds_read_b128 a[88:91], v2 offset:17408
    v_mfma_f32_16x16x32_bf16 v[72:75], a[24:27], a[80:83], v[72:75]
    v_mov_b32 v61, v190
    v_mfma_f32_16x16x32_bf16 v[76:79], a[24:27], a[84:87], v[76:79]
    buffer_load_dwordx4 a[24:27], v46, s[12:15], s28 offen offset:1024
    v_mov_b32 v62, v191
    v_mfma_f32_16x16x32_bf16 v[80:83], a[28:31], a[72:75], v[80:83]
    s_nop 1
    v_mfma_f32_16x16x32_bf16 v[84:87], a[28:31], a[76:79], v[84:87]
    ds_read_b128 a[92:95], v2 offset:35840
    v_permlane32_swap_b32 v190, v61
    v_mfma_f32_16x16x32_bf16 v[88:91], a[28:31], a[80:83], v[88:91]
    v_permlane32_swap_b32 v191, v62
    v_mfma_f32_16x16x32_bf16 v[92:95], a[28:31], a[84:87], v[92:95]
    buffer_load_dwordx4 a[28:31], v47, s[12:15], s28 offen offset:1024
    s_nop 1
    v_mfma_f32_16x16x32_bf16 v[96:99], a[32:35], a[72:75], v[96:99]
    v_add_f32 v190, v190, v61
    v_mfma_f32_16x16x32_bf16 v[100:103], a[32:35], a[76:79], v[100:103]
    ds_read_b128 a[96:99], v3 offset:17408
    v_add_f32 v191, v191, v62
    v_mfma_f32_16x16x32_bf16 v[104:107], a[32:35], a[80:83], v[104:107]
    v_mul_f32 v13, 0xbae38e39, v190
    v_mfma_f32_16x16x32_bf16 v[108:111], a[32:35], a[84:87], v[108:111]
    buffer_load_dwordx4 a[32:35], v48, s[12:15], s28 offen offset:1024
    v_mul_f32 v61, v13, v13
    v_mfma_f32_16x16x32_bf16 v[112:115], a[36:39], a[72:75], v[112:115]
    v_mfma_f32_16x16x32_bf16 v[116:119], a[36:39], a[76:79], v[116:119]
    ds_read_b128 a[100:103], v3 offset:35840
    v_mul_f32 v62, 0x3ae38e39, v191
    v_mfma_f32_16x16x32_bf16 v[120:123], a[36:39], a[80:83], v[120:123]
    v_sub_f32 v62, v62, v61
    v_mfma_f32_16x16x32_bf16 v[124:127], a[36:39], a[84:87], v[124:127]
    buffer_load_dwordx4 a[36:39], v49, s[12:15], s28 offen offset:1024
    v_max_f32 v62, 0, v62
    v_mfma_f32_16x16x32_bf16 v[128:131], a[40:43], a[72:75], v[128:131]
    v_add_f32 v25, 0x3727c5ac, v62
    v_mfma_f32_16x16x32_bf16 v[132:135], a[40:43], a[76:79], v[132:135]
    v_rsq_f32 v61, v25
    v_mfma_f32_16x16x32_bf16 v[136:139], a[40:43], a[80:83], v[136:139]
    s_nop 0
    v_mfma_f32_16x16x32_bf16 v[140:143], a[40:43], a[84:87], v[140:143]
    buffer_load_dwordx4 a[40:43], v50, s[12:15], s28 offen offset:1024
    v_mul_f32 v21, 0xc0135761, v61
    v_mfma_f32_16x16x32_bf16 v[144:147], a[44:47], a[72:75], v[144:147]
    v_mul_f32 v62, v61, v61
    v_mfma_f32_16x16x32_bf16 v[148:151], a[44:47], a[76:79], v[148:151]
    v_mul_f32 v17, 0xbdd2d3e8, v61
    v_mfma_f32_16x16x32_bf16 v[152:155], a[44:47], a[80:83], v[152:155]
    v_mul_f32 v17, v17, v62
    v_mfma_f32_16x16x32_bf16 v[156:159], a[44:47], a[84:87], v[156:159]
    buffer_load_dwordx4 a[44:47], v51, s[12:15], s28 offen offset:1024
    s_waitcnt vmcnt(12) lgkmcnt(0)
    v_mfma_f32_16x16x32_bf16 v[64:67], a[48:51], a[88:91], v[64:67]
    v_mfma_f32_16x16x32_bf16 v[68:71], a[48:51], a[92:95], v[68:71]
    ds_read_b128 a[72:75], v2 offset:0
    v_mfma_f32_16x16x32_bf16 v[72:75], a[48:51], a[96:99], v[72:75]
    v_mfma_f32_16x16x32_bf16 v[76:79], a[48:51], a[100:103], v[76:79]
    buffer_load_dwordx4 a[48:51], v46, s[12:15], s28 offen offset:2048
    v_mfma_f32_16x16x32_bf16 v[80:83], a[52:55], a[88:91], v[80:83]
    v_mfma_f32_16x16x32_bf16 v[84:87], a[52:55], a[92:95], v[84:87]
    ds_read_b128 a[76:79], v2 offset:18432
    v_mfma_f32_16x16x32_bf16 v[88:91], a[52:55], a[96:99], v[88:91]
    v_mfma_f32_16x16x32_bf16 v[92:95], a[52:55], a[100:103], v[92:95]
    buffer_load_dwordx4 a[52:55], v47, s[12:15], s28 offen offset:2048
    v_mfma_f32_16x16x32_bf16 v[96:99], a[56:59], a[88:91], v[96:99]
    v_mfma_f32_16x16x32_bf16 v[100:103], a[56:59], a[92:95], v[100:103]
    ds_read_b128 a[80:83], v3 offset:0
    v_mfma_f32_16x16x32_bf16 v[104:107], a[56:59], a[96:99], v[104:107]
    v_mfma_f32_16x16x32_bf16 v[108:111], a[56:59], a[100:103], v[108:111]
    buffer_load_dwordx4 a[56:59], v48, s[12:15], s28 offen offset:2048
    v_mfma_f32_16x16x32_bf16 v[112:115], a[60:63], a[88:91], v[112:115]
    v_mfma_f32_16x16x32_bf16 v[116:119], a[60:63], a[92:95], v[116:119]
    ds_read_b128 a[84:87], v3 offset:18432
    v_mfma_f32_16x16x32_bf16 v[120:123], a[60:63], a[96:99], v[120:123]
    v_mfma_f32_16x16x32_bf16 v[124:127], a[60:63], a[100:103], v[124:127]
    buffer_load_dwordx4 a[60:63], v49, s[12:15], s28 offen offset:2048
    v_mfma_f32_16x16x32_bf16 v[128:131], a[64:67], a[88:91], v[128:131]
    v_mfma_f32_16x16x32_bf16 v[132:135], a[64:67], a[92:95], v[132:135]
    v_mfma_f32_16x16x32_bf16 v[136:139], a[64:67], a[96:99], v[136:139]
    v_mfma_f32_16x16x32_bf16 v[140:143], a[64:67], a[100:103], v[140:143]
    buffer_load_dwordx4 a[64:67], v50, s[12:15], s28 offen offset:2048
    v_mfma_f32_16x16x32_bf16 v[144:147], a[68:71], a[88:91], v[144:147]
    v_mfma_f32_16x16x32_bf16 v[148:151], a[68:71], a[92:95], v[148:151]
    v_mfma_f32_16x16x32_bf16 v[152:155], a[68:71], a[96:99], v[152:155]
    v_mfma_f32_16x16x32_bf16 v[156:159], a[68:71], a[100:103], v[156:159]
    buffer_load_dwordx4 a[68:71], v51, s[12:15], s28 offen offset:2048
    s_waitcnt vmcnt(12) lgkmcnt(0)
    v_mfma_f32_16x16x32_bf16 v[160:163], a[0:3], a[72:75], 0
    ds_read_b128 v[26:29], v8 offset:0
    ds_read_b128 v[30:33], v8 offset:16
    v_mfma_f32_16x16x32_bf16 v[164:167], a[0:3], a[76:79], 0
    ds_read_b128 a[88:91], v2 offset:1024
    s_waitcnt lgkmcnt(1)
    v_mfma_f32_16x16x32_bf16 v[168:171], a[0:3], a[80:83], 0
    v_fmac_f32 v64, v26, v10
    v_mfma_f32_16x16x32_bf16 v[172:175], a[0:3], a[84:87], 0
    buffer_load_dwordx4 a[0:3], v46, s[12:15], s28 offen offset:3072
    v_fmac_f32 v65, v27, v10
    v_fmac_f32 v66, v28, v10
    v_mfma_f32_16x16x32_bf16 v[176:179], a[4:7], a[72:75], 0
    v_fmac_f32 v67, v29, v10
    v_mfma_f32_16x16x32_bf16 v[180:183], a[4:7], a[76:79], 0
    ds_read_b128 a[92:95], v2 offset:19456
    v_fmac_f32 v68, v26, v11
    v_mfma_f32_16x16x32_bf16 v[184:187], a[4:7], a[80:83], 0
    v_fmac_f32 v69, v27, v11
    v_fmac_f32 v70, v28, v11
    v_mfma_f32_16x16x32_bf16 v[188:191], a[4:7], a[84:87], 0
    buffer_load_dwordx4 a[4:7], v47, s[12:15], s28 offen offset:3072
    v_fmac_f32 v71, v29, v11
    v_mfma_f32_16x16x32_bf16 v[192:195], a[8:11], a[72:75], 0
    v_mul_f32 v34, v64, v64
    v_mfma_f32_16x16x32_bf16 v[196:199], a[8:11], a[76:79], 0
    ds_read_b128 a[96:99], v3 offset:1024
    v_mul_f32 v35, v65, v65
    v_mfma_f32_16x16x32_bf16 v[200:203], a[8:11], a[80:83], 0
    v_mul_f32 v36, v66, v66
    v_mul_f32 v37, v67, v67
    v_mfma_f32_16x16x32_bf16 v[204:207], a[8:11], a[84:87], 0
    buffer_load_dwordx4 a[8:11], v48, s[12:15], s28 offen offset:3072
    v_mul_f32 v38, v68, v68
    v_mfma_f32_16x16x32_bf16 v[208:211], a[12:15], a[72:75], 0
    v_mul_f32 v39, v69, v69
    v_mfma_f32_16x16x32_bf16 v[212:215], a[12:15], a[76:79], 0
    ds_read_b128 a[100:103], v3 offset:19456
    v_mul_f32 v40, v70, v70
    v_mul_f32 v41, v71, v71
    v_mfma_f32_16x16x32_bf16 v[216:219], a[12:15], a[80:83], 0
    v_fma_f32 v34, v34, v14, v18
    v_mfma_f32_16x16x32_bf16 v[220:223], a[12:15], a[84:87], 0
    buffer_load_dwordx4 a[12:15], v49, s[12:15], s28 offen offset:3072
    v_fma_f32 v35, v35, v14, v18
    v_mfma_f32_16x16x32_bf16 v[224:227], a[16:19], a[72:75], 0
    v_fma_f32 v36, v36, v14, v18
    v_mfma_f32_16x16x32_bf16 v[228:231], a[16:19], a[76:79], 0
    v_fma_f32 v37, v37, v14, v18
    v_fma_f32 v38, v38, v15, v19
    v_mfma_f32_16x16x32_bf16 v[232:235], a[16:19], a[80:83], 0
    v_fma_f32 v39, v39, v15, v19
    v_mfma_f32_16x16x32_bf16 v[236:239], a[16:19], a[84:87], 0
    buffer_load_dwordx4 a[16:19], v50, s[12:15], s28 offen offset:3072
    v_fma_f32 v40, v40, v15, v19
    v_mfma_f32_16x16x32_bf16 v[240:243], a[20:23], a[72:75], 0
    v_fma_f32 v41, v41, v15, v19
    v_mul_f32 v34, v64, v34
    v_mfma_f32_16x16x32_bf16 v[244:247], a[20:23], a[76:79], 0
    v_mul_f32 v35, v65, v35
    v_mfma_f32_16x16x32_bf16 v[248:251], a[20:23], a[80:83], 0
    v_mul_f32 v36, v66, v36
    v_mfma_f32_16x16x32_bf16 v[252:255], a[20:23], a[84:87], 0
    buffer_load_dwordx4 a[20:23], v51, s[12:15], s28 offen offset:3072
    v_mul_f32 v37, v67, v37
    s_waitcnt vmcnt(12) lgkmcnt(0)
    v_mfma_f32_16x16x32_bf16 v[160:163], a[24:27], a[88:91], v[160:163]
    v_mul_f32 v38, v68, v38
    v_mul_f32 v39, v69, v39
    v_mfma_f32_16x16x32_bf16 v[164:167], a[24:27], a[92:95], v[164:167]
    ds_read_b128 a[72:75], v2 offset:2048
    v_mul_f32 v40, v70, v40
    v_mfma_f32_16x16x32_bf16 v[168:171], a[24:27], a[96:99], v[168:171]
    v_mul_f32 v41, v71, v41
    v_mfma_f32_16x16x32_bf16 v[172:175], a[24:27], a[100:103], v[172:175]
    s_add_u32 s28, s28, 4096
    buffer_load_dwordx4 a[24:27], v46, s[12:15], s28 offen offset:0
    v_exp_f32 v34, v34
    v_exp_f32 v35, v35
    v_mfma_f32_16x16x32_bf16 v[176:179], a[28:31], a[88:91], v[176:179]
    v_exp_f32 v36, v36
    v_mfma_f32_16x16x32_bf16 v[180:183], a[28:31], a[92:95], v[180:183]
    ds_read_b128 a[76:79], v2 offset:20480
    v_exp_f32 v37, v37
    v_mfma_f32_16x16x32_bf16 v[184:187], a[28:31], a[96:99], v[184:187]
    v_exp_f32 v38, v38
    v_mfma_f32_16x16x32_bf16 v[188:191], a[28:31], a[100:103], v[188:191]
    buffer_load_dwordx4 a[28:31], v47, s[12:15], s28 offen offset:0
    v_exp_f32 v39, v39
    v_exp_f32 v40, v40
    v_mfma_f32_16x16x32_bf16 v[192:195], a[32:35], a[88:91], v[192:195]
    v_exp_f32 v41, v41
    v_mfma_f32_16x16x32_bf16 v[196:199], a[32:35], a[92:95], v[196:199]
    ds_read_b128 a[80:83], v3 offset:2048
    v_fmac_f32 v80, v30, v10
    v_mfma_f32_16x16x32_bf16 v[200:203], a[32:35], a[96:99], v[200:203]
    v_fmac_f32 v81, v31, v10
    v_fmac_f32 v82, v32, v10
    v_mfma_f32_16x16x32_bf16 v[204:207], a[32:35], a[100:103], v[204:207]
    buffer_load_dwordx4 a[32:35], v48, s[12:15], s28 offen offset:0
    v_fmac_f32 v83, v33, v10
    v_mfma_f32_16x16x32_bf16 v[208:211], a[36:39], a[88:91], v[208:211]
    v_fmac_f32 v84, v30, v11
    v_mfma_f32_16x16x32_bf16 v[212:215], a[36:39], a[92:95], v[212:215]
    ds_read_b128 a[84:87], v3 offset:20480
    v_fmac_f32 v85, v31, v11
    v_mfma_f32_16x16x32_bf16 v[216:219], a[36:39], a[96:99], v[216:219]
    v_fmac_f32 v86, v32, v11
    v_fmac_f32 v87, v33, v11
    v_mfma_f32_16x16x32_bf16 v[220:223], a[36:39], a[100:103], v[220:223]
    buffer_load_dwordx4 a[36:39], v49, s[12:15], s28 offen offset:0
    v_fma_f32 v34, v34, v22, v22
    v_mfma_f32_16x16x32_bf16 v[224:227], a[40:43], a[88:91], v[224:227]
    v_fma_f32 v35, v35, v22, v22
    v_mfma_f32_16x16x32_bf16 v[228:231], a[40:43], a[92:95], v[228:231]
    v_fma_f32 v36, v36, v22, v22
    v_fma_f32 v37, v37, v22, v22
    v_mfma_f32_16x16x32_bf16 v[232:235], a[40:43], a[96:99], v[232:235]
    v_fma_f32 v38, v38, v23, v23
    v_mfma_f32_16x16x32_bf16 v[236:239], a[40:43], a[100:103], v[236:239]
    buffer_load_dwordx4 a[40:43], v50, s[12:15], s28 offen offset:0
    v_fma_f32 v39, v39, v23, v23
    v_mfma_f32_16x16x32_bf16 v[240:243], a[44:47], a[88:91], v[240:243]
    v_fma_f32 v40, v40, v23, v23
    v_mfma_f32_16x16x32_bf16 v[244:247], a[44:47], a[92:95], v[244:247]
    v_fma_f32 v41, v41, v23, v23
    v_rcp_f32 v34, v34
    v_mfma_f32_16x16x32_bf16 v[248:251], a[44:47], a[96:99], v[248:251]
    v_rcp_f32 v35, v35
    v_mfma_f32_16x16x32_bf16 v[252:255], a[44:47], a[100:103], v[252:255]
    buffer_load_dwordx4 a[44:47], v51, s[12:15], s28 offen offset:0
    v_rcp_f32 v36, v36
    s_waitcnt vmcnt(12) lgkmcnt(0)
    v_mfma_f32_16x16x32_bf16 v[160:163], a[48:51], a[72:75], v[160:163]
    v_rcp_f32 v37, v37
    v_rcp_f32 v38, v38
    v_mfma_f32_16x16x32_bf16 v[164:167], a[48:51], a[76:79], v[164:167]
    ds_read_b128 a[88:91], v2 offset:3072
    v_rcp_f32 v39, v39
    v_mfma_f32_16x16x32_bf16 v[168:171], a[48:51], a[80:83], v[168:171]
    v_rcp_f32 v40, v40
    v_mfma_f32_16x16x32_bf16 v[172:175], a[48:51], a[84:87], v[172:175]
    buffer_load_dwordx4 a[48:51], v46, s[12:15], s28 offen offset:1024
    v_rcp_f32 v41, v41
    v_mfma_f32_16x16x32_bf16 v[176:179], a[52:55], a[72:75], v[176:179]
    v_mul_f32 v80, v64, v80
    v_mul_f32 v81, v65, v81
    v_mfma_f32_16x16x32_bf16 v[180:183], a[52:55], a[76:79], v[180:183]
    ds_read_b128 a[92:95], v2 offset:21504
    v_mul_f32 v82, v66, v82
    v_mfma_f32_16x16x32_bf16 v[184:187], a[52:55], a[80:83], v[184:187]
    v_mul_f32 v83, v67, v83
    v_mfma_f32_16x16x32_bf16 v[188:191], a[52:55], a[84:87], v[188:191]
    buffer_load_dwordx4 a[52:55], v47, s[12:15], s28 offen offset:1024
    v_mul_f32 v84, v68, v84
    v_mul_f32 v85, v69, v85
    v_mfma_f32_16x16x32_bf16 v[192:195], a[56:59], a[72:75], v[192:195]
    v_mul_f32 v86, v70, v86
    v_mfma_f32_16x16x32_bf16 v[196:199], a[56:59], a[76:79], v[196:199]
    ds_read_b128 a[96:99], v3 offset:3072
    v_mul_f32 v87, v71, v87
    v_mfma_f32_16x16x32_bf16 v[200:203], a[56:59], a[80:83], v[200:203]
    v_mul_f32 v34, v34, v80
    v_mfma_f32_16x16x32_bf16 v[204:207], a[56:59], a[84:87], v[204:207]
    buffer_load_dwordx4 a[56:59], v48, s[12:15], s28 offen offset:1024
    v_mul_f32 v35, v35, v81
    v_mul_f32 v36, v36, v82
    v_mfma_f32_16x16x32_bf16 v[208:211], a[60:63], a[72:75], v[208:211]
    v_mul_f32 v37, v37, v83
    v_mfma_f32_16x16x32_bf16 v[212:215], a[60:63], a[76:79], v[212:215]
    ds_read_b128 a[100:103], v3 offset:21504
    v_mul_f32 v38, v38, v84
    v_mfma_f32_16x16x32_bf16 v[216:219], a[60:63], a[80:83], v[216:219]
    v_mul_f32 v39, v39, v85
    v_mul_f32 v40, v40, v86
    v_mfma_f32_16x16x32_bf16 v[220:223], a[60:63], a[84:87], v[220:223]
    buffer_load_dwordx4 a[60:63], v49, s[12:15], s28 offen offset:1024
    v_mul_f32 v41, v41, v87
    v_mfma_f32_16x16x32_bf16 v[224:227], a[64:67], a[72:75], v[224:227]
    v_cvt_pk_bf16_f32 v42, v34, v35
    v_mfma_f32_16x16x32_bf16 v[228:231], a[64:67], a[76:79], v[228:231]
    v_cvt_pk_bf16_f32 v43, v36, v37
    v_mfma_f32_16x16x32_bf16 v[232:235], a[64:67], a[80:83], v[232:235]
    v_cvt_pk_bf16_f32 v44, v38, v39
    v_cvt_pk_bf16_f32 v45, v40, v41
    v_mfma_f32_16x16x32_bf16 v[236:239], a[64:67], a[84:87], v[236:239]
    buffer_load_dwordx4 a[64:67], v50, s[12:15], s28 offen offset:1024
    ds_write_b64 v6, v[42:43] offset:0
    v_mfma_f32_16x16x32_bf16 v[240:243], a[68:71], a[72:75], v[240:243]
    ds_write_b64 v6, v[44:45] offset:18432
    v_mfma_f32_16x16x32_bf16 v[244:247], a[68:71], a[76:79], v[244:247]
    v_fmac_f32 v72, v26, v12
    v_fmac_f32 v73, v27, v12
    v_mfma_f32_16x16x32_bf16 v[248:251], a[68:71], a[80:83], v[248:251]
    v_fmac_f32 v74, v28, v12
    v_mfma_f32_16x16x32_bf16 v[252:255], a[68:71], a[84:87], v[252:255]
    buffer_load_dwordx4 a[68:71], v51, s[12:15], s28 offen offset:1024
    v_fmac_f32 v75, v29, v12
    s_waitcnt vmcnt(12) lgkmcnt(2)
    v_mfma_f32_16x16x32_bf16 v[160:163], a[0:3], a[88:91], v[160:163]
    v_fmac_f32 v76, v26, v13
    v_mfma_f32_16x16x32_bf16 v[164:167], a[0:3], a[92:95], v[164:167]
    ds_read_b128 a[72:75], v2 offset:4096
    v_fmac_f32 v77, v27, v13
    v_fmac_f32 v78, v28, v13
    v_mfma_f32_16x16x32_bf16 v[168:171], a[0:3], a[96:99], v[168:171]
    v_fmac_f32 v79, v29, v13
    v_mfma_f32_16x16x32_bf16 v[172:175], a[0:3], a[100:103], v[172:175]
    buffer_load_dwordx4 a[0:3], v46, s[12:15], s28 offen offset:2048
    v_mul_f32 v34, v72, v72
    v_mfma_f32_16x16x32_bf16 v[176:179], a[4:7], a[88:91], v[176:179]
    v_mul_f32 v35, v73, v73
    v_mul_f32 v36, v74, v74
    v_mfma_f32_16x16x32_bf16 v[180:183], a[4:7], a[92:95], v[180:183]
    ds_read_b128 a[76:79], v2 offset:22528
    v_mul_f32 v37, v75, v75
    v_mfma_f32_16x16x32_bf16 v[184:187], a[4:7], a[96:99], v[184:187]
    v_mul_f32 v38, v76, v76
    v_mfma_f32_16x16x32_bf16 v[188:191], a[4:7], a[100:103], v[188:191]
    buffer_load_dwordx4 a[4:7], v47, s[12:15], s28 offen offset:2048
    v_mul_f32 v39, v77, v77
    v_mfma_f32_16x16x32_bf16 v[192:195], a[8:11], a[88:91], v[192:195]
    v_mul_f32 v40, v78, v78
    v_mul_f32 v41, v79, v79
    v_mfma_f32_16x16x32_bf16 v[196:199], a[8:11], a[92:95], v[196:199]
    ds_read_b128 a[80:83], v3 offset:4096
    v_fma_f32 v34, v34, v16, v20
    v_mfma_f32_16x16x32_bf16 v[200:203], a[8:11], a[96:99], v[200:203]
    v_fma_f32 v35, v35, v16, v20
    v_mfma_f32_16x16x32_bf16 v[204:207], a[8:11], a[100:103], v[204:207]
    buffer_load_dwordx4 a[8:11], v48, s[12:15], s28 offen offset:2048
    v_fma_f32 v36, v36, v16, v20
    v_fma_f32 v37, v37, v16, v20
    v_mfma_f32_16x16x32_bf16 v[208:211], a[12:15], a[88:91], v[208:211]
    v_fma_f32 v38, v38, v17, v21
    v_mfma_f32_16x16x32_bf16 v[212:215], a[12:15], a[92:95], v[212:215]
    ds_read_b128 a[84:87], v3 offset:22528
    v_fma_f32 v39, v39, v17, v21
    v_mfma_f32_16x16x32_bf16 v[216:219], a[12:15], a[96:99], v[216:219]
    v_fma_f32 v40, v40, v17, v21
    v_mfma_f32_16x16x32_bf16 v[220:223], a[12:15], a[100:103], v[220:223]
    buffer_load_dwordx4 a[12:15], v49, s[12:15], s28 offen offset:2048
    v_fma_f32 v41, v41, v17, v21
    v_mul_f32 v34, v72, v34
    v_mfma_f32_16x16x32_bf16 v[224:227], a[16:19], a[88:91], v[224:227]
    v_mul_f32 v35, v73, v35
    v_mfma_f32_16x16x32_bf16 v[228:231], a[16:19], a[92:95], v[228:231]
    v_mul_f32 v36, v74, v36
    v_mfma_f32_16x16x32_bf16 v[232:235], a[16:19], a[96:99], v[232:235]
    v_mul_f32 v37, v75, v37
    v_mul_f32 v38, v76, v38
    v_mfma_f32_16x16x32_bf16 v[236:239], a[16:19], a[100:103], v[236:239]
    buffer_load_dwordx4 a[16:19], v50, s[12:15], s28 offen offset:2048
    v_mul_f32 v39, v77, v39
    v_mfma_f32_16x16x32_bf16 v[240:243], a[20:23], a[88:91], v[240:243]
    v_mul_f32 v40, v78, v40
    v_mfma_f32_16x16x32_bf16 v[244:247], a[20:23], a[92:95], v[244:247]
    v_mul_f32 v41, v79, v41
    v_mfma_f32_16x16x32_bf16 v[248:251], a[20:23], a[96:99], v[248:251]
    v_exp_f32 v34, v34
    v_exp_f32 v35, v35
    v_mfma_f32_16x16x32_bf16 v[252:255], a[20:23], a[100:103], v[252:255]
    buffer_load_dwordx4 a[20:23], v51, s[12:15], s28 offen offset:2048
    v_exp_f32 v36, v36
    s_waitcnt vmcnt(12) lgkmcnt(0)
    v_mfma_f32_16x16x32_bf16 v[160:163], a[24:27], a[72:75], v[160:163]
    v_exp_f32 v37, v37
    v_mfma_f32_16x16x32_bf16 v[164:167], a[24:27], a[76:79], v[164:167]
    ds_read_b128 a[88:91], v2 offset:5120
    v_exp_f32 v38, v38
    v_exp_f32 v39, v39
    v_mfma_f32_16x16x32_bf16 v[168:171], a[24:27], a[80:83], v[168:171]
    v_exp_f32 v40, v40
    v_mfma_f32_16x16x32_bf16 v[172:175], a[24:27], a[84:87], v[172:175]
    buffer_load_dwordx4 a[24:27], v46, s[12:15], s28 offen offset:3072
    v_exp_f32 v41, v41
    v_mfma_f32_16x16x32_bf16 v[176:179], a[28:31], a[72:75], v[176:179]
    v_fmac_f32 v88, v30, v12
    v_mfma_f32_16x16x32_bf16 v[180:183], a[28:31], a[76:79], v[180:183]
    ds_read_b128 a[92:95], v2 offset:23552
    v_fmac_f32 v89, v31, v12
    v_fmac_f32 v90, v32, v12
    v_mfma_f32_16x16x32_bf16 v[184:187], a[28:31], a[80:83], v[184:187]
    v_fmac_f32 v91, v33, v12
    v_mfma_f32_16x16x32_bf16 v[188:191], a[28:31], a[84:87], v[188:191]
    buffer_load_dwordx4 a[28:31], v47, s[12:15], s28 offen offset:3072
    v_fmac_f32 v92, v30, v13
    v_mfma_f32_16x16x32_bf16 v[192:195], a[32:35], a[72:75], v[192:195]
    v_fmac_f32 v93, v31, v13
    v_fmac_f32 v94, v32, v13
    v_mfma_f32_16x16x32_bf16 v[196:199], a[32:35], a[76:79], v[196:199]
    ds_read_b128 a[96:99], v3 offset:5120
    v_fmac_f32 v95, v33, v13
    v_mfma_f32_16x16x32_bf16 v[200:203], a[32:35], a[80:83], v[200:203]
    v_fma_f32 v34, v34, v24, v24
    v_mfma_f32_16x16x32_bf16 v[204:207], a[32:35], a[84:87], v[204:207]
    buffer_load_dwordx4 a[32:35], v48, s[12:15], s28 offen offset:3072
    v_fma_f32 v35, v35, v24, v24
    v_mfma_f32_16x16x32_bf16 v[208:211], a[36:39], a[72:75], v[208:211]
    v_fma_f32 v36, v36, v24, v24
    v_fma_f32 v37, v37, v24, v24
    v_mfma_f32_16x16x32_bf16 v[212:215], a[36:39], a[76:79], v[212:215]
    ds_read_b128 a[100:103], v3 offset:23552
    v_fma_f32 v38, v38, v25, v25
    v_mfma_f32_16x16x32_bf16 v[216:219], a[36:39], a[80:83], v[216:219]
    v_fma_f32 v39, v39, v25, v25
    v_mfma_f32_16x16x32_bf16 v[220:223], a[36:39], a[84:87], v[220:223]
    buffer_load_dwordx4 a[36:39], v49, s[12:15], s28 offen offset:3072
    v_fma_f32 v40, v40, v25, v25
    v_fma_f32 v41, v41, v25, v25
    v_mfma_f32_16x16x32_bf16 v[224:227], a[40:43], a[72:75], v[224:227]
    v_rcp_f32 v34, v34
    v_mfma_f32_16x16x32_bf16 v[228:231], a[40:43], a[76:79], v[228:231]
    v_rcp_f32 v35, v35
    v_mfma_f32_16x16x32_bf16 v[232:235], a[40:43], a[80:83], v[232:235]
    v_rcp_f32 v36, v36
    v_mfma_f32_16x16x32_bf16 v[236:239], a[40:43], a[84:87], v[236:239]
    buffer_load_dwordx4 a[40:43], v50, s[12:15], s28 offen offset:3072
    v_rcp_f32 v37, v37
    v_rcp_f32 v38, v38
    v_mfma_f32_16x16x32_bf16 v[240:243], a[44:47], a[72:75], v[240:243]
    v_rcp_f32 v39, v39
    v_mfma_f32_16x16x32_bf16 v[244:247], a[44:47], a[76:79], v[244:247]
    v_rcp_f32 v40, v40
    v_mfma_f32_16x16x32_bf16 v[248:251], a[44:47], a[80:83], v[248:251]
    v_rcp_f32 v41, v41
    v_mul_f32 v88, v72, v88
    v_mfma_f32_16x16x32_bf16 v[252:255], a[44:47], a[84:87], v[252:255]
    buffer_load_dwordx4 a[44:47], v51, s[12:15], s28 offen offset:3072
    v_mul_f32 v89, v73, v89
    s_waitcnt vmcnt(12) lgkmcnt(0)
    v_mfma_f32_16x16x32_bf16 v[160:163], a[48:51], a[88:91], v[160:163]
    v_mul_f32 v90, v74, v90
    v_mfma_f32_16x16x32_bf16 v[164:167], a[48:51], a[92:95], v[164:167]
    ds_read_b128 a[72:75], v2 offset:6144
    v_mul_f32 v91, v75, v91
    v_mfma_f32_16x16x32_bf16 v[168:171], a[48:51], a[96:99], v[168:171]
    v_mul_f32 v92, v76, v92
    v_mul_f32 v93, v77, v93
    v_mfma_f32_16x16x32_bf16 v[172:175], a[48:51], a[100:103], v[172:175]
    s_add_u32 s28, s28, 4096
    buffer_load_dwordx4 a[48:51], v46, s[12:15], s28 offen offset:0
    v_mul_f32 v94, v78, v94
    v_mfma_f32_16x16x32_bf16 v[176:179], a[52:55], a[88:91], v[176:179]
    v_mul_f32 v95, v79, v95
    v_mfma_f32_16x16x32_bf16 v[180:183], a[52:55], a[92:95], v[180:183]
    ds_read_b128 a[76:79], v2 offset:24576
    v_mul_f32 v34, v34, v88
    v_mul_f32 v35, v35, v89
    v_mfma_f32_16x16x32_bf16 v[184:187], a[52:55], a[96:99], v[184:187]
    v_mul_f32 v36, v36, v90
    v_mfma_f32_16x16x32_bf16 v[188:191], a[52:55], a[100:103], v[188:191]
    buffer_load_dwordx4 a[52:55], v47, s[12:15], s28 offen offset:0
    v_mul_f32 v37, v37, v91
    v_mfma_f32_16x16x32_bf16 v[192:195], a[56:59], a[88:91], v[192:195]
    v_mul_f32 v38, v38, v92
    v_mfma_f32_16x16x32_bf16 v[196:199], a[56:59], a[92:95], v[196:199]
    ds_read_b128 a[80:83], v3 offset:6144
    v_mul_f32 v39, v39, v93
    v_mul_f32 v40, v40, v94
    v_mfma_f32_16x16x32_bf16 v[200:203], a[56:59], a[96:99], v[200:203]
    v_mul_f32 v41, v41, v95
    v_mfma_f32_16x16x32_bf16 v[204:207], a[56:59], a[100:103], v[204:207]
    buffer_load_dwordx4 a[56:59], v48, s[12:15], s28 offen offset:0
    v_cvt_pk_bf16_f32 v42, v34, v35
    v_mfma_f32_16x16x32_bf16 v[208:211], a[60:63], a[88:91], v[208:211]
    v_cvt_pk_bf16_f32 v43, v36, v37
    v_cvt_pk_bf16_f32 v44, v38, v39
    v_mfma_f32_16x16x32_bf16 v[212:215], a[60:63], a[92:95], v[212:215]
    ds_read_b128 a[84:87], v3 offset:24576
    v_cvt_pk_bf16_f32 v45, v40, v41
    v_mfma_f32_16x16x32_bf16 v[216:219], a[60:63], a[96:99], v[216:219]
    ds_write_b64 v9, v[42:43] offset:0
    v_mfma_f32_16x16x32_bf16 v[220:223], a[60:63], a[100:103], v[220:223]
    buffer_load_dwordx4 a[60:63], v49, s[12:15], s28 offen offset:0
    ds_write_b64 v9, v[44:45] offset:18432
    v_mfma_f32_16x16x32_bf16 v[224:227], a[64:67], a[88:91], v[224:227]
    ds_read_b128 v[26:29], v8 offset:128
    ds_read_b128 v[30:33], v8 offset:144
    v_mfma_f32_16x16x32_bf16 v[228:231], a[64:67], a[92:95], v[228:231]
    s_waitcnt lgkmcnt(0)
    v_mfma_f32_16x16x32_bf16 v[232:235], a[64:67], a[96:99], v[232:235]
    v_fmac_f32 v96, v26, v10
    v_mfma_f32_16x16x32_bf16 v[236:239], a[64:67], a[100:103], v[236:239]
    buffer_load_dwordx4 a[64:67], v50, s[12:15], s28 offen offset:0
    v_fmac_f32 v97, v27, v10
    v_fmac_f32 v98, v28, v10
    v_mfma_f32_16x16x32_bf16 v[240:243], a[68:71], a[88:91], v[240:243]
    v_fmac_f32 v99, v29, v10
    v_mfma_f32_16x16x32_bf16 v[244:247], a[68:71], a[92:95], v[244:247]
    v_fmac_f32 v100, v26, v11
    v_mfma_f32_16x16x32_bf16 v[248:251], a[68:71], a[96:99], v[248:251]
    v_fmac_f32 v101, v27, v11
    v_fmac_f32 v102, v28, v11
    v_mfma_f32_16x16x32_bf16 v[252:255], a[68:71], a[100:103], v[252:255]
    buffer_load_dwordx4 a[68:71], v51, s[12:15], s28 offen offset:0
    v_fmac_f32 v103, v29, v11
    s_waitcnt vmcnt(12)
    v_mfma_f32_16x16x32_bf16 v[160:163], a[0:3], a[72:75], v[160:163]
    v_mul_f32 v34, v96, v96
    v_mfma_f32_16x16x32_bf16 v[164:167], a[0:3], a[76:79], v[164:167]
    ds_read_b128 a[88:91], v2 offset:7168
    v_mul_f32 v35, v97, v97
    v_mfma_f32_16x16x32_bf16 v[168:171], a[0:3], a[80:83], v[168:171]
    v_mul_f32 v36, v98, v98
    v_mul_f32 v37, v99, v99
    v_mfma_f32_16x16x32_bf16 v[172:175], a[0:3], a[84:87], v[172:175]
    buffer_load_dwordx4 a[0:3], v46, s[12:15], s28 offen offset:1024
    v_mul_f32 v38, v100, v100
    v_mfma_f32_16x16x32_bf16 v[176:179], a[4:7], a[72:75], v[176:179]
    v_mul_f32 v39, v101, v101
    v_mfma_f32_16x16x32_bf16 v[180:183], a[4:7], a[76:79], v[180:183]
    ds_read_b128 a[92:95], v2 offset:25600
    v_mul_f32 v40, v102, v102
    v_mul_f32 v41, v103, v103
    v_mfma_f32_16x16x32_bf16 v[184:187], a[4:7], a[80:83], v[184:187]
    v_fma_f32 v34, v34, v14, v18
    v_mfma_f32_16x16x32_bf16 v[188:191], a[4:7], a[84:87], v[188:191]
    buffer_load_dwordx4 a[4:7], v47, s[12:15], s28 offen offset:1024
    v_fma_f32 v35, v35, v14, v18
    v_mfma_f32_16x16x32_bf16 v[192:195], a[8:11], a[72:75], v[192:195]
    v_fma_f32 v36, v36, v14, v18
    v_mfma_f32_16x16x32_bf16 v[196:199], a[8:11], a[76:79], v[196:199]
    ds_read_b128 a[96:99], v3 offset:7168
    v_fma_f32 v37, v37, v14, v18
    v_fma_f32 v38, v38, v15, v19
    v_mfma_f32_16x16x32_bf16 v[200:203], a[8:11], a[80:83], v[200:203]
    v_fma_f32 v39, v39, v15, v19
    v_mfma_f32_16x16x32_bf16 v[204:207], a[8:11], a[84:87], v[204:207]
    buffer_load_dwordx4 a[8:11], v48, s[12:15], s28 offen offset:1024
    v_fma_f32 v40, v40, v15, v19
    v_mfma_f32_16x16x32_bf16 v[208:211], a[12:15], a[72:75], v[208:211]
    v_fma_f32 v41, v41, v15, v19
    v_mul_f32 v34, v96, v34
    v_mfma_f32_16x16x32_bf16 v[212:215], a[12:15], a[76:79], v[212:215]
    ds_read_b128 a[100:103], v3 offset:25600
    v_mul_f32 v35, v97, v35
    v_mfma_f32_16x16x32_bf16 v[216:219], a[12:15], a[80:83], v[216:219]
    v_mul_f32 v36, v98, v36
    v_mfma_f32_16x16x32_bf16 v[220:223], a[12:15], a[84:87], v[220:223]
    buffer_load_dwordx4 a[12:15], v49, s[12:15], s28 offen offset:1024
    v_mul_f32 v37, v99, v37
    v_mfma_f32_16x16x32_bf16 v[224:227], a[16:19], a[72:75], v[224:227]
    v_mul_f32 v38, v100, v38
    v_mul_f32 v39, v101, v39
    v_mfma_f32_16x16x32_bf16 v[228:231], a[16:19], a[76:79], v[228:231]
    v_mul_f32 v40, v102, v40
    v_mfma_f32_16x16x32_bf16 v[232:235], a[16:19], a[80:83], v[232:235]
    v_mul_f32 v41, v103, v41
    v_mfma_f32_16x16x32_bf16 v[236:239], a[16:19], a[84:87], v[236:239]
    buffer_load_dwordx4 a[16:19], v50, s[12:15], s28 offen offset:1024
    v_exp_f32 v34, v34
    v_exp_f32 v35, v35
    v_mfma_f32_16x16x32_bf16 v[240:243], a[20:23], a[72:75], v[240:243]
    v_exp_f32 v36, v36
    v_mfma_f32_16x16x32_bf16 v[244:247], a[20:23], a[76:79], v[244:247]
    v_exp_f32 v37, v37
    v_mfma_f32_16x16x32_bf16 v[248:251], a[20:23], a[80:83], v[248:251]
    v_exp_f32 v38, v38
    v_mfma_f32_16x16x32_bf16 v[252:255], a[20:23], a[84:87], v[252:255]
    buffer_load_dwordx4 a[20:23], v51, s[12:15], s28 offen offset:1024
    v_exp_f32 v39, v39
    v_exp_f32 v40, v40
    s_waitcnt vmcnt(12) lgkmcnt(0)
    v_mfma_f32_16x16x32_bf16 v[160:163], a[24:27], a[88:91], v[160:163]
    v_exp_f32 v41, v41
    v_mfma_f32_16x16x32_bf16 v[164:167], a[24:27], a[92:95], v[164:167]
    ds_read_b128 a[72:75], v2 offset:8192
    v_fmac_f32 v112, v30, v10
    v_mfma_f32_16x16x32_bf16 v[168:171], a[24:27], a[96:99], v[168:171]
    v_fmac_f32 v113, v31, v10
    v_fmac_f32 v114, v32, v10
    v_mfma_f32_16x16x32_bf16 v[172:175], a[24:27], a[100:103], v[172:175]
    buffer_load_dwordx4 a[24:27], v46, s[12:15], s28 offen offset:2048
    v_fmac_f32 v115, v33, v10
    v_mfma_f32_16x16x32_bf16 v[176:179], a[28:31], a[88:91], v[176:179]
    v_fmac_f32 v116, v30, v11
    v_mfma_f32_16x16x32_bf16 v[180:183], a[28:31], a[92:95], v[180:183]
    ds_read_b128 a[76:79], v2 offset:26624
    v_fmac_f32 v117, v31, v11
    v_mfma_f32_16x16x32_bf16 v[184:187], a[28:31], a[96:99], v[184:187]
    v_fmac_f32 v118, v32, v11
    v_fmac_f32 v119, v33, v11
    v_mfma_f32_16x16x32_bf16 v[188:191], a[28:31], a[100:103], v[188:191]
    buffer_load_dwordx4 a[28:31], v47, s[12:15], s28 offen offset:2048
    v_fma_f32 v34, v34, v22, v22
    v_mfma_f32_16x16x32_bf16 v[192:195], a[32:35], a[88:91], v[192:195]
    v_fma_f32 v35, v35, v22, v22
    v_mfma_f32_16x16x32_bf16 v[196:199], a[32:35], a[92:95], v[196:199]
    ds_read_b128 a[80:83], v3 offset:8192
    v_fma_f32 v36, v36, v22, v22
    v_fma_f32 v37, v37, v22, v22
    v_mfma_f32_16x16x32_bf16 v[200:203], a[32:35], a[96:99], v[200:203]
    v_fma_f32 v38, v38, v23, v23
    v_mfma_f32_16x16x32_bf16 v[204:207], a[32:35], a[100:103], v[204:207]
    buffer_load_dwordx4 a[32:35], v48, s[12:15], s28 offen offset:2048
    v_fma_f32 v39, v39, v23, v23
    v_mfma_f32_16x16x32_bf16 v[208:211], a[36:39], a[88:91], v[208:211]
    v_fma_f32 v40, v40, v23, v23
    v_mfma_f32_16x16x32_bf16 v[212:215], a[36:39], a[92:95], v[212:215]
    ds_read_b128 a[84:87], v3 offset:26624
    v_fma_f32 v41, v41, v23, v23
    v_rcp_f32 v34, v34
    v_mfma_f32_16x16x32_bf16 v[216:219], a[36:39], a[96:99], v[216:219]
    v_rcp_f32 v35, v35
    v_mfma_f32_16x16x32_bf16 v[220:223], a[36:39], a[100:103], v[220:223]
    buffer_load_dwordx4 a[36:39], v49, s[12:15], s28 offen offset:2048
    v_rcp_f32 v36, v36
    v_mfma_f32_16x16x32_bf16 v[224:227], a[40:43], a[88:91], v[224:227]
    v_rcp_f32 v37, v37
    v_rcp_f32 v38, v38
    v_mfma_f32_16x16x32_bf16 v[228:231], a[40:43], a[92:95], v[228:231]
    v_rcp_f32 v39, v39
    v_mfma_f32_16x16x32_bf16 v[232:235], a[40:43], a[96:99], v[232:235]
    v_rcp_f32 v40, v40
    v_mfma_f32_16x16x32_bf16 v[236:239], a[40:43], a[100:103], v[236:239]
    buffer_load_dwordx4 a[40:43], v50, s[12:15], s28 offen offset:2048
    v_rcp_f32 v41, v41
    v_mfma_f32_16x16x32_bf16 v[240:243], a[44:47], a[88:91], v[240:243]
    v_mul_f32 v112, v96, v112
    v_mul_f32 v113, v97, v113
    v_mfma_f32_16x16x32_bf16 v[244:247], a[44:47], a[92:95], v[244:247]
    v_mul_f32 v114, v98, v114
    v_mfma_f32_16x16x32_bf16 v[248:251], a[44:47], a[96:99], v[248:251]
    v_mul_f32 v115, v99, v115
    v_mfma_f32_16x16x32_bf16 v[252:255], a[44:47], a[100:103], v[252:255]
    buffer_load_dwordx4 a[44:47], v51, s[12:15], s28 offen offset:2048
    v_mul_f32 v116, v100, v116
    v_mul_f32 v117, v101, v117
    s_waitcnt vmcnt(12) lgkmcnt(0)
    v_mfma_f32_16x16x32_bf16 v[160:163], a[48:51], a[72:75], v[160:163]
    v_mul_f32 v118, v102, v118
    v_mfma_f32_16x16x32_bf16 v[164:167], a[48:51], a[76:79], v[164:167]
    ds_read_b128 a[88:91], v2 offset:9216
    v_mul_f32 v119, v103, v119
    v_mfma_f32_16x16x32_bf16 v[168:171], a[48:51], a[80:83], v[168:171]
    v_mul_f32 v34, v34, v112
    v_mfma_f32_16x16x32_bf16 v[172:175], a[48:51], a[84:87], v[172:175]
    buffer_load_dwordx4 a[48:51], v46, s[12:15], s28 offen offset:3072
    v_mul_f32 v35, v35, v113
    v_mul_f32 v36, v36, v114
    v_mfma_f32_16x16x32_bf16 v[176:179], a[52:55], a[72:75], v[176:179]
    v_mul_f32 v37, v37, v115
    v_mfma_f32_16x16x32_bf16 v[180:183], a[52:55], a[76:79], v[180:183]
    ds_read_b128 a[92:95], v2 offset:27648
    v_mul_f32 v38, v38, v116
    v_mfma_f32_16x16x32_bf16 v[184:187], a[52:55], a[80:83], v[184:187]
    v_mul_f32 v39, v39, v117
    v_mul_f32 v40, v40, v118
    v_mfma_f32_16x16x32_bf16 v[188:191], a[52:55], a[84:87], v[188:191]
    buffer_load_dwordx4 a[52:55], v47, s[12:15], s28 offen offset:3072
    v_mul_f32 v41, v41, v119
    v_mfma_f32_16x16x32_bf16 v[192:195], a[56:59], a[72:75], v[192:195]
    v_cvt_pk_bf16_f32 v42, v34, v35
    v_mfma_f32_16x16x32_bf16 v[196:199], a[56:59], a[76:79], v[196:199]
    ds_read_b128 a[96:99], v3 offset:9216
    v_cvt_pk_bf16_f32 v43, v36, v37
    v_mfma_f32_16x16x32_bf16 v[200:203], a[56:59], a[80:83], v[200:203]
    v_cvt_pk_bf16_f32 v44, v38, v39
    v_cvt_pk_bf16_f32 v45, v40, v41
    v_mfma_f32_16x16x32_bf16 v[204:207], a[56:59], a[84:87], v[204:207]
    buffer_load_dwordx4 a[56:59], v48, s[12:15], s28 offen offset:3072
    ds_write_b64 v7, v[42:43] offset:0
    v_mfma_f32_16x16x32_bf16 v[208:211], a[60:63], a[72:75], v[208:211]
    ds_write_b64 v7, v[44:45] offset:18432
    v_mfma_f32_16x16x32_bf16 v[212:215], a[60:63], a[76:79], v[212:215]
    ds_read_b128 a[100:103], v3 offset:27648
    v_fmac_f32 v104, v26, v12
    v_fmac_f32 v105, v27, v12
    v_mfma_f32_16x16x32_bf16 v[216:219], a[60:63], a[80:83], v[216:219]
    v_fmac_f32 v106, v28, v12
    v_mfma_f32_16x16x32_bf16 v[220:223], a[60:63], a[84:87], v[220:223]
    buffer_load_dwordx4 a[60:63], v49, s[12:15], s28 offen offset:3072
    v_fmac_f32 v107, v29, v12
    v_mfma_f32_16x16x32_bf16 v[224:227], a[64:67], a[72:75], v[224:227]
    v_fmac_f32 v108, v26, v13
    v_mfma_f32_16x16x32_bf16 v[228:231], a[64:67], a[76:79], v[228:231]
    v_fmac_f32 v109, v27, v13
    v_fmac_f32 v110, v28, v13
    v_mfma_f32_16x16x32_bf16 v[232:235], a[64:67], a[80:83], v[232:235]
    v_fmac_f32 v111, v29, v13
    v_mfma_f32_16x16x32_bf16 v[236:239], a[64:67], a[84:87], v[236:239]
    buffer_load_dwordx4 a[64:67], v50, s[12:15], s28 offen offset:3072
    v_mul_f32 v34, v104, v104
    v_mfma_f32_16x16x32_bf16 v[240:243], a[68:71], a[72:75], v[240:243]
    v_mul_f32 v35, v105, v105
    v_mul_f32 v36, v106, v106
    v_mfma_f32_16x16x32_bf16 v[244:247], a[68:71], a[76:79], v[244:247]
    v_mul_f32 v37, v107, v107
    v_mfma_f32_16x16x32_bf16 v[248:251], a[68:71], a[80:83], v[248:251]
    v_mul_f32 v38, v108, v108
    v_mfma_f32_16x16x32_bf16 v[252:255], a[68:71], a[84:87], v[252:255]
    buffer_load_dwordx4 a[68:71], v51, s[12:15], s28 offen offset:3072
    v_mul_f32 v39, v109, v109
    s_waitcnt vmcnt(12) lgkmcnt(0)
    v_mfma_f32_16x16x32_bf16 v[160:163], a[0:3], a[88:91], v[160:163]
    v_mul_f32 v40, v110, v110
    v_mul_f32 v41, v111, v111
    v_mfma_f32_16x16x32_bf16 v[164:167], a[0:3], a[92:95], v[164:167]
    ds_read_b128 a[72:75], v2 offset:10240
    v_fma_f32 v34, v34, v16, v20
    v_mfma_f32_16x16x32_bf16 v[168:171], a[0:3], a[96:99], v[168:171]
    v_fma_f32 v35, v35, v16, v20
    v_mfma_f32_16x16x32_bf16 v[172:175], a[0:3], a[100:103], v[172:175]
    s_add_u32 s28, s28, 4096
    buffer_load_dwordx4 a[0:3], v46, s[12:15], s28 offen offset:0
    v_fma_f32 v36, v36, v16, v20
    v_fma_f32 v37, v37, v16, v20
    v_mfma_f32_16x16x32_bf16 v[176:179], a[4:7], a[88:91], v[176:179]
    v_fma_f32 v38, v38, v17, v21
    v_mfma_f32_16x16x32_bf16 v[180:183], a[4:7], a[92:95], v[180:183]
    ds_read_b128 a[76:79], v2 offset:28672
    v_fma_f32 v39, v39, v17, v21
    v_mfma_f32_16x16x32_bf16 v[184:187], a[4:7], a[96:99], v[184:187]
    v_fma_f32 v40, v40, v17, v21
    v_mfma_f32_16x16x32_bf16 v[188:191], a[4:7], a[100:103], v[188:191]
    buffer_load_dwordx4 a[4:7], v47, s[12:15], s28 offen offset:0
    v_fma_f32 v41, v41, v17, v21
    v_mul_f32 v34, v104, v34
    v_mfma_f32_16x16x32_bf16 v[192:195], a[8:11], a[88:91], v[192:195]
    v_mul_f32 v35, v105, v35
    v_mfma_f32_16x16x32_bf16 v[196:199], a[8:11], a[92:95], v[196:199]
    ds_read_b128 a[80:83], v3 offset:10240
    v_mul_f32 v36, v106, v36
    v_mfma_f32_16x16x32_bf16 v[200:203], a[8:11], a[96:99], v[200:203]
    v_mul_f32 v37, v107, v37
    v_mul_f32 v38, v108, v38
    v_mfma_f32_16x16x32_bf16 v[204:207], a[8:11], a[100:103], v[204:207]
    buffer_load_dwordx4 a[8:11], v48, s[12:15], s28 offen offset:0
    v_mul_f32 v39, v109, v39
    v_mfma_f32_16x16x32_bf16 v[208:211], a[12:15], a[88:91], v[208:211]
    v_mul_f32 v40, v110, v40
    v_mfma_f32_16x16x32_bf16 v[212:215], a[12:15], a[92:95], v[212:215]
    ds_read_b128 a[84:87], v3 offset:28672
    v_mul_f32 v41, v111, v41
    v_mfma_f32_16x16x32_bf16 v[216:219], a[12:15], a[96:99], v[216:219]
    v_exp_f32 v34, v34
    v_exp_f32 v35, v35
    v_mfma_f32_16x16x32_bf16 v[220:223], a[12:15], a[100:103], v[220:223]
    buffer_load_dwordx4 a[12:15], v49, s[12:15], s28 offen offset:0
    v_exp_f32 v36, v36
    v_mfma_f32_16x16x32_bf16 v[224:227], a[16:19], a[88:91], v[224:227]
    v_exp_f32 v37, v37
    v_mfma_f32_16x16x32_bf16 v[228:231], a[16:19], a[92:95], v[228:231]
    v_exp_f32 v38, v38
    v_exp_f32 v39, v39
    v_mfma_f32_16x16x32_bf16 v[232:235], a[16:19], a[96:99], v[232:235]
    v_exp_f32 v40, v40
    v_mfma_f32_16x16x32_bf16 v[236:239], a[16:19], a[100:103], v[236:239]
    buffer_load_dwordx4 a[16:19], v50, s[12:15], s28 offen offset:0
    v_exp_f32 v41, v41
    v_mfma_f32_16x16x32_bf16 v[240:243], a[20:23], a[88:91], v[240:243]
    v_fmac_f32 v120, v30, v12
    v_mfma_f32_16x16x32_bf16 v[244:247], a[20:23], a[92:95], v[244:247]
    v_fmac_f32 v121, v31, v12
    v_fmac_f32 v122, v32, v12
    v_mfma_f32_16x16x32_bf16 v[248:251], a[20:23], a[96:99], v[248:251]
    v_fmac_f32 v123, v33, v12
    v_mfma_f32_16x16x32_bf16 v[252:255], a[20:23], a[100:103], v[252:255]
    buffer_load_dwordx4 a[20:23], v51, s[12:15], s28 offen offset:0
    v_fmac_f32 v124, v30, v13
    s_waitcnt vmcnt(12) lgkmcnt(0)
    v_mfma_f32_16x16x32_bf16 v[160:163], a[24:27], a[72:75], v[160:163]
    v_fmac_f32 v125, v31, v13
    v_fmac_f32 v126, v32, v13
    v_mfma_f32_16x16x32_bf16 v[164:167], a[24:27], a[76:79], v[164:167]
    ds_read_b128 a[88:91], v2 offset:11264
    v_fmac_f32 v127, v33, v13
    v_mfma_f32_16x16x32_bf16 v[168:171], a[24:27], a[80:83], v[168:171]
    v_fma_f32 v34, v34, v24, v24
    v_mfma_f32_16x16x32_bf16 v[172:175], a[24:27], a[84:87], v[172:175]
    buffer_load_dwordx4 a[24:27], v46, s[12:15], s28 offen offset:1024
    v_fma_f32 v35, v35, v24, v24
    v_mfma_f32_16x16x32_bf16 v[176:179], a[28:31], a[72:75], v[176:179]
    v_fma_f32 v36, v36, v24, v24
    v_fma_f32 v37, v37, v24, v24
    v_mfma_f32_16x16x32_bf16 v[180:183], a[28:31], a[76:79], v[180:183]
    ds_read_b128 a[92:95], v2 offset:29696
    v_fma_f32 v38, v38, v25, v25
    v_mfma_f32_16x16x32_bf16 v[184:187], a[28:31], a[80:83], v[184:187]
    v_fma_f32 v39, v39, v25, v25
    v_mfma_f32_16x16x32_bf16 v[188:191], a[28:31], a[84:87], v[188:191]
    buffer_load_dwordx4 a[28:31], v47, s[12:15], s28 offen offset:1024
    v_fma_f32 v40, v40, v25, v25
    v_fma_f32 v41, v41, v25, v25
    v_mfma_f32_16x16x32_bf16 v[192:195], a[32:35], a[72:75], v[192:195]
    v_rcp_f32 v34, v34
    v_mfma_f32_16x16x32_bf16 v[196:199], a[32:35], a[76:79], v[196:199]
    ds_read_b128 a[96:99], v3 offset:11264
    v_rcp_f32 v35, v35
    v_mfma_f32_16x16x32_bf16 v[200:203], a[32:35], a[80:83], v[200:203]
    v_rcp_f32 v36, v36
    v_mfma_f32_16x16x32_bf16 v[204:207], a[32:35], a[84:87], v[204:207]
    buffer_load_dwordx4 a[32:35], v48, s[12:15], s28 offen offset:1024
    v_rcp_f32 v37, v37
    v_rcp_f32 v38, v38
    v_mfma_f32_16x16x32_bf16 v[208:211], a[36:39], a[72:75], v[208:211]
    v_rcp_f32 v39, v39
    v_mfma_f32_16x16x32_bf16 v[212:215], a[36:39], a[76:79], v[212:215]
    ds_read_b128 a[100:103], v3 offset:29696
    v_rcp_f32 v40, v40
    v_mfma_f32_16x16x32_bf16 v[216:219], a[36:39], a[80:83], v[216:219]
    v_rcp_f32 v41, v41
    v_mul_f32 v120, v104, v120
    v_mfma_f32_16x16x32_bf16 v[220:223], a[36:39], a[84:87], v[220:223]
    buffer_load_dwordx4 a[36:39], v49, s[12:15], s28 offen offset:1024
    v_mul_f32 v121, v105, v121
    v_mfma_f32_16x16x32_bf16 v[224:227], a[40:43], a[72:75], v[224:227]
    v_mul_f32 v122, v106, v122
    v_mfma_f32_16x16x32_bf16 v[228:231], a[40:43], a[76:79], v[228:231]
    v_mul_f32 v123, v107, v123
    v_mfma_f32_16x16x32_bf16 v[232:235], a[40:43], a[80:83], v[232:235]
    v_mul_f32 v124, v108, v124
    v_mul_f32 v125, v109, v125
    v_mfma_f32_16x16x32_bf16 v[236:239], a[40:43], a[84:87], v[236:239]
    buffer_load_dwordx4 a[40:43], v50, s[12:15], s28 offen offset:1024
    v_mul_f32 v126, v110, v126
    v_mfma_f32_16x16x32_bf16 v[240:243], a[44:47], a[72:75], v[240:243]
    v_mul_f32 v127, v111, v127
    v_mfma_f32_16x16x32_bf16 v[244:247], a[44:47], a[76:79], v[244:247]
    v_mul_f32 v34, v34, v120
    v_mul_f32 v35, v35, v121
    v_mfma_f32_16x16x32_bf16 v[248:251], a[44:47], a[80:83], v[248:251]
    v_mul_f32 v36, v36, v122
    v_mfma_f32_16x16x32_bf16 v[252:255], a[44:47], a[84:87], v[252:255]
    buffer_load_dwordx4 a[44:47], v51, s[12:15], s28 offen offset:1024
    v_mul_f32 v37, v37, v123
    s_waitcnt vmcnt(12) lgkmcnt(0)
    v_mfma_f32_16x16x32_bf16 v[160:163], a[48:51], a[88:91], v[160:163]
    v_mul_f32 v38, v38, v124
    v_mfma_f32_16x16x32_bf16 v[164:167], a[48:51], a[92:95], v[164:167]
    ds_read_b128 a[72:75], v2 offset:12288
    v_mul_f32 v39, v39, v125
    v_mul_f32 v40, v40, v126
    v_mfma_f32_16x16x32_bf16 v[168:171], a[48:51], a[96:99], v[168:171]
    v_mul_f32 v41, v41, v127
    v_mfma_f32_16x16x32_bf16 v[172:175], a[48:51], a[100:103], v[172:175]
    buffer_load_dwordx4 a[48:51], v46, s[12:15], s28 offen offset:2048
    v_cvt_pk_bf16_f32 v42, v34, v35
    v_mfma_f32_16x16x32_bf16 v[176:179], a[52:55], a[88:91], v[176:179]
    v_cvt_pk_bf16_f32 v43, v36, v37
    v_cvt_pk_bf16_f32 v44, v38, v39
    v_mfma_f32_16x16x32_bf16 v[180:183], a[52:55], a[92:95], v[180:183]
    ds_read_b128 a[76:79], v2 offset:30720
    v_cvt_pk_bf16_f32 v45, v40, v41
    v_mfma_f32_16x16x32_bf16 v[184:187], a[52:55], a[96:99], v[184:187]
    ds_write_b64 v0, v[42:43] offset:0
    v_mfma_f32_16x16x32_bf16 v[188:191], a[52:55], a[100:103], v[188:191]
    buffer_load_dwordx4 a[52:55], v47, s[12:15], s28 offen offset:2048
    ds_write_b64 v0, v[44:45] offset:18432
    v_mfma_f32_16x16x32_bf16 v[192:195], a[56:59], a[88:91], v[192:195]
    ds_read_b128 v[26:29], v8 offset:256
    ds_read_b128 v[30:33], v8 offset:272
    v_mfma_f32_16x16x32_bf16 v[196:199], a[56:59], a[92:95], v[196:199]
    ds_read_b128 a[80:83], v3 offset:12288
    s_waitcnt lgkmcnt(1)
    v_mfma_f32_16x16x32_bf16 v[200:203], a[56:59], a[96:99], v[200:203]
    v_fmac_f32 v128, v26, v10
    v_mfma_f32_16x16x32_bf16 v[204:207], a[56:59], a[100:103], v[204:207]
    buffer_load_dwordx4 a[56:59], v48, s[12:15], s28 offen offset:2048
    v_fmac_f32 v129, v27, v10
    v_fmac_f32 v130, v28, v10
    v_mfma_f32_16x16x32_bf16 v[208:211], a[60:63], a[88:91], v[208:211]
    v_fmac_f32 v131, v29, v10
    v_mfma_f32_16x16x32_bf16 v[212:215], a[60:63], a[92:95], v[212:215]
    ds_read_b128 a[84:87], v3 offset:30720
    v_fmac_f32 v132, v26, v11
    v_mfma_f32_16x16x32_bf16 v[216:219], a[60:63], a[96:99], v[216:219]
    v_fmac_f32 v133, v27, v11
    v_fmac_f32 v134, v28, v11
    v_mfma_f32_16x16x32_bf16 v[220:223], a[60:63], a[100:103], v[220:223]
    buffer_load_dwordx4 a[60:63], v49, s[12:15], s28 offen offset:2048
    v_fmac_f32 v135, v29, v11
    v_mfma_f32_16x16x32_bf16 v[224:227], a[64:67], a[88:91], v[224:227]
    v_mul_f32 v34, v128, v128
    v_mfma_f32_16x16x32_bf16 v[228:231], a[64:67], a[92:95], v[228:231]
    v_mul_f32 v35, v129, v129
    v_mfma_f32_16x16x32_bf16 v[232:235], a[64:67], a[96:99], v[232:235]
    v_mul_f32 v36, v130, v130
    v_mul_f32 v37, v131, v131
    v_mfma_f32_16x16x32_bf16 v[236:239], a[64:67], a[100:103], v[236:239]
    buffer_load_dwordx4 a[64:67], v50, s[12:15], s28 offen offset:2048
    v_mul_f32 v38, v132, v132
    v_mfma_f32_16x16x32_bf16 v[240:243], a[68:71], a[88:91], v[240:243]
    v_mul_f32 v39, v133, v133
    v_mfma_f32_16x16x32_bf16 v[244:247], a[68:71], a[92:95], v[244:247]
    v_mul_f32 v40, v134, v134
    v_mul_f32 v41, v135, v135
    v_mfma_f32_16x16x32_bf16 v[248:251], a[68:71], a[96:99], v[248:251]
    v_fma_f32 v34, v34, v14, v18
    v_mfma_f32_16x16x32_bf16 v[252:255], a[68:71], a[100:103], v[252:255]
    buffer_load_dwordx4 a[68:71], v51, s[12:15], s28 offen offset:2048
    v_fma_f32 v35, v35, v14, v18
    s_waitcnt vmcnt(12) lgkmcnt(0)
    v_mfma_f32_16x16x32_bf16 v[160:163], a[0:3], a[72:75], v[160:163]
    v_fma_f32 v36, v36, v14, v18
    v_mfma_f32_16x16x32_bf16 v[164:167], a[0:3], a[76:79], v[164:167]
    ds_read_b128 a[88:91], v2 offset:13312
    v_fma_f32 v37, v37, v14, v18
    v_fma_f32 v38, v38, v15, v19
    v_mfma_f32_16x16x32_bf16 v[168:171], a[0:3], a[80:83], v[168:171]
    v_fma_f32 v39, v39, v15, v19
    v_mfma_f32_16x16x32_bf16 v[172:175], a[0:3], a[84:87], v[172:175]
    buffer_load_dwordx4 a[0:3], v46, s[12:15], s28 offen offset:3072
    v_fma_f32 v40, v40, v15, v19
    v_mfma_f32_16x16x32_bf16 v[176:179], a[4:7], a[72:75], v[176:179]
    v_fma_f32 v41, v41, v15, v19
    v_mul_f32 v34, v128, v34
    v_mfma_f32_16x16x32_bf16 v[180:183], a[4:7], a[76:79], v[180:183]
    ds_read_b128 a[92:95], v2 offset:31744
    v_mul_f32 v35, v129, v35
    v_mfma_f32_16x16x32_bf16 v[184:187], a[4:7], a[80:83], v[184:187]
    v_mul_f32 v36, v130, v36
    v_mfma_f32_16x16x32_bf16 v[188:191], a[4:7], a[84:87], v[188:191]
    buffer_load_dwordx4 a[4:7], v47, s[12:15], s28 offen offset:3072
    v_mul_f32 v37, v131, v37
    v_mfma_f32_16x16x32_bf16 v[192:195], a[8:11], a[72:75], v[192:195]
    v_mul_f32 v38, v132, v38
    v_mul_f32 v39, v133, v39
    v_mfma_f32_16x16x32_bf16 v[196:199], a[8:11], a[76:79], v[196:199]
    ds_read_b128 a[96:99], v3 offset:13312
    v_mul_f32 v40, v134, v40
    v_mfma_f32_16x16x32_bf16 v[200:203], a[8:11], a[80:83], v[200:203]
    v_mul_f32 v41, v135, v41
    v_mfma_f32_16x16x32_bf16 v[204:207], a[8:11], a[84:87], v[204:207]
    buffer_load_dwordx4 a[8:11], v48, s[12:15], s28 offen offset:3072
    v_exp_f32 v34, v34
    v_exp_f32 v35, v35
    v_mfma_f32_16x16x32_bf16 v[208:211], a[12:15], a[72:75], v[208:211]
    v_exp_f32 v36, v36
    v_mfma_f32_16x16x32_bf16 v[212:215], a[12:15], a[76:79], v[212:215]
    ds_read_b128 a[100:103], v3 offset:31744
    v_exp_f32 v37, v37
    v_mfma_f32_16x16x32_bf16 v[216:219], a[12:15], a[80:83], v[216:219]
    v_exp_f32 v38, v38
    v_mfma_f32_16x16x32_bf16 v[220:223], a[12:15], a[84:87], v[220:223]
    buffer_load_dwordx4 a[12:15], v49, s[12:15], s28 offen offset:3072
    v_exp_f32 v39, v39
    v_exp_f32 v40, v40
    v_mfma_f32_16x16x32_bf16 v[224:227], a[16:19], a[72:75], v[224:227]
    v_exp_f32 v41, v41
    v_mfma_f32_16x16x32_bf16 v[228:231], a[16:19], a[76:79], v[228:231]
    v_fmac_f32 v144, v30, v10
    v_mfma_f32_16x16x32_bf16 v[232:235], a[16:19], a[80:83], v[232:235]
    v_fmac_f32 v145, v31, v10
    v_fmac_f32 v146, v32, v10
    v_mfma_f32_16x16x32_bf16 v[236:239], a[16:19], a[84:87], v[236:239]
    buffer_load_dwordx4 a[16:19], v50, s[12:15], s28 offen offset:3072
    v_fmac_f32 v147, v33, v10
    v_mfma_f32_16x16x32_bf16 v[240:243], a[20:23], a[72:75], v[240:243]
    v_fmac_f32 v148, v30, v11
    v_mfma_f32_16x16x32_bf16 v[244:247], a[20:23], a[76:79], v[244:247]
    v_fmac_f32 v149, v31, v11
    v_mfma_f32_16x16x32_bf16 v[248:251], a[20:23], a[80:83], v[248:251]
    v_fmac_f32 v150, v32, v11
    v_fmac_f32 v151, v33, v11
    v_mfma_f32_16x16x32_bf16 v[252:255], a[20:23], a[84:87], v[252:255]
    buffer_load_dwordx4 a[20:23], v51, s[12:15], s28 offen offset:3072
    v_fma_f32 v34, v34, v22, v22
    s_waitcnt vmcnt(12) lgkmcnt(0)
    v_mfma_f32_16x16x32_bf16 v[160:163], a[24:27], a[88:91], v[160:163]
    v_fma_f32 v35, v35, v22, v22
    v_mfma_f32_16x16x32_bf16 v[164:167], a[24:27], a[92:95], v[164:167]
    ds_read_b128 a[72:75], v2 offset:14336
    v_fma_f32 v36, v36, v22, v22
    v_fma_f32 v37, v37, v22, v22
    v_mfma_f32_16x16x32_bf16 v[168:171], a[24:27], a[96:99], v[168:171]
    v_fma_f32 v38, v38, v23, v23
    v_mfma_f32_16x16x32_bf16 v[172:175], a[24:27], a[100:103], v[172:175]
    s_add_u32 s28, s28, 4096
    buffer_load_dwordx4 a[24:27], v46, s[12:15], s28 offen offset:0
    v_fma_f32 v39, v39, v23, v23
    v_mfma_f32_16x16x32_bf16 v[176:179], a[28:31], a[88:91], v[176:179]
    v_fma_f32 v40, v40, v23, v23
    v_mfma_f32_16x16x32_bf16 v[180:183], a[28:31], a[92:95], v[180:183]
    ds_read_b128 a[76:79], v2 offset:32768
    v_fma_f32 v41, v41, v23, v23
    v_rcp_f32 v34, v34
    v_mfma_f32_16x16x32_bf16 v[184:187], a[28:31], a[96:99], v[184:187]
    v_rcp_f32 v35, v35
    v_mfma_f32_16x16x32_bf16 v[188:191], a[28:31], a[100:103], v[188:191]
    buffer_load_dwordx4 a[28:31], v47, s[12:15], s28 offen offset:0
    v_rcp_f32 v36, v36
    v_mfma_f32_16x16x32_bf16 v[192:195], a[32:35], a[88:91], v[192:195]
    v_rcp_f32 v37, v37
    v_rcp_f32 v38, v38
    v_mfma_f32_16x16x32_bf16 v[196:199], a[32:35], a[92:95], v[196:199]
    ds_read_b128 a[80:83], v3 offset:14336
    v_rcp_f32 v39, v39
    v_mfma_f32_16x16x32_bf16 v[200:203], a[32:35], a[96:99], v[200:203]
    v_rcp_f32 v40, v40
    v_mfma_f32_16x16x32_bf16 v[204:207], a[32:35], a[100:103], v[204:207]
    buffer_load_dwordx4 a[32:35], v48, s[12:15], s28 offen offset:0
    v_rcp_f32 v41, v41
    v_mfma_f32_16x16x32_bf16 v[208:211], a[36:39], a[88:91], v[208:211]
    v_mul_f32 v144, v128, v144
    v_mul_f32 v145, v129, v145
    v_mfma_f32_16x16x32_bf16 v[212:215], a[36:39], a[92:95], v[212:215]
    ds_read_b128 a[84:87], v3 offset:32768
    v_mul_f32 v146, v130, v146
    v_mfma_f32_16x16x32_bf16 v[216:219], a[36:39], a[96:99], v[216:219]
    v_mul_f32 v147, v131, v147
    v_mfma_f32_16x16x32_bf16 v[220:223], a[36:39], a[100:103], v[220:223]
    buffer_load_dwordx4 a[36:39], v49, s[12:15], s28 offen offset:0
    v_mul_f32 v148, v132, v148
    v_mul_f32 v149, v133, v149
    v_mfma_f32_16x16x32_bf16 v[224:227], a[40:43], a[88:91], v[224:227]
    v_mul_f32 v150, v134, v150
    v_mfma_f32_16x16x32_bf16 v[228:231], a[40:43], a[92:95], v[228:231]
    v_mul_f32 v151, v135, v151
    v_mfma_f32_16x16x32_bf16 v[232:235], a[40:43], a[96:99], v[232:235]
    v_mul_f32 v34, v34, v144
    v_mfma_f32_16x16x32_bf16 v[236:239], a[40:43], a[100:103], v[236:239]
    buffer_load_dwordx4 a[40:43], v50, s[12:15], s28 offen offset:0
    v_mul_f32 v35, v35, v145
    v_mul_f32 v36, v36, v146
    v_mfma_f32_16x16x32_bf16 v[240:243], a[44:47], a[88:91], v[240:243]
    v_mul_f32 v37, v37, v147
    v_mfma_f32_16x16x32_bf16 v[244:247], a[44:47], a[92:95], v[244:247]
    v_mul_f32 v38, v38, v148
    v_mfma_f32_16x16x32_bf16 v[248:251], a[44:47], a[96:99], v[248:251]
    v_mul_f32 v39, v39, v149
    v_mul_f32 v40, v40, v150
    v_mfma_f32_16x16x32_bf16 v[252:255], a[44:47], a[100:103], v[252:255]
    buffer_load_dwordx4 a[44:47], v51, s[12:15], s28 offen offset:0
    v_mul_f32 v41, v41, v151
    s_waitcnt vmcnt(12) lgkmcnt(0)
    v_mfma_f32_16x16x32_bf16 v[160:163], a[48:51], a[72:75], v[160:163]
    v_cvt_pk_bf16_f32 v42, v34, v35
    v_mfma_f32_16x16x32_bf16 v[164:167], a[48:51], a[76:79], v[164:167]
    ds_read_b128 a[88:91], v2 offset:15360
    v_cvt_pk_bf16_f32 v43, v36, v37
    v_mfma_f32_16x16x32_bf16 v[168:171], a[48:51], a[80:83], v[168:171]
    v_cvt_pk_bf16_f32 v44, v38, v39
    v_cvt_pk_bf16_f32 v45, v40, v41
    v_mfma_f32_16x16x32_bf16 v[172:175], a[48:51], a[84:87], v[172:175]
    buffer_load_dwordx4 a[48:51], v46, s[12:15], s28 offen offset:1024
    ds_write_b64 v6, v[42:43] offset:1024
    v_mfma_f32_16x16x32_bf16 v[176:179], a[52:55], a[72:75], v[176:179]
    ds_write_b64 v6, v[44:45] offset:19456
    v_mfma_f32_16x16x32_bf16 v[180:183], a[52:55], a[76:79], v[180:183]
    ds_read_b128 a[92:95], v2 offset:33792
    v_fmac_f32 v136, v26, v12
    v_fmac_f32 v137, v27, v12
    v_mfma_f32_16x16x32_bf16 v[184:187], a[52:55], a[80:83], v[184:187]
    v_fmac_f32 v138, v28, v12
    v_mfma_f32_16x16x32_bf16 v[188:191], a[52:55], a[84:87], v[188:191]
    buffer_load_dwordx4 a[52:55], v47, s[12:15], s28 offen offset:1024
    v_fmac_f32 v139, v29, v12
    v_mfma_f32_16x16x32_bf16 v[192:195], a[56:59], a[72:75], v[192:195]
    v_fmac_f32 v140, v26, v13
    v_mfma_f32_16x16x32_bf16 v[196:199], a[56:59], a[76:79], v[196:199]
    ds_read_b128 a[96:99], v3 offset:15360
    v_fmac_f32 v141, v27, v13
    v_fmac_f32 v142, v28, v13
    v_mfma_f32_16x16x32_bf16 v[200:203], a[56:59], a[80:83], v[200:203]
    v_fmac_f32 v143, v29, v13
    v_mfma_f32_16x16x32_bf16 v[204:207], a[56:59], a[84:87], v[204:207]
    buffer_load_dwordx4 a[56:59], v48, s[12:15], s28 offen offset:1024
    v_mul_f32 v34, v136, v136
    v_mfma_f32_16x16x32_bf16 v[208:211], a[60:63], a[72:75], v[208:211]
    v_mul_f32 v35, v137, v137
    v_mul_f32 v36, v138, v138
    v_mfma_f32_16x16x32_bf16 v[212:215], a[60:63], a[76:79], v[212:215]
    ds_read_b128 a[100:103], v3 offset:33792
    v_mul_f32 v37, v139, v139
    v_mfma_f32_16x16x32_bf16 v[216:219], a[60:63], a[80:83], v[216:219]
    v_mul_f32 v38, v140, v140
    v_mfma_f32_16x16x32_bf16 v[220:223], a[60:63], a[84:87], v[220:223]
    buffer_load_dwordx4 a[60:63], v49, s[12:15], s28 offen offset:1024
    v_mul_f32 v39, v141, v141
    v_mfma_f32_16x16x32_bf16 v[224:227], a[64:67], a[72:75], v[224:227]
    v_mul_f32 v40, v142, v142
    v_mul_f32 v41, v143, v143
    v_mfma_f32_16x16x32_bf16 v[228:231], a[64:67], a[76:79], v[228:231]
    v_fma_f32 v34, v34, v16, v20
    v_mfma_f32_16x16x32_bf16 v[232:235], a[64:67], a[80:83], v[232:235]
    v_fma_f32 v35, v35, v16, v20
    v_mfma_f32_16x16x32_bf16 v[236:239], a[64:67], a[84:87], v[236:239]
    buffer_load_dwordx4 a[64:67], v50, s[12:15], s28 offen offset:1024
    v_fma_f32 v36, v36, v16, v20
    v_fma_f32 v37, v37, v16, v20
    v_mfma_f32_16x16x32_bf16 v[240:243], a[68:71], a[72:75], v[240:243]
    v_fma_f32 v38, v38, v17, v21
    v_mfma_f32_16x16x32_bf16 v[244:247], a[68:71], a[76:79], v[244:247]
    v_fma_f32 v39, v39, v17, v21
    v_mfma_f32_16x16x32_bf16 v[248:251], a[68:71], a[80:83], v[248:251]
    v_fma_f32 v40, v40, v17, v21
    v_mfma_f32_16x16x32_bf16 v[252:255], a[68:71], a[84:87], v[252:255]
    buffer_load_dwordx4 a[68:71], v51, s[12:15], s28 offen offset:1024
    v_fma_f32 v41, v41, v17, v21
    v_mul_f32 v34, v136, v34
    s_waitcnt vmcnt(12) lgkmcnt(0)
    v_mfma_f32_16x16x32_bf16 v[160:163], a[0:3], a[88:91], v[160:163]
    v_mul_f32 v35, v137, v35
    v_mfma_f32_16x16x32_bf16 v[164:167], a[0:3], a[92:95], v[164:167]
    ds_read_b128 a[72:75], v2 offset:16384
    v_mul_f32 v36, v138, v36
    v_mfma_f32_16x16x32_bf16 v[168:171], a[0:3], a[96:99], v[168:171]
    v_mul_f32 v37, v139, v37
    v_mul_f32 v38, v140, v38
    v_mfma_f32_16x16x32_bf16 v[172:175], a[0:3], a[100:103], v[172:175]
    s_add_u32 s28, s28, 425984
    buffer_load_dwordx4 a[0:3], v46, s[12:15], s28 offen offset:0
    v_mul_f32 v39, v141, v39
    v_mfma_f32_16x16x32_bf16 v[176:179], a[4:7], a[88:91], v[176:179]
    v_mul_f32 v40, v142, v40
    v_mfma_f32_16x16x32_bf16 v[180:183], a[4:7], a[92:95], v[180:183]
    ds_read_b128 a[76:79], v2 offset:34816
    v_mul_f32 v41, v143, v41
    v_mfma_f32_16x16x32_bf16 v[184:187], a[4:7], a[96:99], v[184:187]
    v_exp_f32 v34, v34
    v_exp_f32 v35, v35
    v_mfma_f32_16x16x32_bf16 v[188:191], a[4:7], a[100:103], v[188:191]
    buffer_load_dwordx4 a[4:7], v47, s[12:15], s28 offen offset:0
    v_exp_f32 v36, v36
    v_mfma_f32_16x16x32_bf16 v[192:195], a[8:11], a[88:91], v[192:195]
    v_exp_f32 v37, v37
    v_mfma_f32_16x16x32_bf16 v[196:199], a[8:11], a[92:95], v[196:199]
    ds_read_b128 a[80:83], v3 offset:16384
    v_exp_f32 v38, v38
    v_exp_f32 v39, v39
    v_mfma_f32_16x16x32_bf16 v[200:203], a[8:11], a[96:99], v[200:203]
    v_exp_f32 v40, v40
    v_mfma_f32_16x16x32_bf16 v[204:207], a[8:11], a[100:103], v[204:207]
    buffer_load_dwordx4 a[8:11], v48, s[12:15], s28 offen offset:0
    v_exp_f32 v41, v41
    v_mfma_f32_16x16x32_bf16 v[208:211], a[12:15], a[88:91], v[208:211]
    v_fmac_f32 v152, v30, v12
    v_mfma_f32_16x16x32_bf16 v[212:215], a[12:15], a[92:95], v[212:215]
    ds_read_b128 a[84:87], v3 offset:34816
    v_fmac_f32 v153, v31, v12
    v_fmac_f32 v154, v32, v12
    v_mfma_f32_16x16x32_bf16 v[216:219], a[12:15], a[96:99], v[216:219]
    v_fmac_f32 v155, v33, v12
    v_mfma_f32_16x16x32_bf16 v[220:223], a[12:15], a[100:103], v[220:223]
    buffer_load_dwordx4 a[12:15], v49, s[12:15], s28 offen offset:0
    v_fmac_f32 v156, v30, v13
    v_mfma_f32_16x16x32_bf16 v[224:227], a[16:19], a[88:91], v[224:227]
    v_fmac_f32 v157, v31, v13
    v_fmac_f32 v158, v32, v13
    v_mfma_f32_16x16x32_bf16 v[228:231], a[16:19], a[92:95], v[228:231]
    v_fmac_f32 v159, v33, v13
    v_mfma_f32_16x16x32_bf16 v[232:235], a[16:19], a[96:99], v[232:235]
    v_fma_f32 v34, v34, v24, v24
    v_mfma_f32_16x16x32_bf16 v[236:239], a[16:19], a[100:103], v[236:239]
    buffer_load_dwordx4 a[16:19], v50, s[12:15], s28 offen offset:0
    v_fma_f32 v35, v35, v24, v24
    v_mfma_f32_16x16x32_bf16 v[240:243], a[20:23], a[88:91], v[240:243]
    v_fma_f32 v36, v36, v24, v24
    v_fma_f32 v37, v37, v24, v24
    v_mfma_f32_16x16x32_bf16 v[244:247], a[20:23], a[92:95], v[244:247]
    v_fma_f32 v38, v38, v25, v25
    v_mfma_f32_16x16x32_bf16 v[248:251], a[20:23], a[96:99], v[248:251]
    v_fma_f32 v39, v39, v25, v25
    v_mfma_f32_16x16x32_bf16 v[252:255], a[20:23], a[100:103], v[252:255]
    buffer_load_dwordx4 a[20:23], v51, s[12:15], s28 offen offset:0
    v_fma_f32 v40, v40, v25, v25
    v_fma_f32 v41, v41, v25, v25
    s_waitcnt vmcnt(12) lgkmcnt(0)
    v_mfma_f32_16x16x32_bf16 v[160:163], a[24:27], a[72:75], v[160:163]
    v_rcp_f32 v34, v34
    v_mfma_f32_16x16x32_bf16 v[164:167], a[24:27], a[76:79], v[164:167]
    ds_read_b128 a[88:91], v2 offset:17408
    v_rcp_f32 v35, v35
    v_mfma_f32_16x16x32_bf16 v[168:171], a[24:27], a[80:83], v[168:171]
    v_rcp_f32 v36, v36
    v_mfma_f32_16x16x32_bf16 v[172:175], a[24:27], a[84:87], v[172:175]
    buffer_load_dwordx4 a[24:27], v46, s[12:15], s28 offen offset:1024
    v_rcp_f32 v37, v37
    v_rcp_f32 v38, v38
    v_mfma_f32_16x16x32_bf16 v[176:179], a[28:31], a[72:75], v[176:179]
    v_rcp_f32 v39, v39
    v_mfma_f32_16x16x32_bf16 v[180:183], a[28:31], a[76:79], v[180:183]
    ds_read_b128 a[92:95], v2 offset:35840
    v_rcp_f32 v40, v40
    v_mfma_f32_16x16x32_bf16 v[184:187], a[28:31], a[80:83], v[184:187]
    v_rcp_f32 v41, v41
    v_mul_f32 v152, v136, v152
    v_mfma_f32_16x16x32_bf16 v[188:191], a[28:31], a[84:87], v[188:191]
    buffer_load_dwordx4 a[28:31], v47, s[12:15], s28 offen offset:1024
    v_mul_f32 v153, v137, v153
    v_mfma_f32_16x16x32_bf16 v[192:195], a[32:35], a[72:75], v[192:195]
    v_mul_f32 v154, v138, v154
    v_mfma_f32_16x16x32_bf16 v[196:199], a[32:35], a[76:79], v[196:199]
    ds_read_b128 a[96:99], v3 offset:17408
    v_mul_f32 v155, v139, v155
    v_mfma_f32_16x16x32_bf16 v[200:203], a[32:35], a[80:83], v[200:203]
    v_mul_f32 v156, v140, v156
    v_mul_f32 v157, v141, v157
    v_mfma_f32_16x16x32_bf16 v[204:207], a[32:35], a[84:87], v[204:207]
    buffer_load_dwordx4 a[32:35], v48, s[12:15], s28 offen offset:1024
    v_mul_f32 v158, v142, v158
    v_mfma_f32_16x16x32_bf16 v[208:211], a[36:39], a[72:75], v[208:211]
    v_mul_f32 v159, v143, v159
    v_mfma_f32_16x16x32_bf16 v[212:215], a[36:39], a[76:79], v[212:215]
    ds_read_b128 a[100:103], v3 offset:35840
    v_mul_f32 v34, v34, v152
    v_mul_f32 v35, v35, v153
    v_mfma_f32_16x16x32_bf16 v[216:219], a[36:39], a[80:83], v[216:219]
    v_mul_f32 v36, v36, v154
    v_mfma_f32_16x16x32_bf16 v[220:223], a[36:39], a[84:87], v[220:223]
    buffer_load_dwordx4 a[36:39], v49, s[12:15], s28 offen offset:1024
    v_mul_f32 v37, v37, v155
    v_mfma_f32_16x16x32_bf16 v[224:227], a[40:43], a[72:75], v[224:227]
    v_mul_f32 v38, v38, v156
    v_mfma_f32_16x16x32_bf16 v[228:231], a[40:43], a[76:79], v[228:231]
    v_mul_f32 v39, v39, v157
    v_mul_f32 v40, v40, v158
    v_mfma_f32_16x16x32_bf16 v[232:235], a[40:43], a[80:83], v[232:235]
    v_mul_f32 v41, v41, v159
    v_mfma_f32_16x16x32_bf16 v[236:239], a[40:43], a[84:87], v[236:239]
    buffer_load_dwordx4 a[40:43], v50, s[12:15], s28 offen offset:1024
    v_cvt_pk_bf16_f32 v42, v34, v35
    v_mfma_f32_16x16x32_bf16 v[240:243], a[44:47], a[72:75], v[240:243]
    v_cvt_pk_bf16_f32 v43, v36, v37
    v_cvt_pk_bf16_f32 v44, v38, v39
    v_mfma_f32_16x16x32_bf16 v[244:247], a[44:47], a[76:79], v[244:247]
    v_cvt_pk_bf16_f32 v45, v40, v41
    v_mfma_f32_16x16x32_bf16 v[248:251], a[44:47], a[80:83], v[248:251]
    ds_write_b64 v9, v[42:43] offset:1024
    v_mfma_f32_16x16x32_bf16 v[252:255], a[44:47], a[84:87], v[252:255]
    buffer_load_dwordx4 a[44:47], v51, s[12:15], s28 offen offset:1024
    ds_write_b64 v9, v[44:45] offset:19456
    s_waitcnt vmcnt(12) lgkmcnt(2)
    v_mfma_f32_16x16x32_bf16 v[160:163], a[48:51], a[88:91], v[160:163]
    v_mfma_f32_16x16x32_bf16 v[164:167], a[48:51], a[92:95], v[164:167]
    ds_read_b128 a[72:75], v2 offset:0
    v_mfma_f32_16x16x32_bf16 v[168:171], a[48:51], a[96:99], v[168:171]
    v_mfma_f32_16x16x32_bf16 v[172:175], a[48:51], a[100:103], v[172:175]
    buffer_load_dwordx4 a[48:51], v46, s[12:15], s28 offen offset:2048
    v_mfma_f32_16x16x32_bf16 v[176:179], a[52:55], a[88:91], v[176:179]
    v_mfma_f32_16x16x32_bf16 v[180:183], a[52:55], a[92:95], v[180:183]
    ds_read_b128 a[76:79], v2 offset:18432
    v_mfma_f32_16x16x32_bf16 v[184:187], a[52:55], a[96:99], v[184:187]
    v_mfma_f32_16x16x32_bf16 v[188:191], a[52:55], a[100:103], v[188:191]
    buffer_load_dwordx4 a[52:55], v47, s[12:15], s28 offen offset:2048
    v_mfma_f32_16x16x32_bf16 v[192:195], a[56:59], a[88:91], v[192:195]
    v_mfma_f32_16x16x32_bf16 v[196:199], a[56:59], a[92:95], v[196:199]
    ds_read_b128 a[80:83], v3 offset:0
    v_mfma_f32_16x16x32_bf16 v[200:203], a[56:59], a[96:99], v[200:203]
    v_mfma_f32_16x16x32_bf16 v[204:207], a[56:59], a[100:103], v[204:207]
    buffer_load_dwordx4 a[56:59], v48, s[12:15], s28 offen offset:2048
    v_mfma_f32_16x16x32_bf16 v[208:211], a[60:63], a[88:91], v[208:211]
    v_mfma_f32_16x16x32_bf16 v[212:215], a[60:63], a[92:95], v[212:215]
    ds_read_b128 a[84:87], v3 offset:18432
    v_mfma_f32_16x16x32_bf16 v[216:219], a[60:63], a[96:99], v[216:219]
    v_mfma_f32_16x16x32_bf16 v[220:223], a[60:63], a[100:103], v[220:223]
    buffer_load_dwordx4 a[60:63], v49, s[12:15], s28 offen offset:2048
    v_mfma_f32_16x16x32_bf16 v[224:227], a[64:67], a[88:91], v[224:227]
    v_mfma_f32_16x16x32_bf16 v[228:231], a[64:67], a[92:95], v[228:231]
    v_mfma_f32_16x16x32_bf16 v[232:235], a[64:67], a[96:99], v[232:235]
    v_mfma_f32_16x16x32_bf16 v[236:239], a[64:67], a[100:103], v[236:239]
    buffer_load_dwordx4 a[64:67], v50, s[12:15], s28 offen offset:2048
    v_mfma_f32_16x16x32_bf16 v[240:243], a[68:71], a[88:91], v[240:243]
    v_mfma_f32_16x16x32_bf16 v[244:247], a[68:71], a[92:95], v[244:247]
    v_mfma_f32_16x16x32_bf16 v[248:251], a[68:71], a[96:99], v[248:251]
    v_mfma_f32_16x16x32_bf16 v[252:255], a[68:71], a[100:103], v[252:255]
    buffer_load_dwordx4 a[68:71], v51, s[12:15], s28 offen offset:2048
    s_waitcnt vmcnt(12) lgkmcnt(0)
    v_mfma_f32_16x16x32_bf16 v[64:67], a[0:3], a[72:75], 0
    ds_read_b128 v[26:29], v8 offset:1536
    ds_read_b128 v[30:33], v8 offset:1552
    v_mfma_f32_16x16x32_bf16 v[68:71], a[0:3], a[76:79], 0
    ds_read_b128 a[88:91], v2 offset:1024
    s_waitcnt lgkmcnt(1)
    v_mfma_f32_16x16x32_bf16 v[72:75], a[0:3], a[80:83], 0
    v_fmac_f32 v160, v26, v10
    v_fmac_f32 v161, v27, v10
    v_mfma_f32_16x16x32_bf16 v[76:79], a[0:3], a[84:87], 0
    buffer_load_dwordx4 a[0:3], v46, s[12:15], s28 offen offset:3072
    v_fmac_f32 v162, v28, v10
    v_mfma_f32_16x16x32_bf16 v[80:83], a[4:7], a[72:75], 0
    v_fmac_f32 v163, v29, v10
    v_mfma_f32_16x16x32_bf16 v[84:87], a[4:7], a[76:79], 0
    ds_read_b128 a[92:95], v2 offset:19456
    v_fmac_f32 v164, v26, v11
    v_fmac_f32 v165, v27, v11
    v_mfma_f32_16x16x32_bf16 v[88:91], a[4:7], a[80:83], 0
    v_fmac_f32 v166, v28, v11
    v_mfma_f32_16x16x32_bf16 v[92:95], a[4:7], a[84:87], 0
    buffer_load_dwordx4 a[4:7], v47, s[12:15], s28 offen offset:3072
    v_fmac_f32 v167, v29, v11
    v_mfma_f32_16x16x32_bf16 v[96:99], a[8:11], a[72:75], 0
    v_mul_f32 v34, v160, v160
    v_mul_f32 v35, v161, v161
    v_mfma_f32_16x16x32_bf16 v[100:103], a[8:11], a[76:79], 0
    ds_read_b128 a[96:99], v3 offset:1024
    v_mul_f32 v36, v162, v162
    v_mfma_f32_16x16x32_bf16 v[104:107], a[8:11], a[80:83], 0
    v_mul_f32 v37, v163, v163
    v_mul_f32 v38, v164, v164
    v_mfma_f32_16x16x32_bf16 v[108:111], a[8:11], a[84:87], 0
    buffer_load_dwordx4 a[8:11], v48, s[12:15], s28 offen offset:3072
    v_mul_f32 v39, v165, v165
    v_mfma_f32_16x16x32_bf16 v[112:115], a[12:15], a[72:75], 0
    v_mul_f32 v40, v166, v166
    v_mfma_f32_16x16x32_bf16 v[116:119], a[12:15], a[76:79], 0
    ds_read_b128 a[100:103], v3 offset:19456
    v_mul_f32 v41, v167, v167
    v_fma_f32 v34, v34, v14, v18
    v_mfma_f32_16x16x32_bf16 v[120:123], a[12:15], a[80:83], 0
    v_fma_f32 v35, v35, v14, v18
    v_mfma_f32_16x16x32_bf16 v[124:127], a[12:15], a[84:87], 0
    buffer_load_dwordx4 a[12:15], v49, s[12:15], s28 offen offset:3072
    v_fma_f32 v36, v36, v14, v18
    v_mfma_f32_16x16x32_bf16 v[128:131], a[16:19], a[72:75], 0
    v_fma_f32 v37, v37, v14, v18
    v_fma_f32 v38, v38, v15, v19
    v_mfma_f32_16x16x32_bf16 v[132:135], a[16:19], a[76:79], 0
    v_fma_f32 v39, v39, v15, v19
    v_mfma_f32_16x16x32_bf16 v[136:139], a[16:19], a[80:83], 0
    v_fma_f32 v40, v40, v15, v19
    v_mfma_f32_16x16x32_bf16 v[140:143], a[16:19], a[84:87], 0
    buffer_load_dwordx4 a[16:19], v50, s[12:15], s28 offen offset:3072
    v_fma_f32 v41, v41, v15, v19
    v_mul_f32 v34, v160, v34
    v_mfma_f32_16x16x32_bf16 v[144:147], a[20:23], a[72:75], 0
    v_mul_f32 v35, v161, v35
    v_mfma_f32_16x16x32_bf16 v[148:151], a[20:23], a[76:79], 0
    v_mul_f32 v36, v162, v36
    v_mul_f32 v37, v163, v37
    v_mfma_f32_16x16x32_bf16 v[152:155], a[20:23], a[80:83], 0
    v_mul_f32 v38, v164, v38
    v_mfma_f32_16x16x32_bf16 v[156:159], a[20:23], a[84:87], 0
    buffer_load_dwordx4 a[20:23], v51, s[12:15], s28 offen offset:3072
    v_mul_f32 v39, v165, v39
    s_waitcnt vmcnt(12) lgkmcnt(0)
    v_mfma_f32_16x16x32_bf16 v[64:67], a[24:27], a[88:91], v[64:67]
    v_mul_f32 v40, v166, v40
    v_mul_f32 v41, v167, v41
    v_mfma_f32_16x16x32_bf16 v[68:71], a[24:27], a[92:95], v[68:71]
    ds_read_b128 a[72:75], v2 offset:2048
    v_exp_f32 v34, v34
    v_mfma_f32_16x16x32_bf16 v[72:75], a[24:27], a[96:99], v[72:75]
    v_exp_f32 v35, v35
    v_mfma_f32_16x16x32_bf16 v[76:79], a[24:27], a[100:103], v[76:79]
    s_add_u32 s28, s28, 4096
    buffer_load_dwordx4 a[24:27], v46, s[12:15], s28 offen offset:0
    v_exp_f32 v36, v36
    v_exp_f32 v37, v37
    v_mfma_f32_16x16x32_bf16 v[80:83], a[28:31], a[88:91], v[80:83]
    v_exp_f32 v38, v38
    v_mfma_f32_16x16x32_bf16 v[84:87], a[28:31], a[92:95], v[84:87]
    ds_read_b128 a[76:79], v2 offset:20480
    v_exp_f32 v39, v39
    v_exp_f32 v40, v40
    v_mfma_f32_16x16x32_bf16 v[88:91], a[28:31], a[96:99], v[88:91]
    v_exp_f32 v41, v41
    v_mfma_f32_16x16x32_bf16 v[92:95], a[28:31], a[100:103], v[92:95]
    buffer_load_dwordx4 a[28:31], v47, s[12:15], s28 offen offset:0
    v_fmac_f32 v176, v30, v10
    v_mfma_f32_16x16x32_bf16 v[96:99], a[32:35], a[88:91], v[96:99]
    v_fmac_f32 v177, v31, v10
    v_fmac_f32 v178, v32, v10
    v_mfma_f32_16x16x32_bf16 v[100:103], a[32:35], a[92:95], v[100:103]
    ds_read_b128 a[80:83], v3 offset:2048
    v_fmac_f32 v179, v33, v10
    v_mfma_f32_16x16x32_bf16 v[104:107], a[32:35], a[96:99], v[104:107]
    v_fmac_f32 v180, v30, v11
    v_mfma_f32_16x16x32_bf16 v[108:111], a[32:35], a[100:103], v[108:111]
    buffer_load_dwordx4 a[32:35], v48, s[12:15], s28 offen offset:0
    v_fmac_f32 v181, v31, v11
    v_fmac_f32 v182, v32, v11
    v_mfma_f32_16x16x32_bf16 v[112:115], a[36:39], a[88:91], v[112:115]
    v_fmac_f32 v183, v33, v11
    v_mfma_f32_16x16x32_bf16 v[116:119], a[36:39], a[92:95], v[116:119]
    ds_read_b128 a[84:87], v3 offset:20480
    v_fma_f32 v34, v34, v22, v22
    v_mfma_f32_16x16x32_bf16 v[120:123], a[36:39], a[96:99], v[120:123]
    v_fma_f32 v35, v35, v22, v22
    v_fma_f32 v36, v36, v22, v22
    v_mfma_f32_16x16x32_bf16 v[124:127], a[36:39], a[100:103], v[124:127]
    buffer_load_dwordx4 a[36:39], v49, s[12:15], s28 offen offset:0
    v_fma_f32 v37, v37, v22, v22
    v_mfma_f32_16x16x32_bf16 v[128:131], a[40:43], a[88:91], v[128:131]
    v_fma_f32 v38, v38, v23, v23
    v_fma_f32 v39, v39, v23, v23
    v_mfma_f32_16x16x32_bf16 v[132:135], a[40:43], a[92:95], v[132:135]
    v_fma_f32 v40, v40, v23, v23
    v_mfma_f32_16x16x32_bf16 v[136:139], a[40:43], a[96:99], v[136:139]
    v_fma_f32 v41, v41, v23, v23
    v_mfma_f32_16x16x32_bf16 v[140:143], a[40:43], a[100:103], v[140:143]
    buffer_load_dwordx4 a[40:43], v50, s[12:15], s28 offen offset:0
    v_rcp_f32 v34, v34
    v_rcp_f32 v35, v35
    v_mfma_f32_16x16x32_bf16 v[144:147], a[44:47], a[88:91], v[144:147]
    v_rcp_f32 v36, v36
    v_mfma_f32_16x16x32_bf16 v[148:151], a[44:47], a[92:95], v[148:151]
    v_rcp_f32 v37, v37
    v_mfma_f32_16x16x32_bf16 v[152:155], a[44:47], a[96:99], v[152:155]
    v_rcp_f32 v38, v38
    v_rcp_f32 v39, v39
    v_mfma_f32_16x16x32_bf16 v[156:159], a[44:47], a[100:103], v[156:159]
    buffer_load_dwordx4 a[44:47], v51, s[12:15], s28 offen offset:0
    v_rcp_f32 v40, v40
    s_waitcnt vmcnt(12) lgkmcnt(0)
    v_mfma_f32_16x16x32_bf16 v[64:67], a[48:51], a[72:75], v[64:67]
    v_rcp_f32 v41, v41
    v_mfma_f32_16x16x32_bf16 v[68:71], a[48:51], a[76:79], v[68:71]
    ds_read_b128 a[88:91], v2 offset:3072
    v_mul_f32 v176, v160, v176
    v_mul_f32 v177, v161, v177
    v_mfma_f32_16x16x32_bf16 v[72:75], a[48:51], a[80:83], v[72:75]
    v_mul_f32 v178, v162, v178
    v_mfma_f32_16x16x32_bf16 v[76:79], a[48:51], a[84:87], v[76:79]
    buffer_load_dwordx4 a[48:51], v46, s[12:15], s28 offen offset:1024
    v_mul_f32 v179, v163, v179
    v_mul_f32 v180, v164, v180
    v_mfma_f32_16x16x32_bf16 v[80:83], a[52:55], a[72:75], v[80:83]
    v_mul_f32 v181, v165, v181
    v_mfma_f32_16x16x32_bf16 v[84:87], a[52:55], a[76:79], v[84:87]
    ds_read_b128 a[92:95], v2 offset:21504
    v_mul_f32 v182, v166, v182
    v_mfma_f32_16x16x32_bf16 v[88:91], a[52:55], a[80:83], v[88:91]
    v_mul_f32 v183, v167, v183
    v_mul_f32 v34, v34, v176
    v_mfma_f32_16x16x32_bf16 v[92:95], a[52:55], a[84:87], v[92:95]
    buffer_load_dwordx4 a[52:55], v47, s[12:15], s28 offen offset:1024
    v_mul_f32 v35, v35, v177
    v_mfma_f32_16x16x32_bf16 v[96:99], a[56:59], a[72:75], v[96:99]
    v_mul_f32 v36, v36, v178
    v_mfma_f32_16x16x32_bf16 v[100:103], a[56:59], a[76:79], v[100:103]
    ds_read_b128 a[96:99], v3 offset:3072
    v_mul_f32 v37, v37, v179
    v_mul_f32 v38, v38, v180
    v_mfma_f32_16x16x32_bf16 v[104:107], a[56:59], a[80:83], v[104:107]
    v_mul_f32 v39, v39, v181
    v_mfma_f32_16x16x32_bf16 v[108:111], a[56:59], a[84:87], v[108:111]
    buffer_load_dwordx4 a[56:59], v48, s[12:15], s28 offen offset:1024
    v_mul_f32 v40, v40, v182
    v_mul_f32 v41, v41, v183
    v_mfma_f32_16x16x32_bf16 v[112:115], a[60:63], a[72:75], v[112:115]
    v_cvt_pk_bf16_f32 v42, v34, v35
    v_mfma_f32_16x16x32_bf16 v[116:119], a[60:63], a[76:79], v[116:119]
    ds_read_b128 a[100:103], v3 offset:21504
    v_cvt_pk_bf16_f32 v43, v36, v37
    v_mfma_f32_16x16x32_bf16 v[120:123], a[60:63], a[80:83], v[120:123]
    v_cvt_pk_bf16_f32 v44, v38, v39
    v_cvt_pk_bf16_f32 v45, v40, v41
    v_mfma_f32_16x16x32_bf16 v[124:127], a[60:63], a[84:87], v[124:127]
    buffer_load_dwordx4 a[60:63], v49, s[12:15], s28 offen offset:1024
    ds_write_b64 v6, v[42:43] offset:6144
    v_mfma_f32_16x16x32_bf16 v[128:131], a[64:67], a[72:75], v[128:131]
    ds_write_b64 v6, v[44:45] offset:24576
    v_mfma_f32_16x16x32_bf16 v[132:135], a[64:67], a[76:79], v[132:135]
    v_fmac_f32 v168, v26, v12
    v_fmac_f32 v169, v27, v12
    v_mfma_f32_16x16x32_bf16 v[136:139], a[64:67], a[80:83], v[136:139]
    v_fmac_f32 v170, v28, v12
    v_mfma_f32_16x16x32_bf16 v[140:143], a[64:67], a[84:87], v[140:143]
    buffer_load_dwordx4 a[64:67], v50, s[12:15], s28 offen offset:1024
    v_fmac_f32 v171, v29, v12
    v_mfma_f32_16x16x32_bf16 v[144:147], a[68:71], a[72:75], v[144:147]
    v_fmac_f32 v172, v26, v13
    v_fmac_f32 v173, v27, v13
    v_mfma_f32_16x16x32_bf16 v[148:151], a[68:71], a[76:79], v[148:151]
    v_fmac_f32 v174, v28, v13
    v_mfma_f32_16x16x32_bf16 v[152:155], a[68:71], a[80:83], v[152:155]
    v_fmac_f32 v175, v29, v13
    v_mul_f32 v34, v168, v168
    v_mfma_f32_16x16x32_bf16 v[156:159], a[68:71], a[84:87], v[156:159]
    buffer_load_dwordx4 a[68:71], v51, s[12:15], s28 offen offset:1024
    v_mul_f32 v35, v169, v169
    s_waitcnt vmcnt(12) lgkmcnt(2)
    v_mfma_f32_16x16x32_bf16 v[64:67], a[0:3], a[88:91], v[64:67]
    v_mul_f32 v36, v170, v170
    v_mfma_f32_16x16x32_bf16 v[68:71], a[0:3], a[92:95], v[68:71]
    ds_read_b128 a[72:75], v2 offset:4096
    v_mul_f32 v37, v171, v171
    v_mul_f32 v38, v172, v172
    v_mfma_f32_16x16x32_bf16 v[72:75], a[0:3], a[96:99], v[72:75]
    v_mul_f32 v39, v173, v173
    v_mfma_f32_16x16x32_bf16 v[76:79], a[0:3], a[100:103], v[76:79]
    buffer_load_dwordx4 a[0:3], v46, s[12:15], s28 offen offset:2048
    v_mul_f32 v40, v174, v174
    v_mfma_f32_16x16x32_bf16 v[80:83], a[4:7], a[88:91], v[80:83]
    v_mul_f32 v41, v175, v175
    v_fma_f32 v34, v34, v16, v20
    v_mfma_f32_16x16x32_bf16 v[84:87], a[4:7], a[92:95], v[84:87]
    ds_read_b128 a[76:79], v2 offset:22528
    v_fma_f32 v35, v35, v16, v20
    v_mfma_f32_16x16x32_bf16 v[88:91], a[4:7], a[96:99], v[88:91]
    v_fma_f32 v36, v36, v16, v20
    v_fma_f32 v37, v37, v16, v20
    v_mfma_f32_16x16x32_bf16 v[92:95], a[4:7], a[100:103], v[92:95]
    buffer_load_dwordx4 a[4:7], v47, s[12:15], s28 offen offset:2048
    v_fma_f32 v38, v38, v17, v21
    v_mfma_f32_16x16x32_bf16 v[96:99], a[8:11], a[88:91], v[96:99]
    v_fma_f32 v39, v39, v17, v21
    v_mfma_f32_16x16x32_bf16 v[100:103], a[8:11], a[92:95], v[100:103]
    ds_read_b128 a[80:83], v3 offset:4096
    v_fma_f32 v40, v40, v17, v21
    v_fma_f32 v41, v41, v17, v21
    v_mfma_f32_16x16x32_bf16 v[104:107], a[8:11], a[96:99], v[104:107]
    v_mul_f32 v34, v168, v34
    v_mfma_f32_16x16x32_bf16 v[108:111], a[8:11], a[100:103], v[108:111]
    buffer_load_dwordx4 a[8:11], v48, s[12:15], s28 offen offset:2048
    v_mul_f32 v35, v169, v35
    v_mfma_f32_16x16x32_bf16 v[112:115], a[12:15], a[88:91], v[112:115]
    v_mul_f32 v36, v170, v36
    v_mul_f32 v37, v171, v37
    v_mfma_f32_16x16x32_bf16 v[116:119], a[12:15], a[92:95], v[116:119]
    ds_read_b128 a[84:87], v3 offset:22528
    v_mul_f32 v38, v172, v38
    v_mfma_f32_16x16x32_bf16 v[120:123], a[12:15], a[96:99], v[120:123]
    v_mul_f32 v39, v173, v39
    v_mfma_f32_16x16x32_bf16 v[124:127], a[12:15], a[100:103], v[124:127]
    buffer_load_dwordx4 a[12:15], v49, s[12:15], s28 offen offset:2048
    v_mul_f32 v40, v174, v40
    v_mul_f32 v41, v175, v41
    v_mfma_f32_16x16x32_bf16 v[128:131], a[16:19], a[88:91], v[128:131]
    v_exp_f32 v34, v34
    v_mfma_f32_16x16x32_bf16 v[132:135], a[16:19], a[92:95], v[132:135]
    v_exp_f32 v35, v35
    v_exp_f32 v36, v36
    v_mfma_f32_16x16x32_bf16 v[136:139], a[16:19], a[96:99], v[136:139]
    v_exp_f32 v37, v37
    v_mfma_f32_16x16x32_bf16 v[140:143], a[16:19], a[100:103], v[140:143]
    buffer_load_dwordx4 a[16:19], v50, s[12:15], s28 offen offset:2048
    v_exp_f32 v38, v38
    v_mfma_f32_16x16x32_bf16 v[144:147], a[20:23], a[88:91], v[144:147]
    v_exp_f32 v39, v39
    v_exp_f32 v40, v40
    v_mfma_f32_16x16x32_bf16 v[148:151], a[20:23], a[92:95], v[148:151]
    v_exp_f32 v41, v41
    v_mfma_f32_16x16x32_bf16 v[152:155], a[20:23], a[96:99], v[152:155]
    v_fmac_f32 v184, v30, v12
    v_mfma_f32_16x16x32_bf16 v[156:159], a[20:23], a[100:103], v[156:159]
    buffer_load_dwordx4 a[20:23], v51, s[12:15], s28 offen offset:2048
    v_fmac_f32 v185, v31, v12
    v_fmac_f32 v186, v32, v12
    s_waitcnt vmcnt(12) lgkmcnt(0)
    v_mfma_f32_16x16x32_bf16 v[64:67], a[24:27], a[72:75], v[64:67]
    v_fmac_f32 v187, v33, v12
    v_mfma_f32_16x16x32_bf16 v[68:71], a[24:27], a[76:79], v[68:71]
    ds_read_b128 a[88:91], v2 offset:5120
    v_fmac_f32 v188, v30, v13
    v_mfma_f32_16x16x32_bf16 v[72:75], a[24:27], a[80:83], v[72:75]
    v_fmac_f32 v189, v31, v13
    v_fmac_f32 v190, v32, v13
    v_mfma_f32_16x16x32_bf16 v[76:79], a[24:27], a[84:87], v[76:79]
    buffer_load_dwordx4 a[24:27], v46, s[12:15], s28 offen offset:3072
    v_fmac_f32 v191, v33, v13
    v_mfma_f32_16x16x32_bf16 v[80:83], a[28:31], a[72:75], v[80:83]
    v_fma_f32 v34, v34, v24, v24
    v_fma_f32 v35, v35, v24, v24
    v_mfma_f32_16x16x32_bf16 v[84:87], a[28:31], a[76:79], v[84:87]
    ds_read_b128 a[92:95], v2 offset:23552
    v_fma_f32 v36, v36, v24, v24
    v_mfma_f32_16x16x32_bf16 v[88:91], a[28:31], a[80:83], v[88:91]
    v_fma_f32 v37, v37, v24, v24
    v_mfma_f32_16x16x32_bf16 v[92:95], a[28:31], a[84:87], v[92:95]
    buffer_load_dwordx4 a[28:31], v47, s[12:15], s28 offen offset:3072
    v_fma_f32 v38, v38, v25, v25
    v_fma_f32 v39, v39, v25, v25
    v_mfma_f32_16x16x32_bf16 v[96:99], a[32:35], a[72:75], v[96:99]
    v_fma_f32 v40, v40, v25, v25
    v_mfma_f32_16x16x32_bf16 v[100:103], a[32:35], a[76:79], v[100:103]
    ds_read_b128 a[96:99], v3 offset:5120
    v_fma_f32 v41, v41, v25, v25
    v_mfma_f32_16x16x32_bf16 v[104:107], a[32:35], a[80:83], v[104:107]
    v_rcp_f32 v34, v34
    v_rcp_f32 v35, v35
    v_mfma_f32_16x16x32_bf16 v[108:111], a[32:35], a[84:87], v[108:111]
    buffer_load_dwordx4 a[32:35], v48, s[12:15], s28 offen offset:3072
    v_rcp_f32 v36, v36
    v_mfma_f32_16x16x32_bf16 v[112:115], a[36:39], a[72:75], v[112:115]
    v_rcp_f32 v37, v37
    v_rcp_f32 v38, v38
    v_mfma_f32_16x16x32_bf16 v[116:119], a[36:39], a[76:79], v[116:119]
    ds_read_b128 a[100:103], v3 offset:23552
    v_rcp_f32 v39, v39
    v_mfma_f32_16x16x32_bf16 v[120:123], a[36:39], a[80:83], v[120:123]
    v_rcp_f32 v40, v40
    v_mfma_f32_16x16x32_bf16 v[124:127], a[36:39], a[84:87], v[124:127]
    buffer_load_dwordx4 a[36:39], v49, s[12:15], s28 offen offset:3072
    v_rcp_f32 v41, v41
    v_mul_f32 v184, v168, v184
    v_mfma_f32_16x16x32_bf16 v[128:131], a[40:43], a[72:75], v[128:131]
    v_mul_f32 v185, v169, v185
    v_mfma_f32_16x16x32_bf16 v[132:135], a[40:43], a[76:79], v[132:135]
    v_mul_f32 v186, v170, v186
    v_mfma_f32_16x16x32_bf16 v[136:139], a[40:43], a[80:83], v[136:139]
    v_mul_f32 v187, v171, v187
    v_mul_f32 v188, v172, v188
    v_mfma_f32_16x16x32_bf16 v[140:143], a[40:43], a[84:87], v[140:143]
    buffer_load_dwordx4 a[40:43], v50, s[12:15], s28 offen offset:3072
    v_mul_f32 v189, v173, v189
    v_mfma_f32_16x16x32_bf16 v[144:147], a[44:47], a[72:75], v[144:147]
    v_mul_f32 v190, v174, v190
    v_mfma_f32_16x16x32_bf16 v[148:151], a[44:47], a[76:79], v[148:151]
    v_mul_f32 v191, v175, v191
    v_mul_f32 v34, v34, v184
    v_mfma_f32_16x16x32_bf16 v[152:155], a[44:47], a[80:83], v[152:155]
    v_mul_f32 v35, v35, v185
    v_mfma_f32_16x16x32_bf16 v[156:159], a[44:47], a[84:87], v[156:159]
    buffer_load_dwordx4 a[44:47], v51, s[12:15], s28 offen offset:3072
    v_mul_f32 v36, v36, v186
    v_mul_f32 v37, v37, v187
    s_waitcnt vmcnt(12) lgkmcnt(0)
    v_mfma_f32_16x16x32_bf16 v[64:67], a[48:51], a[88:91], v[64:67]
    v_mul_f32 v38, v38, v188
    v_mfma_f32_16x16x32_bf16 v[68:71], a[48:51], a[92:95], v[68:71]
    ds_read_b128 a[72:75], v2 offset:6144
    v_mul_f32 v39, v39, v189
    v_mfma_f32_16x16x32_bf16 v[72:75], a[48:51], a[96:99], v[72:75]
    v_mul_f32 v40, v40, v190
    v_mul_f32 v41, v41, v191
    v_mfma_f32_16x16x32_bf16 v[76:79], a[48:51], a[100:103], v[76:79]
    s_add_u32 s28, s28, 4096
    buffer_load_dwordx4 a[48:51], v46, s[12:15], s28 offen offset:0
    v_cvt_pk_bf16_f32 v42, v34, v35
    v_mfma_f32_16x16x32_bf16 v[80:83], a[52:55], a[88:91], v[80:83]
    v_cvt_pk_bf16_f32 v43, v36, v37
    v_mfma_f32_16x16x32_bf16 v[84:87], a[52:55], a[92:95], v[84:87]
    ds_read_b128 a[76:79], v2 offset:24576
    v_cvt_pk_bf16_f32 v44, v38, v39
    v_cvt_pk_bf16_f32 v45, v40, v41
    v_mfma_f32_16x16x32_bf16 v[88:91], a[52:55], a[96:99], v[88:91]
    ds_write_b64 v9, v[42:43] offset:6144
    v_mfma_f32_16x16x32_bf16 v[92:95], a[52:55], a[100:103], v[92:95]
    buffer_load_dwordx4 a[52:55], v47, s[12:15], s28 offen offset:0
    ds_write_b64 v9, v[44:45] offset:24576
    v_mfma_f32_16x16x32_bf16 v[96:99], a[56:59], a[88:91], v[96:99]
    ds_read_b128 v[26:29], v8 offset:1664
    ds_read_b128 v[30:33], v8 offset:1680
    v_mfma_f32_16x16x32_bf16 v[100:103], a[56:59], a[92:95], v[100:103]
    ds_read_b128 a[80:83], v3 offset:6144
    s_waitcnt lgkmcnt(1)
    v_mfma_f32_16x16x32_bf16 v[104:107], a[56:59], a[96:99], v[104:107]
    v_fmac_f32 v192, v26, v10
    v_fmac_f32 v193, v27, v10
    v_mfma_f32_16x16x32_bf16 v[108:111], a[56:59], a[100:103], v[108:111]
    buffer_load_dwordx4 a[56:59], v48, s[12:15], s28 offen offset:0
    v_fmac_f32 v194, v28, v10
    v_mfma_f32_16x16x32_bf16 v[112:115], a[60:63], a[88:91], v[112:115]
    v_fmac_f32 v195, v29, v10
    v_mfma_f32_16x16x32_bf16 v[116:119], a[60:63], a[92:95], v[116:119]
    ds_read_b128 a[84:87], v3 offset:24576
    v_fmac_f32 v196, v26, v11
    v_fmac_f32 v197, v27, v11
    v_mfma_f32_16x16x32_bf16 v[120:123], a[60:63], a[96:99], v[120:123]
    v_fmac_f32 v198, v28, v11
    v_mfma_f32_16x16x32_bf16 v[124:127], a[60:63], a[100:103], v[124:127]
    buffer_load_dwordx4 a[60:63], v49, s[12:15], s28 offen offset:0
    v_fmac_f32 v199, v29, v11
    v_mfma_f32_16x16x32_bf16 v[128:131], a[64:67], a[88:91], v[128:131]
    v_mul_f32 v34, v192, v192
    v_mul_f32 v35, v193, v193
    v_mfma_f32_16x16x32_bf16 v[132:135], a[64:67], a[92:95], v[132:135]
    v_mul_f32 v36, v194, v194
    v_mfma_f32_16x16x32_bf16 v[136:139], a[64:67], a[96:99], v[136:139]
    v_mul_f32 v37, v195, v195
    v_mul_f32 v38, v196, v196
    v_mfma_f32_16x16x32_bf16 v[140:143], a[64:67], a[100:103], v[140:143]
    buffer_load_dwordx4 a[64:67], v50, s[12:15], s28 offen offset:0
    v_mul_f32 v39, v197, v197
    v_mfma_f32_16x16x32_bf16 v[144:147], a[68:71], a[88:91], v[144:147]
    v_mul_f32 v40, v198, v198
    v_mfma_f32_16x16x32_bf16 v[148:151], a[68:71], a[92:95], v[148:151]
    v_mul_f32 v41, v199, v199
    v_fma_f32 v34, v34, v14, v18
    v_mfma_f32_16x16x32_bf16 v[152:155], a[68:71], a[96:99], v[152:155]
    v_fma_f32 v35, v35, v14, v18
    v_mfma_f32_16x16x32_bf16 v[156:159], a[68:71], a[100:103], v[156:159]
    buffer_load_dwordx4 a[68:71], v51, s[12:15], s28 offen offset:0
    v_fma_f32 v36, v36, v14, v18
    s_waitcnt vmcnt(12) lgkmcnt(0)
    v_mfma_f32_16x16x32_bf16 v[64:67], a[0:3], a[72:75], v[64:67]
    v_fma_f32 v37, v37, v14, v18
    v_fma_f32 v38, v38, v15, v19
    v_mfma_f32_16x16x32_bf16 v[68:71], a[0:3], a[76:79], v[68:71]
    ds_read_b128 a[88:91], v2 offset:7168
    v_fma_f32 v39, v39, v15, v19
    v_mfma_f32_16x16x32_bf16 v[72:75], a[0:3], a[80:83], v[72:75]
    v_fma_f32 v40, v40, v15, v19
    v_mfma_f32_16x16x32_bf16 v[76:79], a[0:3], a[84:87], v[76:79]
    buffer_load_dwordx4 a[0:3], v46, s[12:15], s28 offen offset:1024
    v_fma_f32 v41, v41, v15, v19
    v_mul_f32 v34, v192, v34
    v_mfma_f32_16x16x32_bf16 v[80:83], a[4:7], a[72:75], v[80:83]
    v_mul_f32 v35, v193, v35
    v_mfma_f32_16x16x32_bf16 v[84:87], a[4:7], a[76:79], v[84:87]
    ds_read_b128 a[92:95], v2 offset:25600
    v_mul_f32 v36, v194, v36
    v_mul_f32 v37, v195, v37
    v_mfma_f32_16x16x32_bf16 v[88:91], a[4:7], a[80:83], v[88:91]
    v_mul_f32 v38, v196, v38
    v_mfma_f32_16x16x32_bf16 v[92:95], a[4:7], a[84:87], v[92:95]
    buffer_load_dwordx4 a[4:7], v47, s[12:15], s28 offen offset:1024
    v_mul_f32 v39, v197, v39
    v_mfma_f32_16x16x32_bf16 v[96:99], a[8:11], a[72:75], v[96:99]
    v_mul_f32 v40, v198, v40
    v_mul_f32 v41, v199, v41
    v_mfma_f32_16x16x32_bf16 v[100:103], a[8:11], a[76:79], v[100:103]
    ds_read_b128 a[96:99], v3 offset:7168
    v_exp_f32 v34, v34
    v_mfma_f32_16x16x32_bf16 v[104:107], a[8:11], a[80:83], v[104:107]
    v_exp_f32 v35, v35
    v_mfma_f32_16x16x32_bf16 v[108:111], a[8:11], a[84:87], v[108:111]
    buffer_load_dwordx4 a[8:11], v48, s[12:15], s28 offen offset:1024
    v_exp_f32 v36, v36
    v_exp_f32 v37, v37
    v_mfma_f32_16x16x32_bf16 v[112:115], a[12:15], a[72:75], v[112:115]
    v_exp_f32 v38, v38
    v_mfma_f32_16x16x32_bf16 v[116:119], a[12:15], a[76:79], v[116:119]
    ds_read_b128 a[100:103], v3 offset:25600
    v_exp_f32 v39, v39
    v_exp_f32 v40, v40
    v_mfma_f32_16x16x32_bf16 v[120:123], a[12:15], a[80:83], v[120:123]
    v_exp_f32 v41, v41
    v_mfma_f32_16x16x32_bf16 v[124:127], a[12:15], a[84:87], v[124:127]
    buffer_load_dwordx4 a[12:15], v49, s[12:15], s28 offen offset:1024
    v_fmac_f32 v208, v30, v10
    v_mfma_f32_16x16x32_bf16 v[128:131], a[16:19], a[72:75], v[128:131]
    v_fmac_f32 v209, v31, v10
    v_fmac_f32 v210, v32, v10
    v_mfma_f32_16x16x32_bf16 v[132:135], a[16:19], a[76:79], v[132:135]
    v_fmac_f32 v211, v33, v10
    v_mfma_f32_16x16x32_bf16 v[136:139], a[16:19], a[80:83], v[136:139]
    v_fmac_f32 v212, v30, v11
    v_mfma_f32_16x16x32_bf16 v[140:143], a[16:19], a[84:87], v[140:143]
    buffer_load_dwordx4 a[16:19], v50, s[12:15], s28 offen offset:1024
    v_fmac_f32 v213, v31, v11
    v_fmac_f32 v214, v32, v11
    v_mfma_f32_16x16x32_bf16 v[144:147], a[20:23], a[72:75], v[144:147]
    v_fmac_f32 v215, v33, v11
    v_mfma_f32_16x16x32_bf16 v[148:151], a[20:23], a[76:79], v[148:151]
    v_fma_f32 v34, v34, v22, v22
    v_mfma_f32_16x16x32_bf16 v[152:155], a[20:23], a[80:83], v[152:155]
    v_fma_f32 v35, v35, v22, v22
    v_fma_f32 v36, v36, v22, v22
    v_mfma_f32_16x16x32_bf16 v[156:159], a[20:23], a[84:87], v[156:159]
    buffer_load_dwordx4 a[20:23], v51, s[12:15], s28 offen offset:1024
    v_fma_f32 v37, v37, v22, v22
    s_waitcnt vmcnt(12) lgkmcnt(0)
    v_mfma_f32_16x16x32_bf16 v[64:67], a[24:27], a[88:91], v[64:67]
    v_fma_f32 v38, v38, v23, v23
    v_fma_f32 v39, v39, v23, v23
    v_mfma_f32_16x16x32_bf16 v[68:71], a[24:27], a[92:95], v[68:71]
    ds_read_b128 a[72:75], v2 offset:8192
    v_fma_f32 v40, v40, v23, v23
    v_mfma_f32_16x16x32_bf16 v[72:75], a[24:27], a[96:99], v[72:75]
    v_fma_f32 v41, v41, v23, v23
    v_mfma_f32_16x16x32_bf16 v[76:79], a[24:27], a[100:103], v[76:79]
    buffer_load_dwordx4 a[24:27], v46, s[12:15], s28 offen offset:2048
    v_rcp_f32 v34, v34
    v_rcp_f32 v35, v35
    v_mfma_f32_16x16x32_bf16 v[80:83], a[28:31], a[88:91], v[80:83]
    v_rcp_f32 v36, v36
    v_mfma_f32_16x16x32_bf16 v[84:87], a[28:31], a[92:95], v[84:87]
    ds_read_b128 a[76:79], v2 offset:26624
    v_rcp_f32 v37, v37
    v_mfma_f32_16x16x32_bf16 v[88:91], a[28:31], a[96:99], v[88:91]
    v_rcp_f32 v38, v38
    v_rcp_f32 v39, v39
    v_mfma_f32_16x16x32_bf16 v[92:95], a[28:31], a[100:103], v[92:95]
    buffer_load_dwordx4 a[28:31], v47, s[12:15], s28 offen offset:2048
    v_rcp_f32 v40, v40
    v_mfma_f32_16x16x32_bf16 v[96:99], a[32:35], a[88:91], v[96:99]
    v_rcp_f32 v41, v41
    v_mfma_f32_16x16x32_bf16 v[100:103], a[32:35], a[92:95], v[100:103]
    ds_read_b128 a[80:83], v3 offset:8192
    v_mul_f32 v208, v192, v208
    v_mul_f32 v209, v193, v209
    v_mfma_f32_16x16x32_bf16 v[104:107], a[32:35], a[96:99], v[104:107]
    v_mul_f32 v210, v194, v210
    v_mfma_f32_16x16x32_bf16 v[108:111], a[32:35], a[100:103], v[108:111]
    buffer_load_dwordx4 a[32:35], v48, s[12:15], s28 offen offset:2048
    v_mul_f32 v211, v195, v211
    v_mul_f32 v212, v196, v212
    v_mfma_f32_16x16x32_bf16 v[112:115], a[36:39], a[88:91], v[112:115]
    v_mul_f32 v213, v197, v213
    v_mfma_f32_16x16x32_bf16 v[116:119], a[36:39], a[92:95], v[116:119]
    ds_read_b128 a[84:87], v3 offset:26624
    v_mul_f32 v214, v198, v214
    v_mfma_f32_16x16x32_bf16 v[120:123], a[36:39], a[96:99], v[120:123]
    v_mul_f32 v215, v199, v215
    v_mul_f32 v34, v34, v208
    v_mfma_f32_16x16x32_bf16 v[124:127], a[36:39], a[100:103], v[124:127]
    buffer_load_dwordx4 a[36:39], v49, s[12:15], s28 offen offset:2048
    v_mul_f32 v35, v35, v209
    v_mfma_f32_16x16x32_bf16 v[128:131], a[40:43], a[88:91], v[128:131]
    v_mul_f32 v36, v36, v210
    v_mfma_f32_16x16x32_bf16 v[132:135], a[40:43], a[92:95], v[132:135]
    v_mul_f32 v37, v37, v211
    v_mul_f32 v38, v38, v212
    v_mfma_f32_16x16x32_bf16 v[136:139], a[40:43], a[96:99], v[136:139]
    v_mul_f32 v39, v39, v213
    v_mfma_f32_16x16x32_bf16 v[140:143], a[40:43], a[100:103], v[140:143]
    buffer_load_dwordx4 a[40:43], v50, s[12:15], s28 offen offset:2048
    v_mul_f32 v40, v40, v214
    v_mul_f32 v41, v41, v215
    v_mfma_f32_16x16x32_bf16 v[144:147], a[44:47], a[88:91], v[144:147]
    v_cvt_pk_bf16_f32 v42, v34, v35
    v_mfma_f32_16x16x32_bf16 v[148:151], a[44:47], a[92:95], v[148:151]
    v_cvt_pk_bf16_f32 v43, v36, v37
    v_mfma_f32_16x16x32_bf16 v[152:155], a[44:47], a[96:99], v[152:155]
    v_cvt_pk_bf16_f32 v44, v38, v39
    v_cvt_pk_bf16_f32 v45, v40, v41
    v_mfma_f32_16x16x32_bf16 v[156:159], a[44:47], a[100:103], v[156:159]
    buffer_load_dwordx4 a[44:47], v51, s[12:15], s28 offen offset:2048
    ds_write_b64 v7, v[42:43] offset:6144
    s_waitcnt vmcnt(12) lgkmcnt(1)
    v_mfma_f32_16x16x32_bf16 v[64:67], a[48:51], a[72:75], v[64:67]
    ds_write_b64 v7, v[44:45] offset:24576
    v_mfma_f32_16x16x32_bf16 v[68:71], a[48:51], a[76:79], v[68:71]
    ds_read_b128 a[88:91], v2 offset:9216
    v_fmac_f32 v200, v26, v12
    v_fmac_f32 v201, v27, v12
    v_mfma_f32_16x16x32_bf16 v[72:75], a[48:51], a[80:83], v[72:75]
    v_fmac_f32 v202, v28, v12
    v_mfma_f32_16x16x32_bf16 v[76:79], a[48:51], a[84:87], v[76:79]
    buffer_load_dwordx4 a[48:51], v46, s[12:15], s28 offen offset:3072
    v_fmac_f32 v203, v29, v12
    v_mfma_f32_16x16x32_bf16 v[80:83], a[52:55], a[72:75], v[80:83]
    v_fmac_f32 v204, v26, v13
    v_fmac_f32 v205, v27, v13
    v_mfma_f32_16x16x32_bf16 v[84:87], a[52:55], a[76:79], v[84:87]
    ds_read_b128 a[92:95], v2 offset:27648
    v_fmac_f32 v206, v28, v13
    v_mfma_f32_16x16x32_bf16 v[88:91], a[52:55], a[80:83], v[88:91]
    v_fmac_f32 v207, v29, v13
    v_mul_f32 v34, v200, v200
    v_mfma_f32_16x16x32_bf16 v[92:95], a[52:55], a[84:87], v[92:95]
    buffer_load_dwordx4 a[52:55], v47, s[12:15], s28 offen offset:3072
    v_mul_f32 v35, v201, v201
    v_mfma_f32_16x16x32_bf16 v[96:99], a[56:59], a[72:75], v[96:99]
    v_mul_f32 v36, v202, v202
    v_mfma_f32_16x16x32_bf16 v[100:103], a[56:59], a[76:79], v[100:103]
    ds_read_b128 a[96:99], v3 offset:9216
    v_mul_f32 v37, v203, v203
    v_mul_f32 v38, v204, v204
    v_mfma_f32_16x16x32_bf16 v[104:107], a[56:59], a[80:83], v[104:107]
    v_mul_f32 v39, v205, v205
    v_mfma_f32_16x16x32_bf16 v[108:111], a[56:59], a[84:87], v[108:111]
    buffer_load_dwordx4 a[56:59], v48, s[12:15], s28 offen offset:3072
    v_mul_f32 v40, v206, v206
    v_mfma_f32_16x16x32_bf16 v[112:115], a[60:63], a[72:75], v[112:115]
    v_mul_f32 v41, v207, v207
    v_fma_f32 v34, v34, v16, v20
    v_mfma_f32_16x16x32_bf16 v[116:119], a[60:63], a[76:79], v[116:119]
    ds_read_b128 a[100:103], v3 offset:27648
    v_fma_f32 v35, v35, v16, v20
    v_mfma_f32_16x16x32_bf16 v[120:123], a[60:63], a[80:83], v[120:123]
    v_fma_f32 v36, v36, v16, v20
    v_fma_f32 v37, v37, v16, v20
    v_mfma_f32_16x16x32_bf16 v[124:127], a[60:63], a[84:87], v[124:127]
    buffer_load_dwordx4 a[60:63], v49, s[12:15], s28 offen offset:3072
    v_fma_f32 v38, v38, v17, v21
    v_mfma_f32_16x16x32_bf16 v[128:131], a[64:67], a[72:75], v[128:131]
    v_fma_f32 v39, v39, v17, v21
    v_mfma_f32_16x16x32_bf16 v[132:135], a[64:67], a[76:79], v[132:135]
    v_fma_f32 v40, v40, v17, v21
    v_fma_f32 v41, v41, v17, v21
    v_mfma_f32_16x16x32_bf16 v[136:139], a[64:67], a[80:83], v[136:139]
    v_mul_f32 v34, v200, v34
    v_mfma_f32_16x16x32_bf16 v[140:143], a[64:67], a[84:87], v[140:143]
    buffer_load_dwordx4 a[64:67], v50, s[12:15], s28 offen offset:3072
    v_mul_f32 v35, v201, v35
    v_mfma_f32_16x16x32_bf16 v[144:147], a[68:71], a[72:75], v[144:147]
    v_mul_f32 v36, v202, v36
    v_mul_f32 v37, v203, v37
    v_mfma_f32_16x16x32_bf16 v[148:151], a[68:71], a[76:79], v[148:151]
    v_mul_f32 v38, v204, v38
    v_mfma_f32_16x16x32_bf16 v[152:155], a[68:71], a[80:83], v[152:155]
    v_mul_f32 v39, v205, v39
    v_mfma_f32_16x16x32_bf16 v[156:159], a[68:71], a[84:87], v[156:159]
    buffer_load_dwordx4 a[68:71], v51, s[12:15], s28 offen offset:3072
    v_mul_f32 v40, v206, v40
    v_mul_f32 v41, v207, v41
    s_waitcnt vmcnt(12) lgkmcnt(0)
    v_mfma_f32_16x16x32_bf16 v[64:67], a[0:3], a[88:91], v[64:67]
    v_exp_f32 v34, v34
    v_mfma_f32_16x16x32_bf16 v[68:71], a[0:3], a[92:95], v[68:71]
    ds_read_b128 a[72:75], v2 offset:10240
    v_exp_f32 v35, v35
    v_exp_f32 v36, v36
    v_mfma_f32_16x16x32_bf16 v[72:75], a[0:3], a[96:99], v[72:75]
    v_exp_f32 v37, v37
    v_mfma_f32_16x16x32_bf16 v[76:79], a[0:3], a[100:103], v[76:79]
    s_add_u32 s28, s28, 4096
    buffer_load_dwordx4 a[0:3], v46, s[12:15], s28 offen offset:0
    v_exp_f32 v38, v38
    v_mfma_f32_16x16x32_bf16 v[80:83], a[4:7], a[88:91], v[80:83]
    v_exp_f32 v39, v39
    v_exp_f32 v40, v40
    v_mfma_f32_16x16x32_bf16 v[84:87], a[4:7], a[92:95], v[84:87]
    ds_read_b128 a[76:79], v2 offset:28672
    v_exp_f32 v41, v41
    v_mfma_f32_16x16x32_bf16 v[88:91], a[4:7], a[96:99], v[88:91]
    v_fmac_f32 v216, v30, v12
    v_mfma_f32_16x16x32_bf16 v[92:95], a[4:7], a[100:103], v[92:95]
    buffer_load_dwordx4 a[4:7], v47, s[12:15], s28 offen offset:0
    v_fmac_f32 v217, v31, v12
    v_fmac_f32 v218, v32, v12
    v_mfma_f32_16x16x32_bf16 v[96:99], a[8:11], a[88:91], v[96:99]
    v_fmac_f32 v219, v33, v12
    v_mfma_f32_16x16x32_bf16 v[100:103], a[8:11], a[92:95], v[100:103]
    ds_read_b128 a[80:83], v3 offset:10240
    v_fmac_f32 v220, v30, v13
    v_mfma_f32_16x16x32_bf16 v[104:107], a[8:11], a[96:99], v[104:107]
    v_fmac_f32 v221, v31, v13
    v_fmac_f32 v222, v32, v13
    v_mfma_f32_16x16x32_bf16 v[108:111], a[8:11], a[100:103], v[108:111]
    buffer_load_dwordx4 a[8:11], v48, s[12:15], s28 offen offset:0
    v_fmac_f32 v223, v33, v13
    v_mfma_f32_16x16x32_bf16 v[112:115], a[12:15], a[88:91], v[112:115]
    v_fma_f32 v34, v34, v24, v24
    v_fma_f32 v35, v35, v24, v24
    v_mfma_f32_16x16x32_bf16 v[116:119], a[12:15], a[92:95], v[116:119]
    ds_read_b128 a[84:87], v3 offset:28672
    v_fma_f32 v36, v36, v24, v24
    v_mfma_f32_16x16x32_bf16 v[120:123], a[12:15], a[96:99], v[120:123]
    v_fma_f32 v37, v37, v24, v24
    v_mfma_f32_16x16x32_bf16 v[124:127], a[12:15], a[100:103], v[124:127]
    buffer_load_dwordx4 a[12:15], v49, s[12:15], s28 offen offset:0
    v_fma_f32 v38, v38, v25, v25
    v_fma_f32 v39, v39, v25, v25
    v_mfma_f32_16x16x32_bf16 v[128:131], a[16:19], a[88:91], v[128:131]
    v_fma_f32 v40, v40, v25, v25
    v_mfma_f32_16x16x32_bf16 v[132:135], a[16:19], a[92:95], v[132:135]
    v_fma_f32 v41, v41, v25, v25
    v_mfma_f32_16x16x32_bf16 v[136:139], a[16:19], a[96:99], v[136:139]
    v_rcp_f32 v34, v34
    v_rcp_f32 v35, v35
    v_mfma_f32_16x16x32_bf16 v[140:143], a[16:19], a[100:103], v[140:143]
    buffer_load_dwordx4 a[16:19], v50, s[12:15], s28 offen offset:0
    v_rcp_f32 v36, v36
    v_mfma_f32_16x16x32_bf16 v[144:147], a[20:23], a[88:91], v[144:147]
    v_rcp_f32 v37, v37
    v_rcp_f32 v38, v38
    v_mfma_f32_16x16x32_bf16 v[148:151], a[20:23], a[92:95], v[148:151]
    v_rcp_f32 v39, v39
    v_mfma_f32_16x16x32_bf16 v[152:155], a[20:23], a[96:99], v[152:155]
    v_rcp_f32 v40, v40
    v_mfma_f32_16x16x32_bf16 v[156:159], a[20:23], a[100:103], v[156:159]
    buffer_load_dwordx4 a[20:23], v51, s[12:15], s28 offen offset:0
    v_rcp_f32 v41, v41
    v_mul_f32 v216, v200, v216
    s_waitcnt vmcnt(12) lgkmcnt(0)
    v_mfma_f32_16x16x32_bf16 v[64:67], a[24:27], a[72:75], v[64:67]
    v_mul_f32 v217, v201, v217
    v_mfma_f32_16x16x32_bf16 v[68:71], a[24:27], a[76:79], v[68:71]
    ds_read_b128 a[88:91], v2 offset:11264
    v_mul_f32 v218, v202, v218
    v_mfma_f32_16x16x32_bf16 v[72:75], a[24:27], a[80:83], v[72:75]
    v_mul_f32 v219, v203, v219
    v_mul_f32 v220, v204, v220
    v_mfma_f32_16x16x32_bf16 v[76:79], a[24:27], a[84:87], v[76:79]
    buffer_load_dwordx4 a[24:27], v46, s[12:15], s28 offen offset:1024
    v_mul_f32 v221, v205, v221
    v_mfma_f32_16x16x32_bf16 v[80:83], a[28:31], a[72:75], v[80:83]
    v_mul_f32 v222, v206, v222
    v_mfma_f32_16x16x32_bf16 v[84:87], a[28:31], a[76:79], v[84:87]
    ds_read_b128 a[92:95], v2 offset:29696
    v_mul_f32 v223, v207, v223
    v_mul_f32 v34, v34, v216
    v_mfma_f32_16x16x32_bf16 v[88:91], a[28:31], a[80:83], v[88:91]
    v_mul_f32 v35, v35, v217
    v_mfma_f32_16x16x32_bf16 v[92:95], a[28:31], a[84:87], v[92:95]
    buffer_load_dwordx4 a[28:31], v47, s[12:15], s28 offen offset:1024
    v_mul_f32 v36, v36, v218
    v_mul_f32 v37, v37, v219
    v_mfma_f32_16x16x32_bf16 v[96:99], a[32:35], a[72:75], v[96:99]
    v_mul_f32 v38, v38, v220
    v_mfma_f32_16x16x32_bf16 v[100:103], a[32:35], a[76:79], v[100:103]
    ds_read_b128 a[96:99], v3 offset:11264
    v_mul_f32 v39, v39, v221
    v_mfma_f32_16x16x32_bf16 v[104:107], a[32:35], a[80:83], v[104:107]
    v_mul_f32 v40, v40, v222
    v_mul_f32 v41, v41, v223
    v_mfma_f32_16x16x32_bf16 v[108:111], a[32:35], a[84:87], v[108:111]
    buffer_load_dwordx4 a[32:35], v48, s[12:15], s28 offen offset:1024
    v_cvt_pk_bf16_f32 v42, v34, v35
    v_mfma_f32_16x16x32_bf16 v[112:115], a[36:39], a[72:75], v[112:115]
    v_cvt_pk_bf16_f32 v43, v36, v37
    v_mfma_f32_16x16x32_bf16 v[116:119], a[36:39], a[76:79], v[116:119]
    ds_read_b128 a[100:103], v3 offset:29696
    v_cvt_pk_bf16_f32 v44, v38, v39
    v_cvt_pk_bf16_f32 v45, v40, v41
    v_mfma_f32_16x16x32_bf16 v[120:123], a[36:39], a[80:83], v[120:123]
    ds_write_b64 v0, v[42:43] offset:6144
    v_mfma_f32_16x16x32_bf16 v[124:127], a[36:39], a[84:87], v[124:127]
    buffer_load_dwordx4 a[36:39], v49, s[12:15], s28 offen offset:1024
    ds_write_b64 v0, v[44:45] offset:24576
    v_mfma_f32_16x16x32_bf16 v[128:131], a[40:43], a[72:75], v[128:131]
    ds_read_b128 v[26:29], v8 offset:1792
    ds_read_b128 v[30:33], v8 offset:1808
    v_mfma_f32_16x16x32_bf16 v[132:135], a[40:43], a[76:79], v[132:135]
    s_waitcnt lgkmcnt(0)
    v_mfma_f32_16x16x32_bf16 v[136:139], a[40:43], a[80:83], v[136:139]
    v_fmac_f32 v224, v26, v10
    v_fmac_f32 v225, v27, v10
    v_mfma_f32_16x16x32_bf16 v[140:143], a[40:43], a[84:87], v[140:143]
    buffer_load_dwordx4 a[40:43], v50, s[12:15], s28 offen offset:1024
    v_fmac_f32 v226, v28, v10
    v_mfma_f32_16x16x32_bf16 v[144:147], a[44:47], a[72:75], v[144:147]
    v_fmac_f32 v227, v29, v10
    v_mfma_f32_16x16x32_bf16 v[148:151], a[44:47], a[76:79], v[148:151]
    v_fmac_f32 v228, v26, v11
    v_fmac_f32 v229, v27, v11
    v_mfma_f32_16x16x32_bf16 v[152:155], a[44:47], a[80:83], v[152:155]
    v_fmac_f32 v230, v28, v11
    v_mfma_f32_16x16x32_bf16 v[156:159], a[44:47], a[84:87], v[156:159]
    buffer_load_dwordx4 a[44:47], v51, s[12:15], s28 offen offset:1024
    v_fmac_f32 v231, v29, v11
    s_waitcnt vmcnt(12)
    v_mfma_f32_16x16x32_bf16 v[64:67], a[48:51], a[88:91], v[64:67]
    v_mul_f32 v34, v224, v224
    v_mul_f32 v35, v225, v225
    v_mfma_f32_16x16x32_bf16 v[68:71], a[48:51], a[92:95], v[68:71]
    ds_read_b128 a[72:75], v2 offset:12288
    v_mul_f32 v36, v226, v226
    v_mfma_f32_16x16x32_bf16 v[72:75], a[48:51], a[96:99], v[72:75]
    v_mul_f32 v37, v227, v227
    v_mul_f32 v38, v228, v228
    v_mfma_f32_16x16x32_bf16 v[76:79], a[48:51], a[100:103], v[76:79]
    buffer_load_dwordx4 a[48:51], v46, s[12:15], s28 offen offset:2048
    v_mul_f32 v39, v229, v229
    v_mfma_f32_16x16x32_bf16 v[80:83], a[52:55], a[88:91], v[80:83]
    v_mul_f32 v40, v230, v230
    v_mfma_f32_16x16x32_bf16 v[84:87], a[52:55], a[92:95], v[84:87]
    ds_read_b128 a[76:79], v2 offset:30720
    v_mul_f32 v41, v231, v231
    v_fma_f32 v34, v34, v14, v18
    v_mfma_f32_16x16x32_bf16 v[88:91], a[52:55], a[96:99], v[88:91]
    v_fma_f32 v35, v35, v14, v18
    v_mfma_f32_16x16x32_bf16 v[92:95], a[52:55], a[100:103], v[92:95]
    buffer_load_dwordx4 a[52:55], v47, s[12:15], s28 offen offset:2048
    v_fma_f32 v36, v36, v14, v18
    v_mfma_f32_16x16x32_bf16 v[96:99], a[56:59], a[88:91], v[96:99]
    v_fma_f32 v37, v37, v14, v18
    v_fma_f32 v38, v38, v15, v19
    v_mfma_f32_16x16x32_bf16 v[100:103], a[56:59], a[92:95], v[100:103]
    ds_read_b128 a[80:83], v3 offset:12288
    v_fma_f32 v39, v39, v15, v19
    v_mfma_f32_16x16x32_bf16 v[104:107], a[56:59], a[96:99], v[104:107]
    v_fma_f32 v40, v40, v15, v19
    v_mfma_f32_16x16x32_bf16 v[108:111], a[56:59], a[100:103], v[108:111]
    buffer_load_dwordx4 a[56:59], v48, s[12:15], s28 offen offset:2048
    v_fma_f32 v41, v41, v15, v19
    v_mul_f32 v34, v224, v34
    v_mfma_f32_16x16x32_bf16 v[112:115], a[60:63], a[88:91], v[112:115]
    v_mul_f32 v35, v225, v35
    v_mfma_f32_16x16x32_bf16 v[116:119], a[60:63], a[92:95], v[116:119]
    ds_read_b128 a[84:87], v3 offset:30720
    v_mul_f32 v36, v226, v36
    v_mul_f32 v37, v227, v37
    v_mfma_f32_16x16x32_bf16 v[120:123], a[60:63], a[96:99], v[120:123]
    v_mul_f32 v38, v228, v38
    v_mfma_f32_16x16x32_bf16 v[124:127], a[60:63], a[100:103], v[124:127]
    buffer_load_dwordx4 a[60:63], v49, s[12:15], s28 offen offset:2048
    v_mul_f32 v39, v229, v39
    v_mfma_f32_16x16x32_bf16 v[128:131], a[64:67], a[88:91], v[128:131]
    v_mul_f32 v40, v230, v40
    v_mul_f32 v41, v231, v41
    v_mfma_f32_16x16x32_bf16 v[132:135], a[64:67], a[92:95], v[132:135]
    v_exp_f32 v34, v34
    v_mfma_f32_16x16x32_bf16 v[136:139], a[64:67], a[96:99], v[136:139]
    v_exp_f32 v35, v35
    v_mfma_f32_16x16x32_bf16 v[140:143], a[64:67], a[100:103], v[140:143]
    buffer_load_dwordx4 a[64:67], v50, s[12:15], s28 offen offset:2048
    v_exp_f32 v36, v36
    v_exp_f32 v37, v37
    v_mfma_f32_16x16x32_bf16 v[144:147], a[68:71], a[88:91], v[144:147]
    v_exp_f32 v38, v38
    v_mfma_f32_16x16x32_bf16 v[148:151], a[68:71], a[92:95], v[148:151]
    v_exp_f32 v39, v39
    v_exp_f32 v40, v40
    v_mfma_f32_16x16x32_bf16 v[152:155], a[68:71], a[96:99], v[152:155]
    v_exp_f32 v41, v41
    v_mfma_f32_16x16x32_bf16 v[156:159], a[68:71], a[100:103], v[156:159]
    buffer_load_dwordx4 a[68:71], v51, s[12:15], s28 offen offset:2048
    v_fmac_f32 v240, v30, v10
    s_waitcnt vmcnt(12) lgkmcnt(0)
    v_mfma_f32_16x16x32_bf16 v[64:67], a[0:3], a[72:75], v[64:67]
    v_fmac_f32 v241, v31, v10
    v_fmac_f32 v242, v32, v10
    v_mfma_f32_16x16x32_bf16 v[68:71], a[0:3], a[76:79], v[68:71]
    ds_read_b128 a[88:91], v2 offset:13312
    v_fmac_f32 v243, v33, v10
    v_mfma_f32_16x16x32_bf16 v[72:75], a[0:3], a[80:83], v[72:75]
    v_fmac_f32 v244, v30, v11
    v_mfma_f32_16x16x32_bf16 v[76:79], a[0:3], a[84:87], v[76:79]
    buffer_load_dwordx4 a[0:3], v46, s[12:15], s28 offen offset:3072
    v_fmac_f32 v245, v31, v11
    v_fmac_f32 v246, v32, v11
    v_mfma_f32_16x16x32_bf16 v[80:83], a[4:7], a[72:75], v[80:83]
    v_fmac_f32 v247, v33, v11
    v_mfma_f32_16x16x32_bf16 v[84:87], a[4:7], a[76:79], v[84:87]
    ds_read_b128 a[92:95], v2 offset:31744
    v_fma_f32 v34, v34, v22, v22
    v_mfma_f32_16x16x32_bf16 v[88:91], a[4:7], a[80:83], v[88:91]
    v_fma_f32 v35, v35, v22, v22
    v_fma_f32 v36, v36, v22, v22
    v_mfma_f32_16x16x32_bf16 v[92:95], a[4:7], a[84:87], v[92:95]
    buffer_load_dwordx4 a[4:7], v47, s[12:15], s28 offen offset:3072
    v_fma_f32 v37, v37, v22, v22
    v_mfma_f32_16x16x32_bf16 v[96:99], a[8:11], a[72:75], v[96:99]
    v_fma_f32 v38, v38, v23, v23
    v_fma_f32 v39, v39, v23, v23
    v_mfma_f32_16x16x32_bf16 v[100:103], a[8:11], a[76:79], v[100:103]
    ds_read_b128 a[96:99], v3 offset:13312
    v_fma_f32 v40, v40, v23, v23
    v_mfma_f32_16x16x32_bf16 v[104:107], a[8:11], a[80:83], v[104:107]
    v_fma_f32 v41, v41, v23, v23
    v_mfma_f32_16x16x32_bf16 v[108:111], a[8:11], a[84:87], v[108:111]
    buffer_load_dwordx4 a[8:11], v48, s[12:15], s28 offen offset:3072
    v_rcp_f32 v34, v34
    v_rcp_f32 v35, v35
    v_mfma_f32_16x16x32_bf16 v[112:115], a[12:15], a[72:75], v[112:115]
    v_rcp_f32 v36, v36
    v_mfma_f32_16x16x32_bf16 v[116:119], a[12:15], a[76:79], v[116:119]
    ds_read_b128 a[100:103], v3 offset:31744
    v_rcp_f32 v37, v37
    v_mfma_f32_16x16x32_bf16 v[120:123], a[12:15], a[80:83], v[120:123]
    v_rcp_f32 v38, v38
    v_rcp_f32 v39, v39
    v_mfma_f32_16x16x32_bf16 v[124:127], a[12:15], a[84:87], v[124:127]
    buffer_load_dwordx4 a[12:15], v49, s[12:15], s28 offen offset:3072
    v_rcp_f32 v40, v40
    v_mfma_f32_16x16x32_bf16 v[128:131], a[16:19], a[72:75], v[128:131]
    v_rcp_f32 v41, v41
    v_mfma_f32_16x16x32_bf16 v[132:135], a[16:19], a[76:79], v[132:135]
    v_mul_f32 v240, v224, v240
    v_mul_f32 v241, v225, v241
    v_mfma_f32_16x16x32_bf16 v[136:139], a[16:19], a[80:83], v[136:139]
    v_mul_f32 v242, v226, v242
    v_mfma_f32_16x16x32_bf16 v[140:143], a[16:19], a[84:87], v[140:143]
    buffer_load_dwordx4 a[16:19], v50, s[12:15], s28 offen offset:3072
    v_mul_f32 v243, v227, v243
    v_mul_f32 v244, v228, v244
    v_mfma_f32_16x16x32_bf16 v[144:147], a[20:23], a[72:75], v[144:147]
    v_mul_f32 v245, v229, v245
    v_mfma_f32_16x16x32_bf16 v[148:151], a[20:23], a[76:79], v[148:151]
    v_mul_f32 v246, v230, v246
    v_mfma_f32_16x16x32_bf16 v[152:155], a[20:23], a[80:83], v[152:155]
    v_mul_f32 v247, v231, v247
    v_mul_f32 v34, v34, v240
    v_mfma_f32_16x16x32_bf16 v[156:159], a[20:23], a[84:87], v[156:159]
    buffer_load_dwordx4 a[20:23], v51, s[12:15], s28 offen offset:3072
    v_mul_f32 v35, v35, v241
    s_waitcnt vmcnt(12) lgkmcnt(0)
    v_mfma_f32_16x16x32_bf16 v[64:67], a[24:27], a[88:91], v[64:67]
    v_mul_f32 v36, v36, v242
    v_mfma_f32_16x16x32_bf16 v[68:71], a[24:27], a[92:95], v[68:71]
    ds_read_b128 a[72:75], v2 offset:14336
    v_mul_f32 v37, v37, v243
    v_mul_f32 v38, v38, v244
    v_mfma_f32_16x16x32_bf16 v[72:75], a[24:27], a[96:99], v[72:75]
    v_mul_f32 v39, v39, v245
    v_mfma_f32_16x16x32_bf16 v[76:79], a[24:27], a[100:103], v[76:79]
    s_add_u32 s28, s28, 4096
    buffer_load_dwordx4 a[24:27], v46, s[12:15], s28 offen offset:0
    v_mul_f32 v40, v40, v246
    v_mul_f32 v41, v41, v247
    v_mfma_f32_16x16x32_bf16 v[80:83], a[28:31], a[88:91], v[80:83]
    v_cvt_pk_bf16_f32 v42, v34, v35
    v_mfma_f32_16x16x32_bf16 v[84:87], a[28:31], a[92:95], v[84:87]
    ds_read_b128 a[76:79], v2 offset:32768
    v_cvt_pk_bf16_f32 v43, v36, v37
    v_mfma_f32_16x16x32_bf16 v[88:91], a[28:31], a[96:99], v[88:91]
    v_cvt_pk_bf16_f32 v44, v38, v39
    v_cvt_pk_bf16_f32 v45, v40, v41
    v_mfma_f32_16x16x32_bf16 v[92:95], a[28:31], a[100:103], v[92:95]
    buffer_load_dwordx4 a[28:31], v47, s[12:15], s28 offen offset:0
    ds_write_b64 v6, v[42:43] offset:7168
    v_mfma_f32_16x16x32_bf16 v[96:99], a[32:35], a[88:91], v[96:99]
    ds_write_b64 v6, v[44:45] offset:25600
    v_mfma_f32_16x16x32_bf16 v[100:103], a[32:35], a[92:95], v[100:103]
    ds_read_b128 a[80:83], v3 offset:14336
    v_fmac_f32 v232, v26, v12
    v_fmac_f32 v233, v27, v12
    v_mfma_f32_16x16x32_bf16 v[104:107], a[32:35], a[96:99], v[104:107]
    v_fmac_f32 v234, v28, v12
    v_mfma_f32_16x16x32_bf16 v[108:111], a[32:35], a[100:103], v[108:111]
    buffer_load_dwordx4 a[32:35], v48, s[12:15], s28 offen offset:0
    v_fmac_f32 v235, v29, v12
    v_mfma_f32_16x16x32_bf16 v[112:115], a[36:39], a[88:91], v[112:115]
    v_fmac_f32 v236, v26, v13
    v_fmac_f32 v237, v27, v13
    v_mfma_f32_16x16x32_bf16 v[116:119], a[36:39], a[92:95], v[116:119]
    ds_read_b128 a[84:87], v3 offset:32768
    v_fmac_f32 v238, v28, v13
    v_mfma_f32_16x16x32_bf16 v[120:123], a[36:39], a[96:99], v[120:123]
    v_fmac_f32 v239, v29, v13
    v_mul_f32 v34, v232, v232
    v_mfma_f32_16x16x32_bf16 v[124:127], a[36:39], a[100:103], v[124:127]
    buffer_load_dwordx4 a[36:39], v49, s[12:15], s28 offen offset:0
    v_mul_f32 v35, v233, v233
    v_mfma_f32_16x16x32_bf16 v[128:131], a[40:43], a[88:91], v[128:131]
    v_mul_f32 v36, v234, v234
    v_mfma_f32_16x16x32_bf16 v[132:135], a[40:43], a[92:95], v[132:135]
    v_mul_f32 v37, v235, v235
    v_mul_f32 v38, v236, v236
    v_mfma_f32_16x16x32_bf16 v[136:139], a[40:43], a[96:99], v[136:139]
    v_mul_f32 v39, v237, v237
    v_mfma_f32_16x16x32_bf16 v[140:143], a[40:43], a[100:103], v[140:143]
    buffer_load_dwordx4 a[40:43], v50, s[12:15], s28 offen offset:0
    v_mul_f32 v40, v238, v238
    v_mfma_f32_16x16x32_bf16 v[144:147], a[44:47], a[88:91], v[144:147]
    v_mul_f32 v41, v239, v239
    v_fma_f32 v34, v34, v16, v20
    v_mfma_f32_16x16x32_bf16 v[148:151], a[44:47], a[92:95], v[148:151]
    v_fma_f32 v35, v35, v16, v20
    v_mfma_f32_16x16x32_bf16 v[152:155], a[44:47], a[96:99], v[152:155]
    v_fma_f32 v36, v36, v16, v20
    v_fma_f32 v37, v37, v16, v20
    v_mfma_f32_16x16x32_bf16 v[156:159], a[44:47], a[100:103], v[156:159]
    buffer_load_dwordx4 a[44:47], v51, s[12:15], s28 offen offset:0
    v_fma_f32 v38, v38, v17, v21
    s_waitcnt vmcnt(12) lgkmcnt(0)
    v_mfma_f32_16x16x32_bf16 v[64:67], a[48:51], a[72:75], v[64:67]
    v_fma_f32 v39, v39, v17, v21
    v_mfma_f32_16x16x32_bf16 v[68:71], a[48:51], a[76:79], v[68:71]
    ds_read_b128 a[88:91], v2 offset:15360
    v_fma_f32 v40, v40, v17, v21
    v_fma_f32 v41, v41, v17, v21
    v_mfma_f32_16x16x32_bf16 v[72:75], a[48:51], a[80:83], v[72:75]
    v_mul_f32 v34, v232, v34
    v_mfma_f32_16x16x32_bf16 v[76:79], a[48:51], a[84:87], v[76:79]
    buffer_load_dwordx4 a[48:51], v46, s[12:15], s28 offen offset:1024
    v_mul_f32 v35, v233, v35
    v_mfma_f32_16x16x32_bf16 v[80:83], a[52:55], a[72:75], v[80:83]
    v_mul_f32 v36, v234, v36
    v_mul_f32 v37, v235, v37
    v_mfma_f32_16x16x32_bf16 v[84:87], a[52:55], a[76:79], v[84:87]
    ds_read_b128 a[92:95], v2 offset:33792
    v_mul_f32 v38, v236, v38
    v_mfma_f32_16x16x32_bf16 v[88:91], a[52:55], a[80:83], v[88:91]
    v_mul_f32 v39, v237, v39
    v_mfma_f32_16x16x32_bf16 v[92:95], a[52:55], a[84:87], v[92:95]
    buffer_load_dwordx4 a[52:55], v47, s[12:15], s28 offen offset:1024
    v_mul_f32 v40, v238, v40
    v_mul_f32 v41, v239, v41
    v_mfma_f32_16x16x32_bf16 v[96:99], a[56:59], a[72:75], v[96:99]
    v_exp_f32 v34, v34
    v_mfma_f32_16x16x32_bf16 v[100:103], a[56:59], a[76:79], v[100:103]
    ds_read_b128 a[96:99], v3 offset:15360
    v_exp_f32 v35, v35
    v_exp_f32 v36, v36
    v_mfma_f32_16x16x32_bf16 v[104:107], a[56:59], a[80:83], v[104:107]
    v_exp_f32 v37, v37
    v_mfma_f32_16x16x32_bf16 v[108:111], a[56:59], a[84:87], v[108:111]
    buffer_load_dwordx4 a[56:59], v48, s[12:15], s28 offen offset:1024
    v_exp_f32 v38, v38
    v_mfma_f32_16x16x32_bf16 v[112:115], a[60:63], a[72:75], v[112:115]
    v_exp_f32 v39, v39
    v_exp_f32 v40, v40
    v_mfma_f32_16x16x32_bf16 v[116:119], a[60:63], a[76:79], v[116:119]
    ds_read_b128 a[100:103], v3 offset:33792
    v_exp_f32 v41, v41
    v_mfma_f32_16x16x32_bf16 v[120:123], a[60:63], a[80:83], v[120:123]
    v_fmac_f32 v248, v30, v12
    v_mfma_f32_16x16x32_bf16 v[124:127], a[60:63], a[84:87], v[124:127]
    buffer_load_dwordx4 a[60:63], v49, s[12:15], s28 offen offset:1024
    v_fmac_f32 v249, v31, v12
    v_fmac_f32 v250, v32, v12
    v_mfma_f32_16x16x32_bf16 v[128:131], a[64:67], a[72:75], v[128:131]
    v_fmac_f32 v251, v33, v12
    v_mfma_f32_16x16x32_bf16 v[132:135], a[64:67], a[76:79], v[132:135]
    v_fmac_f32 v252, v30, v13
    v_mfma_f32_16x16x32_bf16 v[136:139], a[64:67], a[80:83], v[136:139]
    v_fmac_f32 v253, v31, v13
    v_fmac_f32 v254, v32, v13
    v_mfma_f32_16x16x32_bf16 v[140:143], a[64:67], a[84:87], v[140:143]
    buffer_load_dwordx4 a[64:67], v50, s[12:15], s28 offen offset:1024
    v_fmac_f32 v255, v33, v13
    v_mfma_f32_16x16x32_bf16 v[144:147], a[68:71], a[72:75], v[144:147]
    v_fma_f32 v34, v34, v24, v24
    v_fma_f32 v35, v35, v24, v24
    v_mfma_f32_16x16x32_bf16 v[148:151], a[68:71], a[76:79], v[148:151]
    v_fma_f32 v36, v36, v24, v24
    v_mfma_f32_16x16x32_bf16 v[152:155], a[68:71], a[80:83], v[152:155]
    v_fma_f32 v37, v37, v24, v24
    v_mfma_f32_16x16x32_bf16 v[156:159], a[68:71], a[84:87], v[156:159]
    buffer_load_dwordx4 a[68:71], v51, s[12:15], s28 offen offset:1024
    v_fma_f32 v38, v38, v25, v25
    v_fma_f32 v39, v39, v25, v25
    s_waitcnt vmcnt(12) lgkmcnt(0)
    v_mfma_f32_16x16x32_bf16 v[64:67], a[0:3], a[88:91], v[64:67]
    v_fma_f32 v40, v40, v25, v25
    v_mfma_f32_16x16x32_bf16 v[68:71], a[0:3], a[92:95], v[68:71]
    ds_read_b128 a[72:75], v2 offset:16384
    v_fma_f32 v41, v41, v25, v25
    v_mfma_f32_16x16x32_bf16 v[72:75], a[0:3], a[96:99], v[72:75]
    v_rcp_f32 v34, v34
    v_rcp_f32 v35, v35
    v_mfma_f32_16x16x32_bf16 v[76:79], a[0:3], a[100:103], v[76:79]
    buffer_load_dwordx4 a[0:3], v52, s[12:15], s29 offen offset:0
    v_rcp_f32 v36, v36
    v_mfma_f32_16x16x32_bf16 v[80:83], a[4:7], a[88:91], v[80:83]
    v_rcp_f32 v37, v37
    v_rcp_f32 v38, v38
    v_mfma_f32_16x16x32_bf16 v[84:87], a[4:7], a[92:95], v[84:87]
    ds_read_b128 a[76:79], v2 offset:34816
    v_rcp_f32 v39, v39
    v_mfma_f32_16x16x32_bf16 v[88:91], a[4:7], a[96:99], v[88:91]
    v_rcp_f32 v40, v40
    v_mfma_f32_16x16x32_bf16 v[92:95], a[4:7], a[100:103], v[92:95]
    buffer_load_dwordx4 a[4:7], v53, s[12:15], s29 offen offset:0
    v_rcp_f32 v41, v41
    v_mul_f32 v248, v232, v248
    v_mfma_f32_16x16x32_bf16 v[96:99], a[8:11], a[88:91], v[96:99]
    v_mul_f32 v249, v233, v249
    v_mfma_f32_16x16x32_bf16 v[100:103], a[8:11], a[92:95], v[100:103]
    ds_read_b128 a[80:83], v3 offset:16384
    v_mul_f32 v250, v234, v250
    v_mfma_f32_16x16x32_bf16 v[104:107], a[8:11], a[96:99], v[104:107]
    v_mul_f32 v251, v235, v251
    v_mul_f32 v252, v236, v252
    v_mfma_f32_16x16x32_bf16 v[108:111], a[8:11], a[100:103], v[108:111]
    buffer_load_dwordx4 a[8:11], v54, s[12:15], s29 offen offset:0
    v_mul_f32 v253, v237, v253
    v_mfma_f32_16x16x32_bf16 v[112:115], a[12:15], a[88:91], v[112:115]
    v_mul_f32 v254, v238, v254
    v_mfma_f32_16x16x32_bf16 v[116:119], a[12:15], a[92:95], v[116:119]
    ds_read_b128 a[84:87], v3 offset:34816
    v_mul_f32 v255, v239, v255
    v_mul_f32 v34, v34, v248
    v_mfma_f32_16x16x32_bf16 v[120:123], a[12:15], a[96:99], v[120:123]
    v_mul_f32 v35, v35, v249
    v_mfma_f32_16x16x32_bf16 v[124:127], a[12:15], a[100:103], v[124:127]
    buffer_load_dwordx4 a[12:15], v55, s[12:15], s29 offen offset:0
    v_mul_f32 v36, v36, v250
    v_mul_f32 v37, v37, v251
    v_mfma_f32_16x16x32_bf16 v[128:131], a[16:19], a[88:91], v[128:131]
    v_mul_f32 v38, v38, v252
    v_mfma_f32_16x16x32_bf16 v[132:135], a[16:19], a[92:95], v[132:135]
    v_mul_f32 v39, v39, v253
    v_mfma_f32_16x16x32_bf16 v[136:139], a[16:19], a[96:99], v[136:139]
    v_mul_f32 v40, v40, v254
    v_mul_f32 v41, v41, v255
    v_mfma_f32_16x16x32_bf16 v[140:143], a[16:19], a[100:103], v[140:143]
    buffer_load_dwordx4 a[16:19], v56, s[12:15], s29 offen offset:0
    v_cvt_pk_bf16_f32 v42, v34, v35
    v_mfma_f32_16x16x32_bf16 v[144:147], a[20:23], a[88:91], v[144:147]
    v_cvt_pk_bf16_f32 v43, v36, v37
    v_mfma_f32_16x16x32_bf16 v[148:151], a[20:23], a[92:95], v[148:151]
    v_cvt_pk_bf16_f32 v44, v38, v39
    v_cvt_pk_bf16_f32 v45, v40, v41
    v_mfma_f32_16x16x32_bf16 v[152:155], a[20:23], a[96:99], v[152:155]
    ds_write_b64 v9, v[42:43] offset:7168
    v_mfma_f32_16x16x32_bf16 v[156:159], a[20:23], a[100:103], v[156:159]
    buffer_load_dwordx4 a[20:23], v57, s[12:15], s29 offen offset:0
    ds_write_b64 v9, v[44:45] offset:25600
    s_waitcnt vmcnt(12) lgkmcnt(2)
    v_mfma_f32_16x16x32_bf16 v[64:67], a[24:27], a[72:75], v[64:67]
    v_mfma_f32_16x16x32_bf16 v[68:71], a[24:27], a[76:79], v[68:71]
    ds_read_b128 a[88:91], v2 offset:17408
    v_mfma_f32_16x16x32_bf16 v[72:75], a[24:27], a[80:83], v[72:75]
    v_mfma_f32_16x16x32_bf16 v[76:79], a[24:27], a[84:87], v[76:79]
    buffer_load_dwordx4 a[24:27], v52, s[12:15], s29 offen offset:1024
    v_mfma_f32_16x16x32_bf16 v[80:83], a[28:31], a[72:75], v[80:83]
    v_mfma_f32_16x16x32_bf16 v[84:87], a[28:31], a[76:79], v[84:87]
    ds_read_b128 a[92:95], v2 offset:35840
    v_mfma_f32_16x16x32_bf16 v[88:91], a[28:31], a[80:83], v[88:91]
    v_mfma_f32_16x16x32_bf16 v[92:95], a[28:31], a[84:87], v[92:95]
    buffer_load_dwordx4 a[28:31], v53, s[12:15], s29 offen offset:1024
    v_mfma_f32_16x16x32_bf16 v[96:99], a[32:35], a[72:75], v[96:99]
    v_mfma_f32_16x16x32_bf16 v[100:103], a[32:35], a[76:79], v[100:103]
    ds_read_b128 a[96:99], v3 offset:17408
    v_mfma_f32_16x16x32_bf16 v[104:107], a[32:35], a[80:83], v[104:107]
    v_mfma_f32_16x16x32_bf16 v[108:111], a[32:35], a[84:87], v[108:111]
    buffer_load_dwordx4 a[32:35], v54, s[12:15], s29 offen offset:1024
    v_mfma_f32_16x16x32_bf16 v[112:115], a[36:39], a[72:75], v[112:115]
    v_mfma_f32_16x16x32_bf16 v[116:119], a[36:39], a[76:79], v[116:119]
    ds_read_b128 a[100:103], v3 offset:35840
    v_mfma_f32_16x16x32_bf16 v[120:123], a[36:39], a[80:83], v[120:123]
    v_mfma_f32_16x16x32_bf16 v[124:127], a[36:39], a[84:87], v[124:127]
    buffer_load_dwordx4 a[36:39], v55, s[12:15], s29 offen offset:1024
    v_mfma_f32_16x16x32_bf16 v[128:131], a[40:43], a[72:75], v[128:131]
    v_mfma_f32_16x16x32_bf16 v[132:135], a[40:43], a[76:79], v[132:135]
    v_mfma_f32_16x16x32_bf16 v[136:139], a[40:43], a[80:83], v[136:139]
    v_mfma_f32_16x16x32_bf16 v[140:143], a[40:43], a[84:87], v[140:143]
    buffer_load_dwordx4 a[40:43], v56, s[12:15], s29 offen offset:1024
    v_mfma_f32_16x16x32_bf16 v[144:147], a[44:47], a[72:75], v[144:147]
    v_mfma_f32_16x16x32_bf16 v[148:151], a[44:47], a[76:79], v[148:151]
    v_mfma_f32_16x16x32_bf16 v[152:155], a[44:47], a[80:83], v[152:155]
    v_mfma_f32_16x16x32_bf16 v[156:159], a[44:47], a[84:87], v[156:159]
    buffer_load_dwordx4 a[44:47], v57, s[12:15], s29 offen offset:1024
    s_waitcnt vmcnt(12) lgkmcnt(0)
    s_barrier
    ds_read_b128 a[72:75], v4 offset:0
    ds_read_b128 a[76:79], v4 offset:18432
    ds_read_b128 a[80:83], v5 offset:0
    ds_read_b128 a[84:87], v5 offset:18432
    v_mfma_f32_16x16x32_bf16 v[64:67], a[48:51], a[88:91], v[64:67]
    v_mfma_f32_16x16x32_bf16 v[68:71], a[48:51], a[92:95], v[68:71]
    v_mfma_f32_16x16x32_bf16 v[72:75], a[48:51], a[96:99], v[72:75]
    v_mfma_f32_16x16x32_bf16 v[76:79], a[48:51], a[100:103], v[76:79]
    buffer_load_dwordx4 a[48:51], v52, s[12:15], s29 offen offset:2048
    v_mfma_f32_16x16x32_bf16 v[80:83], a[52:55], a[88:91], v[80:83]
    v_mfma_f32_16x16x32_bf16 v[84:87], a[52:55], a[92:95], v[84:87]
    v_mfma_f32_16x16x32_bf16 v[88:91], a[52:55], a[96:99], v[88:91]
    v_mfma_f32_16x16x32_bf16 v[92:95], a[52:55], a[100:103], v[92:95]
    buffer_load_dwordx4 a[52:55], v53, s[12:15], s29 offen offset:2048
    v_mfma_f32_16x16x32_bf16 v[96:99], a[56:59], a[88:91], v[96:99]
    v_mfma_f32_16x16x32_bf16 v[100:103], a[56:59], a[92:95], v[100:103]
    v_mfma_f32_16x16x32_bf16 v[104:107], a[56:59], a[96:99], v[104:107]
    v_mfma_f32_16x16x32_bf16 v[108:111], a[56:59], a[100:103], v[108:111]
    buffer_load_dwordx4 a[56:59], v54, s[12:15], s29 offen offset:2048
    v_mfma_f32_16x16x32_bf16 v[112:115], a[60:63], a[88:91], v[112:115]
    v_mfma_f32_16x16x32_bf16 v[116:119], a[60:63], a[92:95], v[116:119]
    v_mfma_f32_16x16x32_bf16 v[120:123], a[60:63], a[96:99], v[120:123]
    v_mfma_f32_16x16x32_bf16 v[124:127], a[60:63], a[100:103], v[124:127]
    buffer_load_dwordx4 a[60:63], v55, s[12:15], s29 offen offset:2048
    v_mfma_f32_16x16x32_bf16 v[128:131], a[64:67], a[88:91], v[128:131]
    v_mfma_f32_16x16x32_bf16 v[132:135], a[64:67], a[92:95], v[132:135]
    v_mfma_f32_16x16x32_bf16 v[136:139], a[64:67], a[96:99], v[136:139]
    v_mfma_f32_16x16x32_bf16 v[140:143], a[64:67], a[100:103], v[140:143]
    buffer_load_dwordx4 a[64:67], v56, s[12:15], s29 offen offset:2048
    v_mfma_f32_16x16x32_bf16 v[144:147], a[68:71], a[88:91], v[144:147]
    v_mfma_f32_16x16x32_bf16 v[148:151], a[68:71], a[92:95], v[148:151]
    v_mfma_f32_16x16x32_bf16 v[152:155], a[68:71], a[96:99], v[152:155]
    v_mfma_f32_16x16x32_bf16 v[156:159], a[68:71], a[100:103], v[156:159]
    buffer_load_dwordx4 a[68:71], v57, s[12:15], s29 offen offset:2048
    s_waitcnt vmcnt(12) lgkmcnt(0)
    v_mfma_f32_16x16x32_bf16 v[160:163], a[0:3], a[72:75], 0
    ds_read_b128 v[26:29], v8 offset:3072
    ds_read_b128 v[30:33], v8 offset:3088
    v_mfma_f32_16x16x32_bf16 v[164:167], a[0:3], a[76:79], 0
    ds_read_b128 a[88:91], v4 offset:1024
    s_waitcnt lgkmcnt(1)
    v_fmac_f32 v64, v26, v10
    v_mfma_f32_16x16x32_bf16 v[168:171], a[0:3], a[80:83], 0
    v_fmac_f32 v65, v27, v10
    v_fmac_f32 v66, v28, v10
    v_mfma_f32_16x16x32_bf16 v[172:175], a[0:3], a[84:87], 0
    buffer_load_dwordx4 a[0:3], v52, s[12:15], s29 offen offset:3072
    v_fmac_f32 v67, v29, v10
    v_fmac_f32 v68, v26, v11
    v_mfma_f32_16x16x32_bf16 v[176:179], a[4:7], a[72:75], 0
    v_fmac_f32 v69, v27, v11
    v_fmac_f32 v70, v28, v11
    v_mfma_f32_16x16x32_bf16 v[180:183], a[4:7], a[76:79], 0
    ds_read_b128 a[92:95], v4 offset:19456
    v_fmac_f32 v71, v29, v11
    v_mul_f32 v34, v64, v64
    v_mfma_f32_16x16x32_bf16 v[184:187], a[4:7], a[80:83], 0
    v_mul_f32 v35, v65, v65
    v_mul_f32 v36, v66, v66
    v_mfma_f32_16x16x32_bf16 v[188:191], a[4:7], a[84:87], 0
    buffer_load_dwordx4 a[4:7], v53, s[12:15], s29 offen offset:3072
    v_mul_f32 v37, v67, v67
    v_mul_f32 v38, v68, v68
    v_mfma_f32_16x16x32_bf16 v[192:195], a[8:11], a[72:75], 0
    v_mul_f32 v39, v69, v69
    v_mul_f32 v40, v70, v70
    v_mfma_f32_16x16x32_bf16 v[196:199], a[8:11], a[76:79], 0
    ds_read_b128 a[96:99], v5 offset:1024
    v_mul_f32 v41, v71, v71
    v_fma_f32 v34, v34, v14, v18
    v_mfma_f32_16x16x32_bf16 v[200:203], a[8:11], a[80:83], 0
    v_fma_f32 v35, v35, v14, v18
    v_fma_f32 v36, v36, v14, v18
    v_mfma_f32_16x16x32_bf16 v[204:207], a[8:11], a[84:87], 0
    buffer_load_dwordx4 a[8:11], v54, s[12:15], s29 offen offset:3072
    v_fma_f32 v37, v37, v14, v18
    v_fma_f32 v38, v38, v15, v19
    v_mfma_f32_16x16x32_bf16 v[208:211], a[12:15], a[72:75], 0
    v_fma_f32 v39, v39, v15, v19
    v_fma_f32 v40, v40, v15, v19
    v_mfma_f32_16x16x32_bf16 v[212:215], a[12:15], a[76:79], 0
    ds_read_b128 a[100:103], v5 offset:19456
    v_fma_f32 v41, v41, v15, v19
    v_mul_f32 v34, v64, v34
    v_mfma_f32_16x16x32_bf16 v[216:219], a[12:15], a[80:83], 0
    v_mul_f32 v35, v65, v35
    v_mul_f32 v36, v66, v36
    v_mfma_f32_16x16x32_bf16 v[220:223], a[12:15], a[84:87], 0
    buffer_load_dwordx4 a[12:15], v55, s[12:15], s29 offen offset:3072
    v_mul_f32 v37, v67, v37
    v_mul_f32 v38, v68, v38
    v_mfma_f32_16x16x32_bf16 v[224:227], a[16:19], a[72:75], 0
    v_mul_f32 v39, v69, v39
    v_mul_f32 v40, v70, v40
    v_mfma_f32_16x16x32_bf16 v[228:231], a[16:19], a[76:79], 0
    v_mul_f32 v41, v71, v41
    v_exp_f32 v34, v34
    v_mfma_f32_16x16x32_bf16 v[232:235], a[16:19], a[80:83], 0
    v_exp_f32 v35, v35
    v_exp_f32 v36, v36
    v_mfma_f32_16x16x32_bf16 v[236:239], a[16:19], a[84:87], 0
    buffer_load_dwordx4 a[16:19], v56, s[12:15], s29 offen offset:3072
    v_exp_f32 v37, v37
    v_exp_f32 v38, v38
    v_mfma_f32_16x16x32_bf16 v[240:243], a[20:23], a[72:75], 0
    v_exp_f32 v39, v39
    v_exp_f32 v40, v40
    v_mfma_f32_16x16x32_bf16 v[244:247], a[20:23], a[76:79], 0
    v_exp_f32 v41, v41
    v_fmac_f32 v80, v30, v10
    v_mfma_f32_16x16x32_bf16 v[248:251], a[20:23], a[80:83], 0
    v_fmac_f32 v81, v31, v10
    v_fmac_f32 v82, v32, v10
    v_mfma_f32_16x16x32_bf16 v[252:255], a[20:23], a[84:87], 0
    buffer_load_dwordx4 a[20:23], v57, s[12:15], s29 offen offset:3072
    v_fmac_f32 v83, v33, v10
    v_fmac_f32 v84, v30, v11
    s_waitcnt vmcnt(12) lgkmcnt(0)
    v_mfma_f32_16x16x32_bf16 v[160:163], a[24:27], a[88:91], v[160:163]
    v_fmac_f32 v85, v31, v11
    v_fmac_f32 v86, v32, v11
    v_mfma_f32_16x16x32_bf16 v[164:167], a[24:27], a[92:95], v[164:167]
    ds_read_b128 a[72:75], v4 offset:2048
    v_fmac_f32 v87, v33, v11
    v_fma_f32 v34, v34, v22, v22
    v_mfma_f32_16x16x32_bf16 v[168:171], a[24:27], a[96:99], v[168:171]
    v_fma_f32 v35, v35, v22, v22
    v_fma_f32 v36, v36, v22, v22
    v_mfma_f32_16x16x32_bf16 v[172:175], a[24:27], a[100:103], v[172:175]
    s_add_u32 s29, s29, 4096
    buffer_load_dwordx4 a[24:27], v52, s[12:15], s29 offen offset:0
    v_fma_f32 v37, v37, v22, v22
    v_fma_f32 v38, v38, v23, v23
    v_mfma_f32_16x16x32_bf16 v[176:179], a[28:31], a[88:91], v[176:179]
    v_fma_f32 v39, v39, v23, v23
    v_fma_f32 v40, v40, v23, v23
    v_mfma_f32_16x16x32_bf16 v[180:183], a[28:31], a[92:95], v[180:183]
    ds_read_b128 a[76:79], v4 offset:20480
    v_fma_f32 v41, v41, v23, v23
    v_rcp_f32 v34, v34
    v_mfma_f32_16x16x32_bf16 v[184:187], a[28:31], a[96:99], v[184:187]
    v_rcp_f32 v35, v35
    v_rcp_f32 v36, v36
    v_mfma_f32_16x16x32_bf16 v[188:191], a[28:31], a[100:103], v[188:191]
    buffer_load_dwordx4 a[28:31], v53, s[12:15], s29 offen offset:0
    v_rcp_f32 v37, v37
    v_rcp_f32 v38, v38
    v_mfma_f32_16x16x32_bf16 v[192:195], a[32:35], a[88:91], v[192:195]
    v_rcp_f32 v39, v39
    v_rcp_f32 v40, v40
    v_mfma_f32_16x16x32_bf16 v[196:199], a[32:35], a[92:95], v[196:199]
    ds_read_b128 a[80:83], v5 offset:2048
    v_rcp_f32 v41, v41
    v_mul_f32 v80, v64, v80
    v_mfma_f32_16x16x32_bf16 v[200:203], a[32:35], a[96:99], v[200:203]
    v_mul_f32 v81, v65, v81
    v_mul_f32 v82, v66, v82
    v_mfma_f32_16x16x32_bf16 v[204:207], a[32:35], a[100:103], v[204:207]
    buffer_load_dwordx4 a[32:35], v54, s[12:15], s29 offen offset:0
    v_mul_f32 v83, v67, v83
    v_mul_f32 v84, v68, v84
    v_mfma_f32_16x16x32_bf16 v[208:211], a[36:39], a[88:91], v[208:211]
    v_mul_f32 v85, v69, v85
    v_mul_f32 v86, v70, v86
    v_mfma_f32_16x16x32_bf16 v[212:215], a[36:39], a[92:95], v[212:215]
    ds_read_b128 a[84:87], v5 offset:20480
    v_mul_f32 v87, v71, v87
    v_mul_f32 v34, v34, v80
    v_mfma_f32_16x16x32_bf16 v[216:219], a[36:39], a[96:99], v[216:219]
    v_mul_f32 v35, v35, v81
    v_mul_f32 v36, v36, v82
    v_mfma_f32_16x16x32_bf16 v[220:223], a[36:39], a[100:103], v[220:223]
    buffer_load_dwordx4 a[36:39], v55, s[12:15], s29 offen offset:0
    v_mul_f32 v37, v37, v83
    v_mul_f32 v38, v38, v84
    v_mfma_f32_16x16x32_bf16 v[224:227], a[40:43], a[88:91], v[224:227]
    v_mul_f32 v39, v39, v85
    v_mul_f32 v40, v40, v86
    v_mfma_f32_16x16x32_bf16 v[228:231], a[40:43], a[92:95], v[228:231]
    v_mul_f32 v41, v41, v87
    v_cvt_pk_bf16_f32 v42, v34, v35
    v_mfma_f32_16x16x32_bf16 v[232:235], a[40:43], a[96:99], v[232:235]
    v_cvt_pk_bf16_f32 v43, v36, v37
    v_cvt_pk_bf16_f32 v44, v38, v39
    v_mfma_f32_16x16x32_bf16 v[236:239], a[40:43], a[100:103], v[236:239]
    buffer_load_dwordx4 a[40:43], v56, s[12:15], s29 offen offset:0
    v_cvt_pk_bf16_f32 v45, v40, v41
    ds_write_b64 v6, v[42:43] offset:12288
    v_mfma_f32_16x16x32_bf16 v[240:243], a[44:47], a[88:91], v[240:243]
    ds_write_b64 v6, v[44:45] offset:30720
    v_fmac_f32 v72, v26, v12
    v_mfma_f32_16x16x32_bf16 v[244:247], a[44:47], a[92:95], v[244:247]
    v_fmac_f32 v73, v27, v12
    v_fmac_f32 v74, v28, v12
    v_mfma_f32_16x16x32_bf16 v[248:251], a[44:47], a[96:99], v[248:251]
    v_fmac_f32 v75, v29, v12
    v_fmac_f32 v76, v26, v13
    v_mfma_f32_16x16x32_bf16 v[252:255], a[44:47], a[100:103], v[252:255]
    buffer_load_dwordx4 a[44:47], v57, s[12:15], s29 offen offset:0
    v_fmac_f32 v77, v27, v13
    v_fmac_f32 v78, v28, v13
    s_waitcnt vmcnt(12) lgkmcnt(2)
    v_mfma_f32_16x16x32_bf16 v[160:163], a[48:51], a[72:75], v[160:163]
    v_fmac_f32 v79, v29, v13
    v_mul_f32 v34, v72, v72
    v_mfma_f32_16x16x32_bf16 v[164:167], a[48:51], a[76:79], v[164:167]
    ds_read_b128 a[88:91], v4 offset:3072
    v_mul_f32 v35, v73, v73
    v_mul_f32 v36, v74, v74
    v_mfma_f32_16x16x32_bf16 v[168:171], a[48:51], a[80:83], v[168:171]
    v_mul_f32 v37, v75, v75
    v_mul_f32 v38, v76, v76
    v_mfma_f32_16x16x32_bf16 v[172:175], a[48:51], a[84:87], v[172:175]
    buffer_load_dwordx4 a[48:51], v52, s[12:15], s29 offen offset:1024
    v_mul_f32 v39, v77, v77
    v_mul_f32 v40, v78, v78
    v_mfma_f32_16x16x32_bf16 v[176:179], a[52:55], a[72:75], v[176:179]
    v_mul_f32 v41, v79, v79
    v_fma_f32 v34, v34, v16, v20
    v_mfma_f32_16x16x32_bf16 v[180:183], a[52:55], a[76:79], v[180:183]
    ds_read_b128 a[92:95], v4 offset:21504
    v_fma_f32 v35, v35, v16, v20
    v_fma_f32 v36, v36, v16, v20
    v_mfma_f32_16x16x32_bf16 v[184:187], a[52:55], a[80:83], v[184:187]
    v_fma_f32 v37, v37, v16, v20
    v_fma_f32 v38, v38, v17, v21
    v_mfma_f32_16x16x32_bf16 v[188:191], a[52:55], a[84:87], v[188:191]
    buffer_load_dwordx4 a[52:55], v53, s[12:15], s29 offen offset:1024
    v_fma_f32 v39, v39, v17, v21
    v_fma_f32 v40, v40, v17, v21
    v_mfma_f32_16x16x32_bf16 v[192:195], a[56:59], a[72:75], v[192:195]
    v_fma_f32 v41, v41, v17, v21
    v_mul_f32 v34, v72, v34
    v_mfma_f32_16x16x32_bf16 v[196:199], a[56:59], a[76:79], v[196:199]
    ds_read_b128 a[96:99], v5 offset:3072
    v_mul_f32 v35, v73, v35
    v_mul_f32 v36, v74, v36
    v_mfma_f32_16x16x32_bf16 v[200:203], a[56:59], a[80:83], v[200:203]
    v_mul_f32 v37, v75, v37
    v_mul_f32 v38, v76, v38
    v_mfma_f32_16x16x32_bf16 v[204:207], a[56:59], a[84:87], v[204:207]
    buffer_load_dwordx4 a[56:59], v54, s[12:15], s29 offen offset:1024
    v_mul_f32 v39, v77, v39
    v_mul_f32 v40, v78, v40
    v_mfma_f32_16x16x32_bf16 v[208:211], a[60:63], a[72:75], v[208:211]
    v_mul_f32 v41, v79, v41
    v_exp_f32 v34, v34
    v_mfma_f32_16x16x32_bf16 v[212:215], a[60:63], a[76:79], v[212:215]
    ds_read_b128 a[100:103], v5 offset:21504
    v_exp_f32 v35, v35
    v_exp_f32 v36, v36
    v_mfma_f32_16x16x32_bf16 v[216:219], a[60:63], a[80:83], v[216:219]
    v_exp_f32 v37, v37
    v_exp_f32 v38, v38
    v_mfma_f32_16x16x32_bf16 v[220:223], a[60:63], a[84:87], v[220:223]
    buffer_load_dwordx4 a[60:63], v55, s[12:15], s29 offen offset:1024
    v_exp_f32 v39, v39
    v_exp_f32 v40, v40
    v_mfma_f32_16x16x32_bf16 v[224:227], a[64:67], a[72:75], v[224:227]
    v_exp_f32 v41, v41
    v_fmac_f32 v88, v30, v12
    v_mfma_f32_16x16x32_bf16 v[228:231], a[64:67], a[76:79], v[228:231]
    v_fmac_f32 v89, v31, v12
    v_fmac_f32 v90, v32, v12
    v_mfma_f32_16x16x32_bf16 v[232:235], a[64:67], a[80:83], v[232:235]
    v_fmac_f32 v91, v33, v12
    v_fmac_f32 v92, v30, v13
    v_mfma_f32_16x16x32_bf16 v[236:239], a[64:67], a[84:87], v[236:239]
    buffer_load_dwordx4 a[64:67], v56, s[12:15], s29 offen offset:1024
    v_fmac_f32 v93, v31, v13
    v_fmac_f32 v94, v32, v13
    v_mfma_f32_16x16x32_bf16 v[240:243], a[68:71], a[72:75], v[240:243]
    v_fmac_f32 v95, v33, v13
    v_fma_f32 v34, v34, v24, v24
    v_mfma_f32_16x16x32_bf16 v[244:247], a[68:71], a[76:79], v[244:247]
    v_fma_f32 v35, v35, v24, v24
    v_fma_f32 v36, v36, v24, v24
    v_mfma_f32_16x16x32_bf16 v[248:251], a[68:71], a[80:83], v[248:251]
    v_fma_f32 v37, v37, v24, v24
    v_fma_f32 v38, v38, v25, v25
    v_mfma_f32_16x16x32_bf16 v[252:255], a[68:71], a[84:87], v[252:255]
    buffer_load_dwordx4 a[68:71], v57, s[12:15], s29 offen offset:1024
    v_fma_f32 v39, v39, v25, v25
    v_fma_f32 v40, v40, v25, v25
    s_waitcnt vmcnt(12) lgkmcnt(0)
    v_mfma_f32_16x16x32_bf16 v[160:163], a[0:3], a[88:91], v[160:163]
    v_fma_f32 v41, v41, v25, v25
    v_rcp_f32 v34, v34
    v_mfma_f32_16x16x32_bf16 v[164:167], a[0:3], a[92:95], v[164:167]
    ds_read_b128 a[72:75], v4 offset:4096
    v_rcp_f32 v35, v35
    v_rcp_f32 v36, v36
    v_mfma_f32_16x16x32_bf16 v[168:171], a[0:3], a[96:99], v[168:171]
    v_rcp_f32 v37, v37
    v_rcp_f32 v38, v38
    v_mfma_f32_16x16x32_bf16 v[172:175], a[0:3], a[100:103], v[172:175]
    buffer_load_dwordx4 a[0:3], v52, s[12:15], s29 offen offset:2048
    v_rcp_f32 v39, v39
    v_rcp_f32 v40, v40
    v_mfma_f32_16x16x32_bf16 v[176:179], a[4:7], a[88:91], v[176:179]
    v_rcp_f32 v41, v41
    v_mul_f32 v88, v72, v88
    v_mfma_f32_16x16x32_bf16 v[180:183], a[4:7], a[92:95], v[180:183]
    ds_read_b128 a[76:79], v4 offset:22528
    v_mul_f32 v89, v73, v89
    v_mul_f32 v90, v74, v90
    v_mfma_f32_16x16x32_bf16 v[184:187], a[4:7], a[96:99], v[184:187]
    v_mul_f32 v91, v75, v91
    v_mul_f32 v92, v76, v92
    v_mfma_f32_16x16x32_bf16 v[188:191], a[4:7], a[100:103], v[188:191]
    buffer_load_dwordx4 a[4:7], v53, s[12:15], s29 offen offset:2048
    v_mul_f32 v93, v77, v93
    v_mul_f32 v94, v78, v94
    v_mfma_f32_16x16x32_bf16 v[192:195], a[8:11], a[88:91], v[192:195]
    v_mul_f32 v95, v79, v95
    v_mul_f32 v34, v34, v88
    v_mfma_f32_16x16x32_bf16 v[196:199], a[8:11], a[92:95], v[196:199]
    ds_read_b128 a[80:83], v5 offset:4096
    v_mul_f32 v35, v35, v89
    v_mul_f32 v36, v36, v90
    v_mfma_f32_16x16x32_bf16 v[200:203], a[8:11], a[96:99], v[200:203]
    v_mul_f32 v37, v37, v91
    v_mul_f32 v38, v38, v92
    v_mfma_f32_16x16x32_bf16 v[204:207], a[8:11], a[100:103], v[204:207]
    buffer_load_dwordx4 a[8:11], v54, s[12:15], s29 offen offset:2048
    v_mul_f32 v39, v39, v93
    v_mul_f32 v40, v40, v94
    v_mfma_f32_16x16x32_bf16 v[208:211], a[12:15], a[88:91], v[208:211]
    v_mul_f32 v41, v41, v95
    v_cvt_pk_bf16_f32 v42, v34, v35
    v_mfma_f32_16x16x32_bf16 v[212:215], a[12:15], a[92:95], v[212:215]
    ds_read_b128 a[84:87], v5 offset:22528
    v_cvt_pk_bf16_f32 v43, v36, v37
    v_cvt_pk_bf16_f32 v44, v38, v39
    v_mfma_f32_16x16x32_bf16 v[216:219], a[12:15], a[96:99], v[216:219]
    v_cvt_pk_bf16_f32 v45, v40, v41
    ds_write_b64 v9, v[42:43] offset:12288
    v_mfma_f32_16x16x32_bf16 v[220:223], a[12:15], a[100:103], v[220:223]
    buffer_load_dwordx4 a[12:15], v55, s[12:15], s29 offen offset:2048
    ds_write_b64 v9, v[44:45] offset:30720
    v_mfma_f32_16x16x32_bf16 v[224:227], a[16:19], a[88:91], v[224:227]
    ds_read_b128 v[26:29], v8 offset:3200
    ds_read_b128 v[30:33], v8 offset:3216
    v_mfma_f32_16x16x32_bf16 v[228:231], a[16:19], a[92:95], v[228:231]
    s_waitcnt lgkmcnt(0)
    v_fmac_f32 v96, v26, v10
    v_mfma_f32_16x16x32_bf16 v[232:235], a[16:19], a[96:99], v[232:235]
    v_fmac_f32 v97, v27, v10
    v_fmac_f32 v98, v28, v10
    v_mfma_f32_16x16x32_bf16 v[236:239], a[16:19], a[100:103], v[236:239]
    buffer_load_dwordx4 a[16:19], v56, s[12:15], s29 offen offset:2048
    v_fmac_f32 v99, v29, v10
    v_fmac_f32 v100, v26, v11
    v_mfma_f32_16x16x32_bf16 v[240:243], a[20:23], a[88:91], v[240:243]
    v_fmac_f32 v101, v27, v11
    v_fmac_f32 v102, v28, v11
    v_mfma_f32_16x16x32_bf16 v[244:247], a[20:23], a[92:95], v[244:247]
    v_fmac_f32 v103, v29, v11
    v_mul_f32 v34, v96, v96
    v_mfma_f32_16x16x32_bf16 v[248:251], a[20:23], a[96:99], v[248:251]
    v_mul_f32 v35, v97, v97
    v_mul_f32 v36, v98, v98
    v_mfma_f32_16x16x32_bf16 v[252:255], a[20:23], a[100:103], v[252:255]
    buffer_load_dwordx4 a[20:23], v57, s[12:15], s29 offen offset:2048
    v_mul_f32 v37, v99, v99
    v_mul_f32 v38, v100, v100
    s_waitcnt vmcnt(12)
    v_mfma_f32_16x16x32_bf16 v[160:163], a[24:27], a[72:75], v[160:163]
    v_mul_f32 v39, v101, v101
    v_mul_f32 v40, v102, v102
    v_mfma_f32_16x16x32_bf16 v[164:167], a[24:27], a[76:79], v[164:167]
    ds_read_b128 a[88:91], v4 offset:5120
    v_mul_f32 v41, v103, v103
    v_fma_f32 v34, v34, v14, v18
    v_mfma_f32_16x16x32_bf16 v[168:171], a[24:27], a[80:83], v[168:171]
    v_fma_f32 v35, v35, v14, v18
    v_fma_f32 v36, v36, v14, v18
    v_mfma_f32_16x16x32_bf16 v[172:175], a[24:27], a[84:87], v[172:175]
    buffer_load_dwordx4 a[24:27], v52, s[12:15], s29 offen offset:3072
    v_fma_f32 v37, v37, v14, v18
    v_fma_f32 v38, v38, v15, v19
    v_mfma_f32_16x16x32_bf16 v[176:179], a[28:31], a[72:75], v[176:179]
    v_fma_f32 v39, v39, v15, v19
    v_fma_f32 v40, v40, v15, v19
    v_mfma_f32_16x16x32_bf16 v[180:183], a[28:31], a[76:79], v[180:183]
    ds_read_b128 a[92:95], v4 offset:23552
    v_fma_f32 v41, v41, v15, v19
    v_mul_f32 v34, v96, v34
    v_mfma_f32_16x16x32_bf16 v[184:187], a[28:31], a[80:83], v[184:187]
    v_mul_f32 v35, v97, v35
    v_mul_f32 v36, v98, v36
    v_mfma_f32_16x16x32_bf16 v[188:191], a[28:31], a[84:87], v[188:191]
    buffer_load_dwordx4 a[28:31], v53, s[12:15], s29 offen offset:3072
    v_mul_f32 v37, v99, v37
    v_mul_f32 v38, v100, v38
    v_mfma_f32_16x16x32_bf16 v[192:195], a[32:35], a[72:75], v[192:195]
    v_mul_f32 v39, v101, v39
    v_mul_f32 v40, v102, v40
    v_mfma_f32_16x16x32_bf16 v[196:199], a[32:35], a[76:79], v[196:199]
    ds_read_b128 a[96:99], v5 offset:5120
    v_mul_f32 v41, v103, v41
    v_exp_f32 v34, v34
    v_mfma_f32_16x16x32_bf16 v[200:203], a[32:35], a[80:83], v[200:203]
    v_exp_f32 v35, v35
    v_exp_f32 v36, v36
    v_mfma_f32_16x16x32_bf16 v[204:207], a[32:35], a[84:87], v[204:207]
    buffer_load_dwordx4 a[32:35], v54, s[12:15], s29 offen offset:3072
    v_exp_f32 v37, v37
    v_exp_f32 v38, v38
    v_mfma_f32_16x16x32_bf16 v[208:211], a[36:39], a[72:75], v[208:211]
    v_exp_f32 v39, v39
    v_exp_f32 v40, v40
    v_mfma_f32_16x16x32_bf16 v[212:215], a[36:39], a[76:79], v[212:215]
    ds_read_b128 a[100:103], v5 offset:23552
    v_exp_f32 v41, v41
    v_fmac_f32 v112, v30, v10
    v_mfma_f32_16x16x32_bf16 v[216:219], a[36:39], a[80:83], v[216:219]
    v_fmac_f32 v113, v31, v10
    v_fmac_f32 v114, v32, v10
    v_mfma_f32_16x16x32_bf16 v[220:223], a[36:39], a[84:87], v[220:223]
    buffer_load_dwordx4 a[36:39], v55, s[12:15], s29 offen offset:3072
    v_fmac_f32 v115, v33, v10
    v_fmac_f32 v116, v30, v11
    v_mfma_f32_16x16x32_bf16 v[224:227], a[40:43], a[72:75], v[224:227]
    v_fmac_f32 v117, v31, v11
    v_fmac_f32 v118, v32, v11
    v_mfma_f32_16x16x32_bf16 v[228:231], a[40:43], a[76:79], v[228:231]
    v_fmac_f32 v119, v33, v11
    v_fma_f32 v34, v34, v22, v22
    v_mfma_f32_16x16x32_bf16 v[232:235], a[40:43], a[80:83], v[232:235]
    v_fma_f32 v35, v35, v22, v22
    v_fma_f32 v36, v36, v22, v22
    v_mfma_f32_16x16x32_bf16 v[236:239], a[40:43], a[84:87], v[236:239]
    buffer_load_dwordx4 a[40:43], v56, s[12:15], s29 offen offset:3072
    v_fma_f32 v37, v37, v22, v22
    v_fma_f32 v38, v38, v23, v23
    v_mfma_f32_16x16x32_bf16 v[240:243], a[44:47], a[72:75], v[240:243]
    v_fma_f32 v39, v39, v23, v23
    v_fma_f32 v40, v40, v23, v23
    v_mfma_f32_16x16x32_bf16 v[244:247], a[44:47], a[76:79], v[244:247]
    v_fma_f32 v41, v41, v23, v23
    v_rcp_f32 v34, v34
    v_mfma_f32_16x16x32_bf16 v[248:251], a[44:47], a[80:83], v[248:251]
    v_rcp_f32 v35, v35
    v_rcp_f32 v36, v36
    v_mfma_f32_16x16x32_bf16 v[252:255], a[44:47], a[84:87], v[252:255]
    buffer_load_dwordx4 a[44:47], v57, s[12:15], s29 offen offset:3072
    v_rcp_f32 v37, v37
    v_rcp_f32 v38, v38
    s_waitcnt vmcnt(12) lgkmcnt(0)
    v_mfma_f32_16x16x32_bf16 v[160:163], a[48:51], a[88:91], v[160:163]
    v_rcp_f32 v39, v39
    v_rcp_f32 v40, v40
    v_mfma_f32_16x16x32_bf16 v[164:167], a[48:51], a[92:95], v[164:167]
    ds_read_b128 a[72:75], v4 offset:6144
    v_rcp_f32 v41, v41
    v_mul_f32 v112, v96, v112
    v_mfma_f32_16x16x32_bf16 v[168:171], a[48:51], a[96:99], v[168:171]
    v_mul_f32 v113, v97, v113
    v_mul_f32 v114, v98, v114
    v_mfma_f32_16x16x32_bf16 v[172:175], a[48:51], a[100:103], v[172:175]
    s_add_u32 s29, s29, 4096
    buffer_load_dwordx4 a[48:51], v52, s[12:15], s29 offen offset:0
    v_mul_f32 v115, v99, v115
    v_mul_f32 v116, v100, v116
    v_mfma_f32_16x16x32_bf16 v[176:179], a[52:55], a[88:91], v[176:179]
    v_mul_f32 v117, v101, v117
    v_mul_f32 v118, v102, v118
    v_mfma_f32_16x16x32_bf16 v[180:183], a[52:55], a[92:95], v[180:183]
    ds_read_b128 a[76:79], v4 offset:24576
    v_mul_f32 v119, v103, v119
    v_mul_f32 v34, v34, v112
    v_mfma_f32_16x16x32_bf16 v[184:187], a[52:55], a[96:99], v[184:187]
    v_mul_f32 v35, v35, v113
    v_mul_f32 v36, v36, v114
    v_mfma_f32_16x16x32_bf16 v[188:191], a[52:55], a[100:103], v[188:191]
    buffer_load_dwordx4 a[52:55], v53, s[12:15], s29 offen offset:0
    v_mul_f32 v37, v37, v115
    v_mul_f32 v38, v38, v116
    v_mfma_f32_16x16x32_bf16 v[192:195], a[56:59], a[88:91], v[192:195]
    v_mul_f32 v39, v39, v117
    v_mul_f32 v40, v40, v118
    v_mfma_f32_16x16x32_bf16 v[196:199], a[56:59], a[92:95], v[196:199]
    ds_read_b128 a[80:83], v5 offset:6144
    v_mul_f32 v41, v41, v119
    v_cvt_pk_bf16_f32 v42, v34, v35
    v_mfma_f32_16x16x32_bf16 v[200:203], a[56:59], a[96:99], v[200:203]
    v_cvt_pk_bf16_f32 v43, v36, v37
    v_cvt_pk_bf16_f32 v44, v38, v39
    v_mfma_f32_16x16x32_bf16 v[204:207], a[56:59], a[100:103], v[204:207]
    buffer_load_dwordx4 a[56:59], v54, s[12:15], s29 offen offset:0
    v_cvt_pk_bf16_f32 v45, v40, v41
    ds_write_b64 v7, v[42:43] offset:12288
    v_mfma_f32_16x16x32_bf16 v[208:211], a[60:63], a[88:91], v[208:211]
    ds_write_b64 v7, v[44:45] offset:30720
    v_fmac_f32 v104, v26, v12
    v_mfma_f32_16x16x32_bf16 v[212:215], a[60:63], a[92:95], v[212:215]
    ds_read_b128 a[84:87], v5 offset:24576
    v_fmac_f32 v105, v27, v12
    v_fmac_f32 v106, v28, v12
    v_mfma_f32_16x16x32_bf16 v[216:219], a[60:63], a[96:99], v[216:219]
    v_fmac_f32 v107, v29, v12
    v_fmac_f32 v108, v26, v13
    v_mfma_f32_16x16x32_bf16 v[220:223], a[60:63], a[100:103], v[220:223]
    buffer_load_dwordx4 a[60:63], v55, s[12:15], s29 offen offset:0
    v_fmac_f32 v109, v27, v13
    v_fmac_f32 v110, v28, v13
    v_mfma_f32_16x16x32_bf16 v[224:227], a[64:67], a[88:91], v[224:227]
    v_fmac_f32 v111, v29, v13
    v_mul_f32 v34, v104, v104
    v_mfma_f32_16x16x32_bf16 v[228:231], a[64:67], a[92:95], v[228:231]
    v_mul_f32 v35, v105, v105
    v_mul_f32 v36, v106, v106
    v_mfma_f32_16x16x32_bf16 v[232:235], a[64:67], a[96:99], v[232:235]
    v_mul_f32 v37, v107, v107
    v_mul_f32 v38, v108, v108
    v_mfma_f32_16x16x32_bf16 v[236:239], a[64:67], a[100:103], v[236:239]
    buffer_load_dwordx4 a[64:67], v56, s[12:15], s29 offen offset:0
    v_mul_f32 v39, v109, v109
    v_mul_f32 v40, v110, v110
    v_mfma_f32_16x16x32_bf16 v[240:243], a[68:71], a[88:91], v[240:243]
    v_mul_f32 v41, v111, v111
    v_fma_f32 v34, v34, v16, v20
    v_mfma_f32_16x16x32_bf16 v[244:247], a[68:71], a[92:95], v[244:247]
    v_fma_f32 v35, v35, v16, v20
    v_fma_f32 v36, v36, v16, v20
    v_mfma_f32_16x16x32_bf16 v[248:251], a[68:71], a[96:99], v[248:251]
    v_fma_f32 v37, v37, v16, v20
    v_fma_f32 v38, v38, v17, v21
    v_mfma_f32_16x16x32_bf16 v[252:255], a[68:71], a[100:103], v[252:255]
    buffer_load_dwordx4 a[68:71], v57, s[12:15], s29 offen offset:0
    v_fma_f32 v39, v39, v17, v21
    v_fma_f32 v40, v40, v17, v21
    s_waitcnt vmcnt(12) lgkmcnt(0)
    v_mfma_f32_16x16x32_bf16 v[160:163], a[0:3], a[72:75], v[160:163]
    v_fma_f32 v41, v41, v17, v21
    v_mul_f32 v34, v104, v34
    v_mfma_f32_16x16x32_bf16 v[164:167], a[0:3], a[76:79], v[164:167]
    ds_read_b128 a[88:91], v4 offset:7168
    v_mul_f32 v35, v105, v35
    v_mul_f32 v36, v106, v36
    v_mfma_f32_16x16x32_bf16 v[168:171], a[0:3], a[80:83], v[168:171]
    v_mul_f32 v37, v107, v37
    v_mul_f32 v38, v108, v38
    v_mfma_f32_16x16x32_bf16 v[172:175], a[0:3], a[84:87], v[172:175]
    buffer_load_dwordx4 a[0:3], v52, s[12:15], s29 offen offset:1024
    v_mul_f32 v39, v109, v39
    v_mul_f32 v40, v110, v40
    v_mfma_f32_16x16x32_bf16 v[176:179], a[4:7], a[72:75], v[176:179]
    v_mul_f32 v41, v111, v41
    v_exp_f32 v34, v34
    v_mfma_f32_16x16x32_bf16 v[180:183], a[4:7], a[76:79], v[180:183]
    ds_read_b128 a[92:95], v4 offset:25600
    v_exp_f32 v35, v35
    v_exp_f32 v36, v36
    v_mfma_f32_16x16x32_bf16 v[184:187], a[4:7], a[80:83], v[184:187]
    v_exp_f32 v37, v37
    v_exp_f32 v38, v38
    v_mfma_f32_16x16x32_bf16 v[188:191], a[4:7], a[84:87], v[188:191]
    buffer_load_dwordx4 a[4:7], v53, s[12:15], s29 offen offset:1024
    v_exp_f32 v39, v39
    v_exp_f32 v40, v40
    v_mfma_f32_16x16x32_bf16 v[192:195], a[8:11], a[72:75], v[192:195]
    v_exp_f32 v41, v41
    v_fmac_f32 v120, v30, v12
    v_mfma_f32_16x16x32_bf16 v[196:199], a[8:11], a[76:79], v[196:199]
    ds_read_b128 a[96:99], v5 offset:7168
    v_fmac_f32 v121, v31, v12
    v_fmac_f32 v122, v32, v12
    v_mfma_f32_16x16x32_bf16 v[200:203], a[8:11], a[80:83], v[200:203]
    v_fmac_f32 v123, v33, v12
    v_fmac_f32 v124, v30, v13
    v_mfma_f32_16x16x32_bf16 v[204:207], a[8:11], a[84:87], v[204:207]
    buffer_load_dwordx4 a[8:11], v54, s[12:15], s29 offen offset:1024
    v_fmac_f32 v125, v31, v13
    v_fmac_f32 v126, v32, v13
    v_mfma_f32_16x16x32_bf16 v[208:211], a[12:15], a[72:75], v[208:211]
    v_fmac_f32 v127, v33, v13
    v_fma_f32 v34, v34, v24, v24
    v_mfma_f32_16x16x32_bf16 v[212:215], a[12:15], a[76:79], v[212:215]
    ds_read_b128 a[100:103], v5 offset:25600
    v_fma_f32 v35, v35, v24, v24
    v_fma_f32 v36, v36, v24, v24
    v_mfma_f32_16x16x32_bf16 v[216:219], a[12:15], a[80:83], v[216:219]
    v_fma_f32 v37, v37, v24, v24
    v_fma_f32 v38, v38, v25, v25
    v_mfma_f32_16x16x32_bf16 v[220:223], a[12:15], a[84:87], v[220:223]
    buffer_load_dwordx4 a[12:15], v55, s[12:15], s29 offen offset:1024
    v_fma_f32 v39, v39, v25, v25
    v_fma_f32 v40, v40, v25, v25
    v_mfma_f32_16x16x32_bf16 v[224:227], a[16:19], a[72:75], v[224:227]
    v_fma_f32 v41, v41, v25, v25
    v_rcp_f32 v34, v34
    v_mfma_f32_16x16x32_bf16 v[228:231], a[16:19], a[76:79], v[228:231]
    v_rcp_f32 v35, v35
    v_rcp_f32 v36, v36
    v_mfma_f32_16x16x32_bf16 v[232:235], a[16:19], a[80:83], v[232:235]
    v_rcp_f32 v37, v37
    v_rcp_f32 v38, v38
    v_mfma_f32_16x16x32_bf16 v[236:239], a[16:19], a[84:87], v[236:239]
    buffer_load_dwordx4 a[16:19], v56, s[12:15], s29 offen offset:1024
    v_rcp_f32 v39, v39
    v_rcp_f32 v40, v40
    v_mfma_f32_16x16x32_bf16 v[240:243], a[20:23], a[72:75], v[240:243]
    v_rcp_f32 v41, v41
    v_mul_f32 v120, v104, v120
    v_mfma_f32_16x16x32_bf16 v[244:247], a[20:23], a[76:79], v[244:247]
    v_mul_f32 v121, v105, v121
    v_mul_f32 v122, v106, v122
    v_mfma_f32_16x16x32_bf16 v[248:251], a[20:23], a[80:83], v[248:251]
    v_mul_f32 v123, v107, v123
    v_mul_f32 v124, v108, v124
    v_mfma_f32_16x16x32_bf16 v[252:255], a[20:23], a[84:87], v[252:255]
    buffer_load_dwordx4 a[20:23], v57, s[12:15], s29 offen offset:1024
    v_mul_f32 v125, v109, v125
    v_mul_f32 v126, v110, v126
    s_waitcnt vmcnt(12) lgkmcnt(0)
    v_mfma_f32_16x16x32_bf16 v[160:163], a[24:27], a[88:91], v[160:163]
    v_mul_f32 v127, v111, v127
    v_mul_f32 v34, v34, v120
    v_mfma_f32_16x16x32_bf16 v[164:167], a[24:27], a[92:95], v[164:167]
    ds_read_b128 a[72:75], v4 offset:8192
    v_mul_f32 v35, v35, v121
    v_mul_f32 v36, v36, v122
    v_mfma_f32_16x16x32_bf16 v[168:171], a[24:27], a[96:99], v[168:171]
    v_mul_f32 v37, v37, v123
    v_mul_f32 v38, v38, v124
    v_mfma_f32_16x16x32_bf16 v[172:175], a[24:27], a[100:103], v[172:175]
    buffer_load_dwordx4 a[24:27], v52, s[12:15], s29 offen offset:2048
    v_mul_f32 v39, v39, v125
    v_mul_f32 v40, v40, v126
    v_mfma_f32_16x16x32_bf16 v[176:179], a[28:31], a[88:91], v[176:179]
    v_mul_f32 v41, v41, v127
    v_cvt_pk_bf16_f32 v42, v34, v35
    v_mfma_f32_16x16x32_bf16 v[180:183], a[28:31], a[92:95], v[180:183]
    ds_read_b128 a[76:79], v4 offset:26624
    v_cvt_pk_bf16_f32 v43, v36, v37
    v_cvt_pk_bf16_f32 v44, v38, v39
    v_mfma_f32_16x16x32_bf16 v[184:187], a[28:31], a[96:99], v[184:187]
    v_cvt_pk_bf16_f32 v45, v40, v41
    ds_write_b64 v0, v[42:43] offset:12288
    v_mfma_f32_16x16x32_bf16 v[188:191], a[28:31], a[100:103], v[188:191]
    buffer_load_dwordx4 a[28:31], v53, s[12:15], s29 offen offset:2048
    ds_write_b64 v0, v[44:45] offset:30720
    v_mfma_f32_16x16x32_bf16 v[192:195], a[32:35], a[88:91], v[192:195]
    ds_read_b128 v[26:29], v8 offset:3328
    ds_read_b128 v[30:33], v8 offset:3344
    v_mfma_f32_16x16x32_bf16 v[196:199], a[32:35], a[92:95], v[196:199]
    ds_read_b128 a[80:83], v5 offset:8192
    s_waitcnt lgkmcnt(1)
    v_fmac_f32 v128, v26, v10
    v_mfma_f32_16x16x32_bf16 v[200:203], a[32:35], a[96:99], v[200:203]
    v_fmac_f32 v129, v27, v10
    v_fmac_f32 v130, v28, v10
    v_mfma_f32_16x16x32_bf16 v[204:207], a[32:35], a[100:103], v[204:207]
    buffer_load_dwordx4 a[32:35], v54, s[12:15], s29 offen offset:2048
    v_fmac_f32 v131, v29, v10
    v_fmac_f32 v132, v26, v11
    v_mfma_f32_16x16x32_bf16 v[208:211], a[36:39], a[88:91], v[208:211]
    v_fmac_f32 v133, v27, v11
    v_fmac_f32 v134, v28, v11
    v_mfma_f32_16x16x32_bf16 v[212:215], a[36:39], a[92:95], v[212:215]
    ds_read_b128 a[84:87], v5 offset:26624
    v_fmac_f32 v135, v29, v11
    v_mul_f32 v34, v128, v128
    v_mfma_f32_16x16x32_bf16 v[216:219], a[36:39], a[96:99], v[216:219]
    v_mul_f32 v35, v129, v129
    v_mul_f32 v36, v130, v130
    v_mfma_f32_16x16x32_bf16 v[220:223], a[36:39], a[100:103], v[220:223]
    buffer_load_dwordx4 a[36:39], v55, s[12:15], s29 offen offset:2048
    v_mul_f32 v37, v131, v131
    v_mul_f32 v38, v132, v132
    v_mfma_f32_16x16x32_bf16 v[224:227], a[40:43], a[88:91], v[224:227]
    v_mul_f32 v39, v133, v133
    v_mul_f32 v40, v134, v134
    v_mfma_f32_16x16x32_bf16 v[228:231], a[40:43], a[92:95], v[228:231]
    v_mul_f32 v41, v135, v135
    v_fma_f32 v34, v34, v14, v18
    v_mfma_f32_16x16x32_bf16 v[232:235], a[40:43], a[96:99], v[232:235]
    v_fma_f32 v35, v35, v14, v18
    v_fma_f32 v36, v36, v14, v18
    v_mfma_f32_16x16x32_bf16 v[236:239], a[40:43], a[100:103], v[236:239]
    buffer_load_dwordx4 a[40:43], v56, s[12:15], s29 offen offset:2048
    v_fma_f32 v37, v37, v14, v18
    v_fma_f32 v38, v38, v15, v19
    v_mfma_f32_16x16x32_bf16 v[240:243], a[44:47], a[88:91], v[240:243]
    v_fma_f32 v39, v39, v15, v19
    v_fma_f32 v40, v40, v15, v19
    v_mfma_f32_16x16x32_bf16 v[244:247], a[44:47], a[92:95], v[244:247]
    v_fma_f32 v41, v41, v15, v19
    v_mul_f32 v34, v128, v34
    v_mfma_f32_16x16x32_bf16 v[248:251], a[44:47], a[96:99], v[248:251]
    v_mul_f32 v35, v129, v35
    v_mul_f32 v36, v130, v36
    v_mfma_f32_16x16x32_bf16 v[252:255], a[44:47], a[100:103], v[252:255]
    buffer_load_dwordx4 a[44:47], v57, s[12:15], s29 offen offset:2048
    v_mul_f32 v37, v131, v37
    v_mul_f32 v38, v132, v38
    s_waitcnt vmcnt(12) lgkmcnt(0)
    v_mfma_f32_16x16x32_bf16 v[160:163], a[48:51], a[72:75], v[160:163]
    v_mul_f32 v39, v133, v39
    v_mul_f32 v40, v134, v40
    v_mfma_f32_16x16x32_bf16 v[164:167], a[48:51], a[76:79], v[164:167]
    ds_read_b128 a[88:91], v4 offset:9216
    v_mul_f32 v41, v135, v41
    v_exp_f32 v34, v34
    v_mfma_f32_16x16x32_bf16 v[168:171], a[48:51], a[80:83], v[168:171]
    v_exp_f32 v35, v35
    v_exp_f32 v36, v36
    v_mfma_f32_16x16x32_bf16 v[172:175], a[48:51], a[84:87], v[172:175]
    buffer_load_dwordx4 a[48:51], v52, s[12:15], s29 offen offset:3072
    v_exp_f32 v37, v37
    v_exp_f32 v38, v38
    v_mfma_f32_16x16x32_bf16 v[176:179], a[52:55], a[72:75], v[176:179]
    v_exp_f32 v39, v39
    v_exp_f32 v40, v40
    v_mfma_f32_16x16x32_bf16 v[180:183], a[52:55], a[76:79], v[180:183]
    ds_read_b128 a[92:95], v4 offset:27648
    v_exp_f32 v41, v41
    v_fmac_f32 v144, v30, v10
    v_mfma_f32_16x16x32_bf16 v[184:187], a[52:55], a[80:83], v[184:187]
    v_fmac_f32 v145, v31, v10
    v_fmac_f32 v146, v32, v10
    v_mfma_f32_16x16x32_bf16 v[188:191], a[52:55], a[84:87], v[188:191]
    buffer_load_dwordx4 a[52:55], v53, s[12:15], s29 offen offset:3072
    v_fmac_f32 v147, v33, v10
    v_fmac_f32 v148, v30, v11
    v_mfma_f32_16x16x32_bf16 v[192:195], a[56:59], a[72:75], v[192:195]
    v_fmac_f32 v149, v31, v11
    v_fmac_f32 v150, v32, v11
    v_mfma_f32_16x16x32_bf16 v[196:199], a[56:59], a[76:79], v[196:199]
    ds_read_b128 a[96:99], v5 offset:9216
    v_fmac_f32 v151, v33, v11
    v_fma_f32 v34, v34, v22, v22
    v_mfma_f32_16x16x32_bf16 v[200:203], a[56:59], a[80:83], v[200:203]
    v_fma_f32 v35, v35, v22, v22
    v_fma_f32 v36, v36, v22, v22
    v_mfma_f32_16x16x32_bf16 v[204:207], a[56:59], a[84:87], v[204:207]
    buffer_load_dwordx4 a[56:59], v54, s[12:15], s29 offen offset:3072
    v_fma_f32 v37, v37, v22, v22
    v_fma_f32 v38, v38, v23, v23
    v_mfma_f32_16x16x32_bf16 v[208:211], a[60:63], a[72:75], v[208:211]
    v_fma_f32 v39, v39, v23, v23
    v_fma_f32 v40, v40, v23, v23
    v_mfma_f32_16x16x32_bf16 v[212:215], a[60:63], a[76:79], v[212:215]
    ds_read_b128 a[100:103], v5 offset:27648
    v_fma_f32 v41, v41, v23, v23
    v_rcp_f32 v34, v34
    v_mfma_f32_16x16x32_bf16 v[216:219], a[60:63], a[80:83], v[216:219]
    v_rcp_f32 v35, v35
    v_rcp_f32 v36, v36
    v_mfma_f32_16x16x32_bf16 v[220:223], a[60:63], a[84:87], v[220:223]
    buffer_load_dwordx4 a[60:63], v55, s[12:15], s29 offen offset:3072
    v_rcp_f32 v37, v37
    v_rcp_f32 v38, v38
    v_mfma_f32_16x16x32_bf16 v[224:227], a[64:67], a[72:75], v[224:227]
    v_rcp_f32 v39, v39
    v_rcp_f32 v40, v40
    v_mfma_f32_16x16x32_bf16 v[228:231], a[64:67], a[76:79], v[228:231]
    v_rcp_f32 v41, v41
    v_mul_f32 v144, v128, v144
    v_mfma_f32_16x16x32_bf16 v[232:235], a[64:67], a[80:83], v[232:235]
    v_mul_f32 v145, v129, v145
    v_mul_f32 v146, v130, v146
    v_mfma_f32_16x16x32_bf16 v[236:239], a[64:67], a[84:87], v[236:239]
    buffer_load_dwordx4 a[64:67], v56, s[12:15], s29 offen offset:3072
    v_mul_f32 v147, v131, v147
    v_mul_f32 v148, v132, v148
    v_mfma_f32_16x16x32_bf16 v[240:243], a[68:71], a[72:75], v[240:243]
    v_mul_f32 v149, v133, v149
    v_mul_f32 v150, v134, v150
    v_mfma_f32_16x16x32_bf16 v[244:247], a[68:71], a[76:79], v[244:247]
    v_mul_f32 v151, v135, v151
    v_mul_f32 v34, v34, v144
    v_mfma_f32_16x16x32_bf16 v[248:251], a[68:71], a[80:83], v[248:251]
    v_mul_f32 v35, v35, v145
    v_mul_f32 v36, v36, v146
    v_mfma_f32_16x16x32_bf16 v[252:255], a[68:71], a[84:87], v[252:255]
    buffer_load_dwordx4 a[68:71], v57, s[12:15], s29 offen offset:3072
    v_mul_f32 v37, v37, v147
    v_mul_f32 v38, v38, v148
    s_waitcnt vmcnt(12) lgkmcnt(0)
    v_mfma_f32_16x16x32_bf16 v[160:163], a[0:3], a[88:91], v[160:163]
    v_mul_f32 v39, v39, v149
    v_mul_f32 v40, v40, v150
    v_mfma_f32_16x16x32_bf16 v[164:167], a[0:3], a[92:95], v[164:167]
    ds_read_b128 a[72:75], v4 offset:10240
    v_mul_f32 v41, v41, v151
    v_cvt_pk_bf16_f32 v42, v34, v35
    v_mfma_f32_16x16x32_bf16 v[168:171], a[0:3], a[96:99], v[168:171]
    v_cvt_pk_bf16_f32 v43, v36, v37
    v_cvt_pk_bf16_f32 v44, v38, v39
    v_mfma_f32_16x16x32_bf16 v[172:175], a[0:3], a[100:103], v[172:175]
    s_add_u32 s29, s29, 4096
    buffer_load_dwordx4 a[0:3], v52, s[12:15], s29 offen offset:0
    v_cvt_pk_bf16_f32 v45, v40, v41
    ds_write_b64 v6, v[42:43] offset:13312
    v_mfma_f32_16x16x32_bf16 v[176:179], a[4:7], a[88:91], v[176:179]
    ds_write_b64 v6, v[44:45] offset:31744
    v_fmac_f32 v136, v26, v12
    v_mfma_f32_16x16x32_bf16 v[180:183], a[4:7], a[92:95], v[180:183]
    ds_read_b128 a[76:79], v4 offset:28672
    v_fmac_f32 v137, v27, v12
    v_fmac_f32 v138, v28, v12
    v_mfma_f32_16x16x32_bf16 v[184:187], a[4:7], a[96:99], v[184:187]
    v_fmac_f32 v139, v29, v12
    v_fmac_f32 v140, v26, v13
    v_mfma_f32_16x16x32_bf16 v[188:191], a[4:7], a[100:103], v[188:191]
    buffer_load_dwordx4 a[4:7], v53, s[12:15], s29 offen offset:0
    v_fmac_f32 v141, v27, v13
    v_fmac_f32 v142, v28, v13
    v_mfma_f32_16x16x32_bf16 v[192:195], a[8:11], a[88:91], v[192:195]
    v_fmac_f32 v143, v29, v13
    v_mul_f32 v34, v136, v136
    v_mfma_f32_16x16x32_bf16 v[196:199], a[8:11], a[92:95], v[196:199]
    ds_read_b128 a[80:83], v5 offset:10240
    v_mul_f32 v35, v137, v137
    v_mul_f32 v36, v138, v138
    v_mfma_f32_16x16x32_bf16 v[200:203], a[8:11], a[96:99], v[200:203]
    v_mul_f32 v37, v139, v139
    v_mul_f32 v38, v140, v140
    v_mfma_f32_16x16x32_bf16 v[204:207], a[8:11], a[100:103], v[204:207]
    buffer_load_dwordx4 a[8:11], v54, s[12:15], s29 offen offset:0
    v_mul_f32 v39, v141, v141
    v_mul_f32 v40, v142, v142
    v_mfma_f32_16x16x32_bf16 v[208:211], a[12:15], a[88:91], v[208:211]
    v_mul_f32 v41, v143, v143
    v_fma_f32 v34, v34, v16, v20
    v_mfma_f32_16x16x32_bf16 v[212:215], a[12:15], a[92:95], v[212:215]
    ds_read_b128 a[84:87], v5 offset:28672
    v_fma_f32 v35, v35, v16, v20
    v_fma_f32 v36, v36, v16, v20
    v_mfma_f32_16x16x32_bf16 v[216:219], a[12:15], a[96:99], v[216:219]
    v_fma_f32 v37, v37, v16, v20
    v_fma_f32 v38, v38, v17, v21
    v_mfma_f32_16x16x32_bf16 v[220:223], a[12:15], a[100:103], v[220:223]
    buffer_load_dwordx4 a[12:15], v55, s[12:15], s29 offen offset:0
    v_fma_f32 v39, v39, v17, v21
    v_fma_f32 v40, v40, v17, v21
    v_mfma_f32_16x16x32_bf16 v[224:227], a[16:19], a[88:91], v[224:227]
    v_fma_f32 v41, v41, v17, v21
    v_mul_f32 v34, v136, v34
    v_mfma_f32_16x16x32_bf16 v[228:231], a[16:19], a[92:95], v[228:231]
    v_mul_f32 v35, v137, v35
    v_mul_f32 v36, v138, v36
    v_mfma_f32_16x16x32_bf16 v[232:235], a[16:19], a[96:99], v[232:235]
    v_mul_f32 v37, v139, v37
    v_mul_f32 v38, v140, v38
    v_mfma_f32_16x16x32_bf16 v[236:239], a[16:19], a[100:103], v[236:239]
    buffer_load_dwordx4 a[16:19], v56, s[12:15], s29 offen offset:0
    v_mul_f32 v39, v141, v39
    v_mul_f32 v40, v142, v40
    v_mfma_f32_16x16x32_bf16 v[240:243], a[20:23], a[88:91], v[240:243]
    v_mul_f32 v41, v143, v41
    v_exp_f32 v34, v34
    v_mfma_f32_16x16x32_bf16 v[244:247], a[20:23], a[92:95], v[244:247]
    v_exp_f32 v35, v35
    v_exp_f32 v36, v36
    v_mfma_f32_16x16x32_bf16 v[248:251], a[20:23], a[96:99], v[248:251]
    v_exp_f32 v37, v37
    v_exp_f32 v38, v38
    v_mfma_f32_16x16x32_bf16 v[252:255], a[20:23], a[100:103], v[252:255]
    buffer_load_dwordx4 a[20:23], v57, s[12:15], s29 offen offset:0
    v_exp_f32 v39, v39
    v_exp_f32 v40, v40
    s_waitcnt vmcnt(12) lgkmcnt(0)
    v_mfma_f32_16x16x32_bf16 v[160:163], a[24:27], a[72:75], v[160:163]
    v_exp_f32 v41, v41
    v_fmac_f32 v152, v30, v12
    v_mfma_f32_16x16x32_bf16 v[164:167], a[24:27], a[76:79], v[164:167]
    ds_read_b128 a[88:91], v4 offset:11264
    v_fmac_f32 v153, v31, v12
    v_fmac_f32 v154, v32, v12
    v_mfma_f32_16x16x32_bf16 v[168:171], a[24:27], a[80:83], v[168:171]
    v_fmac_f32 v155, v33, v12
    v_fmac_f32 v156, v30, v13
    v_mfma_f32_16x16x32_bf16 v[172:175], a[24:27], a[84:87], v[172:175]
    buffer_load_dwordx4 a[24:27], v52, s[12:15], s29 offen offset:1024
    v_fmac_f32 v157, v31, v13
    v_fmac_f32 v158, v32, v13
    v_mfma_f32_16x16x32_bf16 v[176:179], a[28:31], a[72:75], v[176:179]
    v_fmac_f32 v159, v33, v13
    v_fma_f32 v34, v34, v24, v24
    v_mfma_f32_16x16x32_bf16 v[180:183], a[28:31], a[76:79], v[180:183]
    ds_read_b128 a[92:95], v4 offset:29696
    v_fma_f32 v35, v35, v24, v24
    v_fma_f32 v36, v36, v24, v24
    v_mfma_f32_16x16x32_bf16 v[184:187], a[28:31], a[80:83], v[184:187]
    v_fma_f32 v37, v37, v24, v24
    v_fma_f32 v38, v38, v25, v25
    v_mfma_f32_16x16x32_bf16 v[188:191], a[28:31], a[84:87], v[188:191]
    buffer_load_dwordx4 a[28:31], v53, s[12:15], s29 offen offset:1024
    v_fma_f32 v39, v39, v25, v25
    v_fma_f32 v40, v40, v25, v25
    v_mfma_f32_16x16x32_bf16 v[192:195], a[32:35], a[72:75], v[192:195]
    v_fma_f32 v41, v41, v25, v25
    v_rcp_f32 v34, v34
    v_mfma_f32_16x16x32_bf16 v[196:199], a[32:35], a[76:79], v[196:199]
    ds_read_b128 a[96:99], v5 offset:11264
    v_rcp_f32 v35, v35
    v_rcp_f32 v36, v36
    v_mfma_f32_16x16x32_bf16 v[200:203], a[32:35], a[80:83], v[200:203]
    v_rcp_f32 v37, v37
    v_rcp_f32 v38, v38
    v_mfma_f32_16x16x32_bf16 v[204:207], a[32:35], a[84:87], v[204:207]
    buffer_load_dwordx4 a[32:35], v54, s[12:15], s29 offen offset:1024
    v_rcp_f32 v39, v39
    v_rcp_f32 v40, v40
    v_mfma_f32_16x16x32_bf16 v[208:211], a[36:39], a[72:75], v[208:211]
    v_rcp_f32 v41, v41
    v_mul_f32 v152, v136, v152
    v_mfma_f32_16x16x32_bf16 v[212:215], a[36:39], a[76:79], v[212:215]
    ds_read_b128 a[100:103], v5 offset:29696
    v_mul_f32 v153, v137, v153
    v_mul_f32 v154, v138, v154
    v_mfma_f32_16x16x32_bf16 v[216:219], a[36:39], a[80:83], v[216:219]
    v_mul_f32 v155, v139, v155
    v_mul_f32 v156, v140, v156
    v_mfma_f32_16x16x32_bf16 v[220:223], a[36:39], a[84:87], v[220:223]
    buffer_load_dwordx4 a[36:39], v55, s[12:15], s29 offen offset:1024
    v_mul_f32 v157, v141, v157
    v_mul_f32 v158, v142, v158
    v_mfma_f32_16x16x32_bf16 v[224:227], a[40:43], a[72:75], v[224:227]
    v_mul_f32 v159, v143, v159
    v_mul_f32 v34, v34, v152
    v_mfma_f32_16x16x32_bf16 v[228:231], a[40:43], a[76:79], v[228:231]
    v_mul_f32 v35, v35, v153
    v_mul_f32 v36, v36, v154
    v_mfma_f32_16x16x32_bf16 v[232:235], a[40:43], a[80:83], v[232:235]
    v_mul_f32 v37, v37, v155
    v_mul_f32 v38, v38, v156
    v_mfma_f32_16x16x32_bf16 v[236:239], a[40:43], a[84:87], v[236:239]
    buffer_load_dwordx4 a[40:43], v56, s[12:15], s29 offen offset:1024
    v_mul_f32 v39, v39, v157
    v_mul_f32 v40, v40, v158
    v_mfma_f32_16x16x32_bf16 v[240:243], a[44:47], a[72:75], v[240:243]
    v_mul_f32 v41, v41, v159
    v_cvt_pk_bf16_f32 v42, v34, v35
    v_mfma_f32_16x16x32_bf16 v[244:247], a[44:47], a[76:79], v[244:247]
    v_cvt_pk_bf16_f32 v43, v36, v37
    v_cvt_pk_bf16_f32 v44, v38, v39
    v_mfma_f32_16x16x32_bf16 v[248:251], a[44:47], a[80:83], v[248:251]
    v_cvt_pk_bf16_f32 v45, v40, v41
    ds_write_b64 v9, v[42:43] offset:13312
    v_mfma_f32_16x16x32_bf16 v[252:255], a[44:47], a[84:87], v[252:255]
    buffer_load_dwordx4 a[44:47], v57, s[12:15], s29 offen offset:1024
    ds_write_b64 v9, v[44:45] offset:31744
    s_waitcnt vmcnt(12) lgkmcnt(2)
    s_waitcnt lgkmcnt(0)
    s_barrier
    ds_read_b128 a[72:75], v4 offset:12288
    ds_read_b128 a[76:79], v4 offset:30720
    ds_read_b128 a[80:83], v5 offset:12288
    ds_read_b128 a[84:87], v5 offset:30720
    v_mfma_f32_16x16x32_bf16 v[160:163], a[48:51], a[88:91], v[160:163]
    v_mfma_f32_16x16x32_bf16 v[164:167], a[48:51], a[92:95], v[164:167]
    v_mfma_f32_16x16x32_bf16 v[168:171], a[48:51], a[96:99], v[168:171]
    v_mfma_f32_16x16x32_bf16 v[172:175], a[48:51], a[100:103], v[172:175]
    buffer_load_dwordx4 a[48:51], v52, s[12:15], s29 offen offset:2048
    v_mfma_f32_16x16x32_bf16 v[176:179], a[52:55], a[88:91], v[176:179]
    v_mfma_f32_16x16x32_bf16 v[180:183], a[52:55], a[92:95], v[180:183]
    v_mfma_f32_16x16x32_bf16 v[184:187], a[52:55], a[96:99], v[184:187]
    v_mfma_f32_16x16x32_bf16 v[188:191], a[52:55], a[100:103], v[188:191]
    buffer_load_dwordx4 a[52:55], v53, s[12:15], s29 offen offset:2048
    v_mfma_f32_16x16x32_bf16 v[192:195], a[56:59], a[88:91], v[192:195]
    v_mfma_f32_16x16x32_bf16 v[196:199], a[56:59], a[92:95], v[196:199]
    v_mfma_f32_16x16x32_bf16 v[200:203], a[56:59], a[96:99], v[200:203]
    v_mfma_f32_16x16x32_bf16 v[204:207], a[56:59], a[100:103], v[204:207]
    buffer_load_dwordx4 a[56:59], v54, s[12:15], s29 offen offset:2048
    v_mfma_f32_16x16x32_bf16 v[208:211], a[60:63], a[88:91], v[208:211]
    v_mfma_f32_16x16x32_bf16 v[212:215], a[60:63], a[92:95], v[212:215]
    v_mfma_f32_16x16x32_bf16 v[216:219], a[60:63], a[96:99], v[216:219]
    v_mfma_f32_16x16x32_bf16 v[220:223], a[60:63], a[100:103], v[220:223]
    buffer_load_dwordx4 a[60:63], v55, s[12:15], s29 offen offset:2048
    v_mfma_f32_16x16x32_bf16 v[224:227], a[64:67], a[88:91], v[224:227]
    v_mfma_f32_16x16x32_bf16 v[228:231], a[64:67], a[92:95], v[228:231]
    v_mfma_f32_16x16x32_bf16 v[232:235], a[64:67], a[96:99], v[232:235]
    v_mfma_f32_16x16x32_bf16 v[236:239], a[64:67], a[100:103], v[236:239]
    buffer_load_dwordx4 a[64:67], v56, s[12:15], s29 offen offset:2048
    v_mfma_f32_16x16x32_bf16 v[240:243], a[68:71], a[88:91], v[240:243]
    v_mfma_f32_16x16x32_bf16 v[244:247], a[68:71], a[92:95], v[244:247]
    v_mfma_f32_16x16x32_bf16 v[248:251], a[68:71], a[96:99], v[248:251]
    v_mfma_f32_16x16x32_bf16 v[252:255], a[68:71], a[100:103], v[252:255]
    buffer_load_dwordx4 a[68:71], v57, s[12:15], s29 offen offset:2048
    s_waitcnt vmcnt(12) lgkmcnt(0)
    v_mfma_f32_16x16x32_bf16 v[160:163], a[0:3], a[72:75], v[160:163]
    v_mfma_f32_16x16x32_bf16 v[164:167], a[0:3], a[76:79], v[164:167]
    ds_read_b128 a[88:91], v4 offset:13312
    v_mfma_f32_16x16x32_bf16 v[168:171], a[0:3], a[80:83], v[168:171]
    v_mfma_f32_16x16x32_bf16 v[172:175], a[0:3], a[84:87], v[172:175]
    buffer_load_dwordx4 a[0:3], v52, s[12:15], s29 offen offset:3072
    v_mfma_f32_16x16x32_bf16 v[176:179], a[4:7], a[72:75], v[176:179]
    v_mfma_f32_16x16x32_bf16 v[180:183], a[4:7], a[76:79], v[180:183]
    ds_read_b128 a[92:95], v4 offset:31744
    v_mfma_f32_16x16x32_bf16 v[184:187], a[4:7], a[80:83], v[184:187]
    v_mfma_f32_16x16x32_bf16 v[188:191], a[4:7], a[84:87], v[188:191]
    buffer_load_dwordx4 a[4:7], v53, s[12:15], s29 offen offset:3072
    v_mfma_f32_16x16x32_bf16 v[192:195], a[8:11], a[72:75], v[192:195]
    v_mfma_f32_16x16x32_bf16 v[196:199], a[8:11], a[76:79], v[196:199]
    ds_read_b128 a[96:99], v5 offset:13312
    v_mfma_f32_16x16x32_bf16 v[200:203], a[8:11], a[80:83], v[200:203]
    v_mfma_f32_16x16x32_bf16 v[204:207], a[8:11], a[84:87], v[204:207]
    buffer_load_dwordx4 a[8:11], v54, s[12:15], s29 offen offset:3072
    v_mfma_f32_16x16x32_bf16 v[208:211], a[12:15], a[72:75], v[208:211]
    v_mfma_f32_16x16x32_bf16 v[212:215], a[12:15], a[76:79], v[212:215]
    ds_read_b128 a[100:103], v5 offset:31744
    v_mfma_f32_16x16x32_bf16 v[216:219], a[12:15], a[80:83], v[216:219]
    v_mfma_f32_16x16x32_bf16 v[220:223], a[12:15], a[84:87], v[220:223]
    buffer_load_dwordx4 a[12:15], v55, s[12:15], s29 offen offset:3072
    v_mfma_f32_16x16x32_bf16 v[224:227], a[16:19], a[72:75], v[224:227]
    v_mfma_f32_16x16x32_bf16 v[228:231], a[16:19], a[76:79], v[228:231]
    v_mfma_f32_16x16x32_bf16 v[232:235], a[16:19], a[80:83], v[232:235]
    v_mfma_f32_16x16x32_bf16 v[236:239], a[16:19], a[84:87], v[236:239]
    buffer_load_dwordx4 a[16:19], v56, s[12:15], s29 offen offset:3072
    v_mfma_f32_16x16x32_bf16 v[240:243], a[20:23], a[72:75], v[240:243]
    v_mfma_f32_16x16x32_bf16 v[244:247], a[20:23], a[76:79], v[244:247]
    v_mfma_f32_16x16x32_bf16 v[248:251], a[20:23], a[80:83], v[248:251]
    v_mfma_f32_16x16x32_bf16 v[252:255], a[20:23], a[84:87], v[252:255]
    buffer_load_dwordx4 a[20:23], v57, s[12:15], s29 offen offset:3072
    s_waitcnt vmcnt(12) lgkmcnt(0)
    v_mfma_f32_16x16x32_bf16 v[160:163], a[24:27], a[88:91], v[160:163]
    v_mfma_f32_16x16x32_bf16 v[164:167], a[24:27], a[92:95], v[164:167]
    ds_read_b128 a[72:75], v4 offset:14336
    v_mfma_f32_16x16x32_bf16 v[168:171], a[24:27], a[96:99], v[168:171]
    v_mfma_f32_16x16x32_bf16 v[172:175], a[24:27], a[100:103], v[172:175]
    s_add_u32 s29, s29, 4096
    buffer_load_dwordx4 a[24:27], v52, s[12:15], s29 offen offset:0
    v_mfma_f32_16x16x32_bf16 v[176:179], a[28:31], a[88:91], v[176:179]
    v_mfma_f32_16x16x32_bf16 v[180:183], a[28:31], a[92:95], v[180:183]
    ds_read_b128 a[76:79], v4 offset:32768
    v_mfma_f32_16x16x32_bf16 v[184:187], a[28:31], a[96:99], v[184:187]
    v_mfma_f32_16x16x32_bf16 v[188:191], a[28:31], a[100:103], v[188:191]
    buffer_load_dwordx4 a[28:31], v53, s[12:15], s29 offen offset:0
    v_mfma_f32_16x16x32_bf16 v[192:195], a[32:35], a[88:91], v[192:195]
    v_mfma_f32_16x16x32_bf16 v[196:199], a[32:35], a[92:95], v[196:199]
    ds_read_b128 a[80:83], v5 offset:14336
    v_mfma_f32_16x16x32_bf16 v[200:203], a[32:35], a[96:99], v[200:203]
    v_mfma_f32_16x16x32_bf16 v[204:207], a[32:35], a[100:103], v[204:207]
    buffer_load_dwordx4 a[32:35], v54, s[12:15], s29 offen offset:0
    v_mfma_f32_16x16x32_bf16 v[208:211], a[36:39], a[88:91], v[208:211]
    v_mfma_f32_16x16x32_bf16 v[212:215], a[36:39], a[92:95], v[212:215]
    ds_read_b128 a[84:87], v5 offset:32768
    v_mfma_f32_16x16x32_bf16 v[216:219], a[36:39], a[96:99], v[216:219]
    v_mfma_f32_16x16x32_bf16 v[220:223], a[36:39], a[100:103], v[220:223]
    buffer_load_dwordx4 a[36:39], v55, s[12:15], s29 offen offset:0
    v_mfma_f32_16x16x32_bf16 v[224:227], a[40:43], a[88:91], v[224:227]
    v_mfma_f32_16x16x32_bf16 v[228:231], a[40:43], a[92:95], v[228:231]
    v_mfma_f32_16x16x32_bf16 v[232:235], a[40:43], a[96:99], v[232:235]
    v_mfma_f32_16x16x32_bf16 v[236:239], a[40:43], a[100:103], v[236:239]
    buffer_load_dwordx4 a[40:43], v56, s[12:15], s29 offen offset:0
    v_mfma_f32_16x16x32_bf16 v[240:243], a[44:47], a[88:91], v[240:243]
    v_mfma_f32_16x16x32_bf16 v[244:247], a[44:47], a[92:95], v[244:247]
    v_mfma_f32_16x16x32_bf16 v[248:251], a[44:47], a[96:99], v[248:251]
    v_mfma_f32_16x16x32_bf16 v[252:255], a[44:47], a[100:103], v[252:255]
    buffer_load_dwordx4 a[44:47], v57, s[12:15], s29 offen offset:0
    s_waitcnt vmcnt(12) lgkmcnt(0)
    v_mfma_f32_16x16x32_bf16 v[160:163], a[48:51], a[72:75], v[160:163]
    v_mfma_f32_16x16x32_bf16 v[164:167], a[48:51], a[76:79], v[164:167]
    ds_read_b128 a[88:91], v4 offset:15360
    v_mfma_f32_16x16x32_bf16 v[168:171], a[48:51], a[80:83], v[168:171]
    v_mfma_f32_16x16x32_bf16 v[172:175], a[48:51], a[84:87], v[172:175]
    buffer_load_dwordx4 a[48:51], v52, s[12:15], s29 offen offset:1024
    v_mfma_f32_16x16x32_bf16 v[176:179], a[52:55], a[72:75], v[176:179]
    v_mfma_f32_16x16x32_bf16 v[180:183], a[52:55], a[76:79], v[180:183]
    ds_read_b128 a[92:95], v4 offset:33792
    v_mfma_f32_16x16x32_bf16 v[184:187], a[52:55], a[80:83], v[184:187]
    v_mfma_f32_16x16x32_bf16 v[188:191], a[52:55], a[84:87], v[188:191]
    buffer_load_dwordx4 a[52:55], v53, s[12:15], s29 offen offset:1024
    v_mfma_f32_16x16x32_bf16 v[192:195], a[56:59], a[72:75], v[192:195]
    v_mfma_f32_16x16x32_bf16 v[196:199], a[56:59], a[76:79], v[196:199]
    ds_read_b128 a[96:99], v5 offset:15360
    v_mfma_f32_16x16x32_bf16 v[200:203], a[56:59], a[80:83], v[200:203]
    v_mfma_f32_16x16x32_bf16 v[204:207], a[56:59], a[84:87], v[204:207]
    buffer_load_dwordx4 a[56:59], v54, s[12:15], s29 offen offset:1024
    v_mfma_f32_16x16x32_bf16 v[208:211], a[60:63], a[72:75], v[208:211]
    v_mfma_f32_16x16x32_bf16 v[212:215], a[60:63], a[76:79], v[212:215]
    ds_read_b128 a[100:103], v5 offset:33792
    v_mfma_f32_16x16x32_bf16 v[216:219], a[60:63], a[80:83], v[216:219]
    v_mfma_f32_16x16x32_bf16 v[220:223], a[60:63], a[84:87], v[220:223]
    buffer_load_dwordx4 a[60:63], v55, s[12:15], s29 offen offset:1024
    v_mfma_f32_16x16x32_bf16 v[224:227], a[64:67], a[72:75], v[224:227]
    v_mfma_f32_16x16x32_bf16 v[228:231], a[64:67], a[76:79], v[228:231]
    v_mfma_f32_16x16x32_bf16 v[232:235], a[64:67], a[80:83], v[232:235]
    v_mfma_f32_16x16x32_bf16 v[236:239], a[64:67], a[84:87], v[236:239]
    buffer_load_dwordx4 a[64:67], v56, s[12:15], s29 offen offset:1024
    v_mfma_f32_16x16x32_bf16 v[240:243], a[68:71], a[72:75], v[240:243]
    v_mfma_f32_16x16x32_bf16 v[244:247], a[68:71], a[76:79], v[244:247]
    v_mfma_f32_16x16x32_bf16 v[248:251], a[68:71], a[80:83], v[248:251]
    v_mfma_f32_16x16x32_bf16 v[252:255], a[68:71], a[84:87], v[252:255]
    buffer_load_dwordx4 a[68:71], v57, s[12:15], s29 offen offset:1024
    s_waitcnt vmcnt(12) lgkmcnt(0)
    v_mfma_f32_16x16x32_bf16 v[160:163], a[0:3], a[88:91], v[160:163]
    v_mfma_f32_16x16x32_bf16 v[164:167], a[0:3], a[92:95], v[164:167]
    ds_read_b128 a[72:75], v4 offset:16384
    v_mfma_f32_16x16x32_bf16 v[168:171], a[0:3], a[96:99], v[168:171]
    v_mfma_f32_16x16x32_bf16 v[172:175], a[0:3], a[100:103], v[172:175]
    s_sub_u32 s29, s29, 16384
    buffer_load_dwordx4 a[0:3], v58, s[12:15], s29 offen offset:0
    v_mfma_f32_16x16x32_bf16 v[176:179], a[4:7], a[88:91], v[176:179]
    v_mfma_f32_16x16x32_bf16 v[180:183], a[4:7], a[92:95], v[180:183]
    ds_read_b128 a[76:79], v4 offset:34816
    v_mfma_f32_16x16x32_bf16 v[184:187], a[4:7], a[96:99], v[184:187]
    v_mfma_f32_16x16x32_bf16 v[188:191], a[4:7], a[100:103], v[188:191]
    buffer_load_dwordx4 a[4:7], v59, s[12:15], s29 offen offset:0
    v_mfma_f32_16x16x32_bf16 v[192:195], a[8:11], a[88:91], v[192:195]
    v_mfma_f32_16x16x32_bf16 v[196:199], a[8:11], a[92:95], v[196:199]
    ds_read_b128 a[80:83], v5 offset:16384
    v_mfma_f32_16x16x32_bf16 v[200:203], a[8:11], a[96:99], v[200:203]
    v_mfma_f32_16x16x32_bf16 v[204:207], a[8:11], a[100:103], v[204:207]
    buffer_load_dwordx4 a[8:11], v60, s[12:15], s29 offen offset:0
    v_mfma_f32_16x16x32_bf16 v[208:211], a[12:15], a[88:91], v[208:211]
    v_mfma_f32_16x16x32_bf16 v[212:215], a[12:15], a[92:95], v[212:215]
    ds_read_b128 a[84:87], v5 offset:34816
    v_mfma_f32_16x16x32_bf16 v[216:219], a[12:15], a[96:99], v[216:219]
    v_mfma_f32_16x16x32_bf16 v[220:223], a[12:15], a[100:103], v[220:223]
    buffer_load_dwordx4 a[12:15], v58, s[12:15], s29 offen offset:1024
    v_mfma_f32_16x16x32_bf16 v[224:227], a[16:19], a[88:91], v[224:227]
    v_mfma_f32_16x16x32_bf16 v[228:231], a[16:19], a[92:95], v[228:231]
    v_mfma_f32_16x16x32_bf16 v[232:235], a[16:19], a[96:99], v[232:235]
    v_mfma_f32_16x16x32_bf16 v[236:239], a[16:19], a[100:103], v[236:239]
    buffer_load_dwordx4 a[16:19], v59, s[12:15], s29 offen offset:1024
    v_mfma_f32_16x16x32_bf16 v[240:243], a[20:23], a[88:91], v[240:243]
    v_mfma_f32_16x16x32_bf16 v[244:247], a[20:23], a[92:95], v[244:247]
    v_mfma_f32_16x16x32_bf16 v[248:251], a[20:23], a[96:99], v[248:251]
    v_mfma_f32_16x16x32_bf16 v[252:255], a[20:23], a[100:103], v[252:255]
    buffer_load_dwordx4 a[20:23], v60, s[12:15], s29 offen offset:1024
    s_waitcnt vmcnt(12) lgkmcnt(0)
    v_mfma_f32_16x16x32_bf16 v[160:163], a[24:27], a[72:75], v[160:163]
    v_mfma_f32_16x16x32_bf16 v[164:167], a[24:27], a[76:79], v[164:167]
    ds_read_b128 a[88:91], v4 offset:17408
    v_mfma_f32_16x16x32_bf16 v[168:171], a[24:27], a[80:83], v[168:171]
    v_mfma_f32_16x16x32_bf16 v[172:175], a[24:27], a[84:87], v[172:175]
    buffer_load_dwordx4 a[24:27], v58, s[12:15], s29 offen offset:2048
    v_mfma_f32_16x16x32_bf16 v[176:179], a[28:31], a[72:75], v[176:179]
    v_mfma_f32_16x16x32_bf16 v[180:183], a[28:31], a[76:79], v[180:183]
    ds_read_b128 a[92:95], v4 offset:35840
    v_mfma_f32_16x16x32_bf16 v[184:187], a[28:31], a[80:83], v[184:187]
    v_mfma_f32_16x16x32_bf16 v[188:191], a[28:31], a[84:87], v[188:191]
    buffer_load_dwordx4 a[28:31], v59, s[12:15], s29 offen offset:2048
    v_mfma_f32_16x16x32_bf16 v[192:195], a[32:35], a[72:75], v[192:195]
    v_mfma_f32_16x16x32_bf16 v[196:199], a[32:35], a[76:79], v[196:199]
    ds_read_b128 a[96:99], v5 offset:17408
    v_mfma_f32_16x16x32_bf16 v[200:203], a[32:35], a[80:83], v[200:203]
    v_mfma_f32_16x16x32_bf16 v[204:207], a[32:35], a[84:87], v[204:207]
    buffer_load_dwordx4 a[32:35], v60, s[12:15], s29 offen offset:2048
    v_mfma_f32_16x16x32_bf16 v[208:211], a[36:39], a[72:75], v[208:211]
    v_mfma_f32_16x16x32_bf16 v[212:215], a[36:39], a[76:79], v[212:215]
    ds_read_b128 a[100:103], v5 offset:35840
    v_mfma_f32_16x16x32_bf16 v[216:219], a[36:39], a[80:83], v[216:219]
    v_mfma_f32_16x16x32_bf16 v[220:223], a[36:39], a[84:87], v[220:223]
    buffer_load_dwordx4 a[36:39], v58, s[12:15], s29 offen offset:3072
    v_mfma_f32_16x16x32_bf16 v[224:227], a[40:43], a[72:75], v[224:227]
    v_mfma_f32_16x16x32_bf16 v[228:231], a[40:43], a[76:79], v[228:231]
    v_mfma_f32_16x16x32_bf16 v[232:235], a[40:43], a[80:83], v[232:235]
    v_mfma_f32_16x16x32_bf16 v[236:239], a[40:43], a[84:87], v[236:239]
    buffer_load_dwordx4 a[40:43], v59, s[12:15], s29 offen offset:3072
    v_mfma_f32_16x16x32_bf16 v[240:243], a[44:47], a[72:75], v[240:243]
    v_mfma_f32_16x16x32_bf16 v[244:247], a[44:47], a[76:79], v[244:247]
    v_mfma_f32_16x16x32_bf16 v[248:251], a[44:47], a[80:83], v[248:251]
    v_mfma_f32_16x16x32_bf16 v[252:255], a[44:47], a[84:87], v[252:255]
    buffer_load_dwordx4 a[44:47], v60, s[12:15], s29 offen offset:3072
    s_waitcnt vmcnt(12) lgkmcnt(0)
    v_mfma_f32_16x16x32_bf16 v[160:163], a[48:51], a[88:91], v[160:163]
    v_mfma_f32_16x16x32_bf16 v[164:167], a[48:51], a[92:95], v[164:167]
    ds_read_b128 a[72:75], v4 offset:0
    v_mfma_f32_16x16x32_bf16 v[168:171], a[48:51], a[96:99], v[168:171]
    v_mfma_f32_16x16x32_bf16 v[172:175], a[48:51], a[100:103], v[172:175]
    s_add_u32 s29, s29, 4096
    buffer_load_dwordx4 a[48:51], v58, s[12:15], s29 offen offset:0
    v_mfma_f32_16x16x32_bf16 v[176:179], a[52:55], a[88:91], v[176:179]
    v_mfma_f32_16x16x32_bf16 v[180:183], a[52:55], a[92:95], v[180:183]
    ds_read_b128 a[76:79], v4 offset:18432
    v_mfma_f32_16x16x32_bf16 v[184:187], a[52:55], a[96:99], v[184:187]
    v_mfma_f32_16x16x32_bf16 v[188:191], a[52:55], a[100:103], v[188:191]
    buffer_load_dwordx4 a[52:55], v59, s[12:15], s29 offen offset:0
    v_mfma_f32_16x16x32_bf16 v[192:195], a[56:59], a[88:91], v[192:195]
    v_mfma_f32_16x16x32_bf16 v[196:199], a[56:59], a[92:95], v[196:199]
    ds_read_b128 a[80:83], v5 offset:0
    v_mfma_f32_16x16x32_bf16 v[200:203], a[56:59], a[96:99], v[200:203]
    v_mfma_f32_16x16x32_bf16 v[204:207], a[56:59], a[100:103], v[204:207]
    buffer_load_dwordx4 a[56:59], v60, s[12:15], s29 offen offset:0
    v_mfma_f32_16x16x32_bf16 v[208:211], a[60:63], a[88:91], v[208:211]
    v_mfma_f32_16x16x32_bf16 v[212:215], a[60:63], a[92:95], v[212:215]
    ds_read_b128 a[84:87], v5 offset:18432
    v_mfma_f32_16x16x32_bf16 v[216:219], a[60:63], a[96:99], v[216:219]
    v_mfma_f32_16x16x32_bf16 v[220:223], a[60:63], a[100:103], v[220:223]
    buffer_load_dwordx4 a[60:63], v58, s[12:15], s29 offen offset:1024
    v_mfma_f32_16x16x32_bf16 v[224:227], a[64:67], a[88:91], v[224:227]
    v_mfma_f32_16x16x32_bf16 v[228:231], a[64:67], a[92:95], v[228:231]
    v_mfma_f32_16x16x32_bf16 v[232:235], a[64:67], a[96:99], v[232:235]
    v_mfma_f32_16x16x32_bf16 v[236:239], a[64:67], a[100:103], v[236:239]
    buffer_load_dwordx4 a[64:67], v59, s[12:15], s29 offen offset:1024
    v_mfma_f32_16x16x32_bf16 v[240:243], a[68:71], a[88:91], v[240:243]
    v_mfma_f32_16x16x32_bf16 v[244:247], a[68:71], a[92:95], v[244:247]
    v_mfma_f32_16x16x32_bf16 v[248:251], a[68:71], a[96:99], v[248:251]
    v_mfma_f32_16x16x32_bf16 v[252:255], a[68:71], a[100:103], v[252:255]
    buffer_load_dwordx4 a[68:71], v60, s[12:15], s29 offen offset:1024
    s_waitcnt vmcnt(15) lgkmcnt(0)
    v_mfma_f32_16x16x32_bf16 v[64:67], a[0:3], a[72:75], 0
    v_cvt_pk_bf16_f32 v34, v160, v161
    v_mfma_f32_16x16x32_bf16 v[68:71], a[0:3], a[76:79], 0
    ds_read_b128 a[88:91], v4 offset:1024
    v_mfma_f32_16x16x32_bf16 v[72:75], a[0:3], a[80:83], 0
    v_mfma_f32_16x16x32_bf16 v[76:79], a[0:3], a[84:87], 0
    buffer_load_dwordx4 a[0:3], v58, s[12:15], s29 offen offset:2048
    v_cvt_pk_bf16_f32 v35, v162, v163
    v_mfma_f32_16x16x32_bf16 v[80:83], a[4:7], a[72:75], 0
    v_mfma_f32_16x16x32_bf16 v[84:87], a[4:7], a[76:79], 0
    ds_read_b128 a[92:95], v4 offset:19456
    v_mfma_f32_16x16x32_bf16 v[88:91], a[4:7], a[80:83], 0
    v_cvt_pk_bf16_f32 v36, v164, v165
    v_mfma_f32_16x16x32_bf16 v[92:95], a[4:7], a[84:87], 0
    buffer_load_dwordx4 a[4:7], v59, s[12:15], s29 offen offset:2048
    v_mfma_f32_16x16x32_bf16 v[96:99], a[8:11], a[72:75], 0
    v_mfma_f32_16x16x32_bf16 v[100:103], a[8:11], a[76:79], 0
    ds_read_b128 a[96:99], v5 offset:1024
    v_cvt_pk_bf16_f32 v37, v166, v167
    v_mfma_f32_16x16x32_bf16 v[104:107], a[8:11], a[80:83], 0
    v_mfma_f32_16x16x32_bf16 v[108:111], a[8:11], a[84:87], 0
    ds_read_b128 a[100:103], v5 offset:19456
    buffer_load_dwordx4 a[8:11], v60, s[12:15], s29 offen offset:2048
    s_waitcnt vmcnt(15) lgkmcnt(0)
    v_mfma_f32_16x16x32_bf16 v[64:67], a[12:15], a[88:91], v[64:67]
    buffer_store_dwordx4 v[34:37], v1, s[12:15], s30 offen offset:0 sc1
    v_mfma_f32_16x16x32_bf16 v[68:71], a[12:15], a[92:95], v[68:71]
    ds_read_b128 a[72:75], v4 offset:2048
    v_mfma_f32_16x16x32_bf16 v[72:75], a[12:15], a[96:99], v[72:75]
    v_mfma_f32_16x16x32_bf16 v[76:79], a[12:15], a[100:103], v[76:79]
    buffer_load_dwordx4 a[12:15], v58, s[12:15], s29 offen offset:3072
    v_cvt_pk_bf16_f32 v38, v168, v169
    v_mfma_f32_16x16x32_bf16 v[80:83], a[16:19], a[88:91], v[80:83]
    v_mfma_f32_16x16x32_bf16 v[84:87], a[16:19], a[92:95], v[84:87]
    ds_read_b128 a[76:79], v4 offset:20480
    v_mfma_f32_16x16x32_bf16 v[88:91], a[16:19], a[96:99], v[88:91]
    v_cvt_pk_bf16_f32 v39, v170, v171
    v_mfma_f32_16x16x32_bf16 v[92:95], a[16:19], a[100:103], v[92:95]
    buffer_load_dwordx4 a[16:19], v59, s[12:15], s29 offen offset:3072
    v_mfma_f32_16x16x32_bf16 v[96:99], a[20:23], a[88:91], v[96:99]
    v_mfma_f32_16x16x32_bf16 v[100:103], a[20:23], a[92:95], v[100:103]
    ds_read_b128 a[80:83], v5 offset:2048
    v_cvt_pk_bf16_f32 v40, v172, v173
    v_mfma_f32_16x16x32_bf16 v[104:107], a[20:23], a[96:99], v[104:107]
    v_mfma_f32_16x16x32_bf16 v[108:111], a[20:23], a[100:103], v[108:111]
    ds_read_b128 a[84:87], v5 offset:20480
    buffer_load_dwordx4 a[20:23], v60, s[12:15], s29 offen offset:3072
    s_waitcnt vmcnt(16) lgkmcnt(0)
    v_mfma_f32_16x16x32_bf16 v[64:67], a[24:27], a[72:75], v[64:67]
    v_cvt_pk_bf16_f32 v41, v174, v175
    v_mfma_f32_16x16x32_bf16 v[68:71], a[24:27], a[76:79], v[68:71]
    ds_read_b128 a[88:91], v4 offset:3072
    v_mfma_f32_16x16x32_bf16 v[72:75], a[24:27], a[80:83], v[72:75]
    v_mfma_f32_16x16x32_bf16 v[76:79], a[24:27], a[84:87], v[76:79]
    s_add_u32 s29, s29, 4096
    buffer_load_dwordx4 a[24:27], v58, s[12:15], s29 offen offset:0
    s_add_u32 s30, s30, 36864
    buffer_store_dwordx4 v[38:41], v1, s[12:15], s30 offen offset:0 sc1
    v_mfma_f32_16x16x32_bf16 v[80:83], a[28:31], a[72:75], v[80:83]
    v_mfma_f32_16x16x32_bf16 v[84:87], a[28:31], a[76:79], v[84:87]
    ds_read_b128 a[92:95], v4 offset:21504
    v_mfma_f32_16x16x32_bf16 v[88:91], a[28:31], a[80:83], v[88:91]
    v_cvt_pk_bf16_f32 v34, v176, v177
    v_mfma_f32_16x16x32_bf16 v[92:95], a[28:31], a[84:87], v[92:95]
    buffer_load_dwordx4 a[28:31], v59, s[12:15], s29 offen offset:0
    v_mfma_f32_16x16x32_bf16 v[96:99], a[32:35], a[72:75], v[96:99]
    v_mfma_f32_16x16x32_bf16 v[100:103], a[32:35], a[76:79], v[100:103]
    ds_read_b128 a[96:99], v5 offset:3072
    v_cvt_pk_bf16_f32 v35, v178, v179
    v_mfma_f32_16x16x32_bf16 v[104:107], a[32:35], a[80:83], v[104:107]
    v_mfma_f32_16x16x32_bf16 v[108:111], a[32:35], a[84:87], v[108:111]
    ds_read_b128 a[100:103], v5 offset:21504
    buffer_load_dwordx4 a[32:35], v60, s[12:15], s29 offen offset:0
    s_waitcnt vmcnt(17) lgkmcnt(0)
    v_mfma_f32_16x16x32_bf16 v[64:67], a[36:39], a[88:91], v[64:67]
    v_cvt_pk_bf16_f32 v36, v180, v181
    v_mfma_f32_16x16x32_bf16 v[68:71], a[36:39], a[92:95], v[68:71]
    ds_read_b128 a[72:75], v4 offset:4096
    v_mfma_f32_16x16x32_bf16 v[72:75], a[36:39], a[96:99], v[72:75]
    v_mfma_f32_16x16x32_bf16 v[76:79], a[36:39], a[100:103], v[76:79]
    buffer_load_dwordx4 a[36:39], v58, s[12:15], s29 offen offset:1024
    v_cvt_pk_bf16_f32 v37, v182, v183
    v_mfma_f32_16x16x32_bf16 v[80:83], a[40:43], a[88:91], v[80:83]
    v_mfma_f32_16x16x32_bf16 v[84:87], a[40:43], a[92:95], v[84:87]
    ds_read_b128 a[76:79], v4 offset:22528
    v_mfma_f32_16x16x32_bf16 v[88:91], a[40:43], a[96:99], v[88:91]
    s_sub_u32 s30, s30, 35840
    buffer_store_dwordx4 v[34:37], v1, s[12:15], s30 offen offset:0 sc1
    v_mfma_f32_16x16x32_bf16 v[92:95], a[40:43], a[100:103], v[92:95]
    buffer_load_dwordx4 a[40:43], v59, s[12:15], s29 offen offset:1024
    v_mfma_f32_16x16x32_bf16 v[96:99], a[44:47], a[88:91], v[96:99]
    v_mfma_f32_16x16x32_bf16 v[100:103], a[44:47], a[92:95], v[100:103]
    ds_read_b128 a[80:83], v5 offset:4096
    v_cvt_pk_bf16_f32 v38, v184, v185
    v_mfma_f32_16x16x32_bf16 v[104:107], a[44:47], a[96:99], v[104:107]
    v_mfma_f32_16x16x32_bf16 v[108:111], a[44:47], a[100:103], v[108:111]
    ds_read_b128 a[84:87], v5 offset:22528
    buffer_load_dwordx4 a[44:47], v60, s[12:15], s29 offen offset:1024
    s_waitcnt vmcnt(18) lgkmcnt(0)
    v_mfma_f32_16x16x32_bf16 v[64:67], a[48:51], a[72:75], v[64:67]
    v_cvt_pk_bf16_f32 v39, v186, v187
    v_mfma_f32_16x16x32_bf16 v[68:71], a[48:51], a[76:79], v[68:71]
    ds_read_b128 a[88:91], v4 offset:5120
    v_mfma_f32_16x16x32_bf16 v[72:75], a[48:51], a[80:83], v[72:75]
    v_mfma_f32_16x16x32_bf16 v[76:79], a[48:51], a[84:87], v[76:79]
    buffer_load_dwordx4 a[48:51], v58, s[12:15], s29 offen offset:2048
    v_cvt_pk_bf16_f32 v40, v188, v189
    v_mfma_f32_16x16x32_bf16 v[80:83], a[52:55], a[72:75], v[80:83]
    v_mfma_f32_16x16x32_bf16 v[84:87], a[52:55], a[76:79], v[84:87]
    ds_read_b128 a[92:95], v4 offset:23552
    v_mfma_f32_16x16x32_bf16 v[88:91], a[52:55], a[80:83], v[88:91]
    v_cvt_pk_bf16_f32 v41, v190, v191
    v_mfma_f32_16x16x32_bf16 v[92:95], a[52:55], a[84:87], v[92:95]
    buffer_load_dwordx4 a[52:55], v59, s[12:15], s29 offen offset:2048
    v_mfma_f32_16x16x32_bf16 v[96:99], a[56:59], a[72:75], v[96:99]
    v_mfma_f32_16x16x32_bf16 v[100:103], a[56:59], a[76:79], v[100:103]
    ds_read_b128 a[96:99], v5 offset:5120
    s_add_u32 s30, s30, 36864
    buffer_store_dwordx4 v[38:41], v1, s[12:15], s30 offen offset:0 sc1
    v_mfma_f32_16x16x32_bf16 v[104:107], a[56:59], a[80:83], v[104:107]
    v_mfma_f32_16x16x32_bf16 v[108:111], a[56:59], a[84:87], v[108:111]
    ds_read_b128 a[100:103], v5 offset:23552
    buffer_load_dwordx4 a[56:59], v60, s[12:15], s29 offen offset:2048
    s_waitcnt vmcnt(19) lgkmcnt(0)
    v_mfma_f32_16x16x32_bf16 v[64:67], a[60:63], a[88:91], v[64:67]
    v_cvt_pk_bf16_f32 v34, v192, v193
    v_mfma_f32_16x16x32_bf16 v[68:71], a[60:63], a[92:95], v[68:71]
    ds_read_b128 a[72:75], v4 offset:6144
    v_mfma_f32_16x16x32_bf16 v[72:75], a[60:63], a[96:99], v[72:75]
    v_mfma_f32_16x16x32_bf16 v[76:79], a[60:63], a[100:103], v[76:79]
    buffer_load_dwordx4 a[60:63], v58, s[12:15], s29 offen offset:3072
    v_cvt_pk_bf16_f32 v35, v194, v195
    v_mfma_f32_16x16x32_bf16 v[80:83], a[64:67], a[88:91], v[80:83]
    v_mfma_f32_16x16x32_bf16 v[84:87], a[64:67], a[92:95], v[84:87]
    ds_read_b128 a[76:79], v4 offset:24576
    v_mfma_f32_16x16x32_bf16 v[88:91], a[64:67], a[96:99], v[88:91]
    v_cvt_pk_bf16_f32 v36, v196, v197
    v_mfma_f32_16x16x32_bf16 v[92:95], a[64:67], a[100:103], v[92:95]
    buffer_load_dwordx4 a[64:67], v59, s[12:15], s29 offen offset:3072
    v_mfma_f32_16x16x32_bf16 v[96:99], a[68:71], a[88:91], v[96:99]
    v_mfma_f32_16x16x32_bf16 v[100:103], a[68:71], a[92:95], v[100:103]
    ds_read_b128 a[80:83], v5 offset:6144
    v_cvt_pk_bf16_f32 v37, v198, v199
    v_mfma_f32_16x16x32_bf16 v[104:107], a[68:71], a[96:99], v[104:107]
    v_mfma_f32_16x16x32_bf16 v[108:111], a[68:71], a[100:103], v[108:111]
    ds_read_b128 a[84:87], v5 offset:24576
    buffer_load_dwordx4 a[68:71], v60, s[12:15], s29 offen offset:3072
    s_waitcnt vmcnt(19) lgkmcnt(0)
    v_mfma_f32_16x16x32_bf16 v[64:67], a[0:3], a[72:75], v[64:67]
    s_sub_u32 s30, s30, 35840
    buffer_store_dwordx4 v[34:37], v1, s[12:15], s30 offen offset:0 sc1
    v_mfma_f32_16x16x32_bf16 v[68:71], a[0:3], a[76:79], v[68:71]
    ds_read_b128 a[88:91], v4 offset:7168
    v_mfma_f32_16x16x32_bf16 v[72:75], a[0:3], a[80:83], v[72:75]
    v_mfma_f32_16x16x32_bf16 v[76:79], a[0:3], a[84:87], v[76:79]
    s_add_u32 s29, s29, 4096
    buffer_load_dwordx4 a[0:3], v58, s[12:15], s29 offen offset:0
    v_cvt_pk_bf16_f32 v38, v200, v201
    v_mfma_f32_16x16x32_bf16 v[80:83], a[4:7], a[72:75], v[80:83]
    v_mfma_f32_16x16x32_bf16 v[84:87], a[4:7], a[76:79], v[84:87]
    ds_read_b128 a[92:95], v4 offset:25600
    v_mfma_f32_16x16x32_bf16 v[88:91], a[4:7], a[80:83], v[88:91]
    v_cvt_pk_bf16_f32 v39, v202, v203
    v_mfma_f32_16x16x32_bf16 v[92:95], a[4:7], a[84:87], v[92:95]
    buffer_load_dwordx4 a[4:7], v59, s[12:15], s29 offen offset:0
    v_mfma_f32_16x16x32_bf16 v[96:99], a[8:11], a[72:75], v[96:99]
    v_mfma_f32_16x16x32_bf16 v[100:103], a[8:11], a[76:79], v[100:103]
    ds_read_b128 a[96:99], v5 offset:7168
    v_cvt_pk_bf16_f32 v40, v204, v205
    v_mfma_f32_16x16x32_bf16 v[104:107], a[8:11], a[80:83], v[104:107]
    v_mfma_f32_16x16x32_bf16 v[108:111], a[8:11], a[84:87], v[108:111]
    ds_read_b128 a[100:103], v5 offset:25600
    buffer_load_dwordx4 a[8:11], v60, s[12:15], s29 offen offset:0
    s_waitcnt vmcnt(19) lgkmcnt(0)
    v_mfma_f32_16x16x32_bf16 v[64:67], a[12:15], a[88:91], v[64:67]
    v_cvt_pk_bf16_f32 v41, v206, v207
    v_mfma_f32_16x16x32_bf16 v[68:71], a[12:15], a[92:95], v[68:71]
    ds_read_b128 a[72:75], v4 offset:8192
    v_mfma_f32_16x16x32_bf16 v[72:75], a[12:15], a[96:99], v[72:75]
    v_mfma_f32_16x16x32_bf16 v[76:79], a[12:15], a[100:103], v[76:79]
    buffer_load_dwordx4 a[12:15], v58, s[12:15], s29 offen offset:1024
    s_add_u32 s30, s30, 36864
    buffer_store_dwordx4 v[38:41], v1, s[12:15], s30 offen offset:0 sc1
    v_mfma_f32_16x16x32_bf16 v[80:83], a[16:19], a[88:91], v[80:83]
    v_mfma_f32_16x16x32_bf16 v[84:87], a[16:19], a[92:95], v[84:87]
    ds_read_b128 a[76:79], v4 offset:26624
    v_mfma_f32_16x16x32_bf16 v[88:91], a[16:19], a[96:99], v[88:91]
    v_cvt_pk_bf16_f32 v34, v208, v209
    v_mfma_f32_16x16x32_bf16 v[92:95], a[16:19], a[100:103], v[92:95]
    buffer_load_dwordx4 a[16:19], v59, s[12:15], s29 offen offset:1024
    v_mfma_f32_16x16x32_bf16 v[96:99], a[20:23], a[88:91], v[96:99]
    v_mfma_f32_16x16x32_bf16 v[100:103], a[20:23], a[92:95], v[100:103]
    ds_read_b128 a[80:83], v5 offset:8192
    v_cvt_pk_bf16_f32 v35, v210, v211
    v_mfma_f32_16x16x32_bf16 v[104:107], a[20:23], a[96:99], v[104:107]
    v_mfma_f32_16x16x32_bf16 v[108:111], a[20:23], a[100:103], v[108:111]
    ds_read_b128 a[84:87], v5 offset:26624
    buffer_load_dwordx4 a[20:23], v60, s[12:15], s29 offen offset:1024
    s_waitcnt vmcnt(19) lgkmcnt(0)
    v_mfma_f32_16x16x32_bf16 v[64:67], a[24:27], a[72:75], v[64:67]
    v_cvt_pk_bf16_f32 v36, v212, v213
    v_mfma_f32_16x16x32_bf16 v[68:71], a[24:27], a[76:79], v[68:71]
    ds_read_b128 a[88:91], v4 offset:9216
    v_mfma_f32_16x16x32_bf16 v[72:75], a[24:27], a[80:83], v[72:75]
    v_mfma_f32_16x16x32_bf16 v[76:79], a[24:27], a[84:87], v[76:79]
    buffer_load_dwordx4 a[24:27], v58, s[12:15], s29 offen offset:2048
    v_cvt_pk_bf16_f32 v37, v214, v215
    v_mfma_f32_16x16x32_bf16 v[80:83], a[28:31], a[72:75], v[80:83]
    v_mfma_f32_16x16x32_bf16 v[84:87], a[28:31], a[76:79], v[84:87]
    ds_read_b128 a[92:95], v4 offset:27648
    v_mfma_f32_16x16x32_bf16 v[88:91], a[28:31], a[80:83], v[88:91]
    s_sub_u32 s30, s30, 35840
    buffer_store_dwordx4 v[34:37], v1, s[12:15], s30 offen offset:0 sc1
    v_mfma_f32_16x16x32_bf16 v[92:95], a[28:31], a[84:87], v[92:95]
    buffer_load_dwordx4 a[28:31], v59, s[12:15], s29 offen offset:2048
    v_mfma_f32_16x16x32_bf16 v[96:99], a[32:35], a[72:75], v[96:99]
    v_mfma_f32_16x16x32_bf16 v[100:103], a[32:35], a[76:79], v[100:103]
    ds_read_b128 a[96:99], v5 offset:9216
    v_cvt_pk_bf16_f32 v38, v216, v217
    v_mfma_f32_16x16x32_bf16 v[104:107], a[32:35], a[80:83], v[104:107]
    v_mfma_f32_16x16x32_bf16 v[108:111], a[32:35], a[84:87], v[108:111]
    ds_read_b128 a[100:103], v5 offset:27648
    buffer_load_dwordx4 a[32:35], v60, s[12:15], s29 offen offset:2048
    s_waitcnt vmcnt(19) lgkmcnt(0)
    v_mfma_f32_16x16x32_bf16 v[64:67], a[36:39], a[88:91], v[64:67]
    v_cvt_pk_bf16_f32 v39, v218, v219
    v_mfma_f32_16x16x32_bf16 v[68:71], a[36:39], a[92:95], v[68:71]
    ds_read_b128 a[72:75], v4 offset:10240
    v_mfma_f32_16x16x32_bf16 v[72:75], a[36:39], a[96:99], v[72:75]
    v_mfma_f32_16x16x32_bf16 v[76:79], a[36:39], a[100:103], v[76:79]
    buffer_load_dwordx4 a[36:39], v58, s[12:15], s29 offen offset:3072
    v_cvt_pk_bf16_f32 v40, v220, v221
    v_mfma_f32_16x16x32_bf16 v[80:83], a[40:43], a[88:91], v[80:83]
    v_mfma_f32_16x16x32_bf16 v[84:87], a[40:43], a[92:95], v[84:87]
    ds_read_b128 a[76:79], v4 offset:28672
    v_mfma_f32_16x16x32_bf16 v[88:91], a[40:43], a[96:99], v[88:91]
    v_cvt_pk_bf16_f32 v41, v222, v223
    v_mfma_f32_16x16x32_bf16 v[92:95], a[40:43], a[100:103], v[92:95]
    buffer_load_dwordx4 a[40:43], v59, s[12:15], s29 offen offset:3072
    v_mfma_f32_16x16x32_bf16 v[96:99], a[44:47], a[88:91], v[96:99]
    v_mfma_f32_16x16x32_bf16 v[100:103], a[44:47], a[92:95], v[100:103]
    ds_read_b128 a[80:83], v5 offset:10240
    s_add_u32 s30, s30, 36864
    buffer_store_dwordx4 v[38:41], v1, s[12:15], s30 offen offset:0 sc1
    v_mfma_f32_16x16x32_bf16 v[104:107], a[44:47], a[96:99], v[104:107]
    v_mfma_f32_16x16x32_bf16 v[108:111], a[44:47], a[100:103], v[108:111]
    ds_read_b128 a[84:87], v5 offset:28672
    buffer_load_dwordx4 a[44:47], v60, s[12:15], s29 offen offset:3072
    s_waitcnt vmcnt(19) lgkmcnt(0)
    v_mfma_f32_16x16x32_bf16 v[64:67], a[48:51], a[72:75], v[64:67]
    v_cvt_pk_bf16_f32 v34, v224, v225
    v_mfma_f32_16x16x32_bf16 v[68:71], a[48:51], a[76:79], v[68:71]
    ds_read_b128 a[88:91], v4 offset:11264
    v_mfma_f32_16x16x32_bf16 v[72:75], a[48:51], a[80:83], v[72:75]
    v_mfma_f32_16x16x32_bf16 v[76:79], a[48:51], a[84:87], v[76:79]
    s_add_u32 s29, s29, 4096
    buffer_load_dwordx4 a[48:51], v58, s[12:15], s29 offen offset:0
    v_cvt_pk_bf16_f32 v35, v226, v227
    v_mfma_f32_16x16x32_bf16 v[80:83], a[52:55], a[72:75], v[80:83]
    v_mfma_f32_16x16x32_bf16 v[84:87], a[52:55], a[76:79], v[84:87]
    ds_read_b128 a[92:95], v4 offset:29696
    v_mfma_f32_16x16x32_bf16 v[88:91], a[52:55], a[80:83], v[88:91]
    v_cvt_pk_bf16_f32 v36, v228, v229
    v_mfma_f32_16x16x32_bf16 v[92:95], a[52:55], a[84:87], v[92:95]
    buffer_load_dwordx4 a[52:55], v59, s[12:15], s29 offen offset:0
    v_mfma_f32_16x16x32_bf16 v[96:99], a[56:59], a[72:75], v[96:99]
    v_mfma_f32_16x16x32_bf16 v[100:103], a[56:59], a[76:79], v[100:103]
    ds_read_b128 a[96:99], v5 offset:11264
    v_cvt_pk_bf16_f32 v37, v230, v231
    v_mfma_f32_16x16x32_bf16 v[104:107], a[56:59], a[80:83], v[104:107]
    v_mfma_f32_16x16x32_bf16 v[108:111], a[56:59], a[84:87], v[108:111]
    ds_read_b128 a[100:103], v5 offset:29696
    buffer_load_dwordx4 a[56:59], v60, s[12:15], s29 offen offset:0
    s_waitcnt vmcnt(19) lgkmcnt(0)
    v_mfma_f32_16x16x32_bf16 v[64:67], a[60:63], a[88:91], v[64:67]
    s_sub_u32 s30, s30, 35840
    buffer_store_dwordx4 v[34:37], v1, s[12:15], s30 offen offset:0 sc1
    v_mfma_f32_16x16x32_bf16 v[68:71], a[60:63], a[92:95], v[68:71]
    ds_read_b128 a[72:75], v4 offset:12288
    v_mfma_f32_16x16x32_bf16 v[72:75], a[60:63], a[96:99], v[72:75]
    v_mfma_f32_16x16x32_bf16 v[76:79], a[60:63], a[100:103], v[76:79]
    buffer_load_dwordx4 a[60:63], v58, s[12:15], s29 offen offset:1024
    v_cvt_pk_bf16_f32 v38, v232, v233
    v_mfma_f32_16x16x32_bf16 v[80:83], a[64:67], a[88:91], v[80:83]
    v_mfma_f32_16x16x32_bf16 v[84:87], a[64:67], a[92:95], v[84:87]
    ds_read_b128 a[76:79], v4 offset:30720
    v_mfma_f32_16x16x32_bf16 v[88:91], a[64:67], a[96:99], v[88:91]
    v_cvt_pk_bf16_f32 v39, v234, v235
    v_mfma_f32_16x16x32_bf16 v[92:95], a[64:67], a[100:103], v[92:95]
    buffer_load_dwordx4 a[64:67], v59, s[12:15], s29 offen offset:1024
    v_mfma_f32_16x16x32_bf16 v[96:99], a[68:71], a[88:91], v[96:99]
    v_mfma_f32_16x16x32_bf16 v[100:103], a[68:71], a[92:95], v[100:103]
    ds_read_b128 a[80:83], v5 offset:12288
    v_cvt_pk_bf16_f32 v40, v236, v237
    v_mfma_f32_16x16x32_bf16 v[104:107], a[68:71], a[96:99], v[104:107]
    v_mfma_f32_16x16x32_bf16 v[108:111], a[68:71], a[100:103], v[108:111]
    ds_read_b128 a[84:87], v5 offset:30720
    buffer_load_dwordx4 a[68:71], v60, s[12:15], s29 offen offset:1024
    s_waitcnt vmcnt(19) lgkmcnt(0)
    v_mfma_f32_16x16x32_bf16 v[64:67], a[0:3], a[72:75], v[64:67]
    v_cvt_pk_bf16_f32 v41, v238, v239
    v_mfma_f32_16x16x32_bf16 v[68:71], a[0:3], a[76:79], v[68:71]
    ds_read_b128 a[88:91], v4 offset:13312
    v_mfma_f32_16x16x32_bf16 v[72:75], a[0:3], a[80:83], v[72:75]
    v_mfma_f32_16x16x32_bf16 v[76:79], a[0:3], a[84:87], v[76:79]
    s_add_u32 s30, s30, 36864
    buffer_store_dwordx4 v[38:41], v1, s[12:15], s30 offen offset:0 sc1
    v_mfma_f32_16x16x32_bf16 v[80:83], a[4:7], a[72:75], v[80:83]
    v_mfma_f32_16x16x32_bf16 v[84:87], a[4:7], a[76:79], v[84:87]
    ds_read_b128 a[92:95], v4 offset:31744
    v_mfma_f32_16x16x32_bf16 v[88:91], a[4:7], a[80:83], v[88:91]
    v_cvt_pk_bf16_f32 v34, v240, v241
    v_mfma_f32_16x16x32_bf16 v[92:95], a[4:7], a[84:87], v[92:95]
    v_mfma_f32_16x16x32_bf16 v[96:99], a[8:11], a[72:75], v[96:99]
    v_mfma_f32_16x16x32_bf16 v[100:103], a[8:11], a[76:79], v[100:103]
    ds_read_b128 a[96:99], v5 offset:13312
    v_cvt_pk_bf16_f32 v35, v242, v243
    v_mfma_f32_16x16x32_bf16 v[104:107], a[8:11], a[80:83], v[104:107]
    v_mfma_f32_16x16x32_bf16 v[108:111], a[8:11], a[84:87], v[108:111]
    ds_read_b128 a[100:103], v5 offset:31744
    s_waitcnt vmcnt(16) lgkmcnt(0)
    v_mfma_f32_16x16x32_bf16 v[64:67], a[12:15], a[88:91], v[64:67]
    v_cvt_pk_bf16_f32 v36, v244, v245
    v_mfma_f32_16x16x32_bf16 v[68:71], a[12:15], a[92:95], v[68:71]
    ds_read_b128 a[72:75], v4 offset:14336
    v_mfma_f32_16x16x32_bf16 v[72:75], a[12:15], a[96:99], v[72:75]
    v_mfma_f32_16x16x32_bf16 v[76:79], a[12:15], a[100:103], v[76:79]
    v_cvt_pk_bf16_f32 v37, v246, v247
    v_mfma_f32_16x16x32_bf16 v[80:83], a[16:19], a[88:91], v[80:83]
    v_mfma_f32_16x16x32_bf16 v[84:87], a[16:19], a[92:95], v[84:87]
    ds_read_b128 a[76:79], v4 offset:32768
    v_mfma_f32_16x16x32_bf16 v[88:91], a[16:19], a[96:99], v[88:91]
    s_sub_u32 s30, s30, 35840
    buffer_store_dwordx4 v[34:37], v1, s[12:15], s30 offen offset:0 sc1
    v_mfma_f32_16x16x32_bf16 v[92:95], a[16:19], a[100:103], v[92:95]
    v_mfma_f32_16x16x32_bf16 v[96:99], a[20:23], a[88:91], v[96:99]
    v_mfma_f32_16x16x32_bf16 v[100:103], a[20:23], a[92:95], v[100:103]
    ds_read_b128 a[80:83], v5 offset:14336
    v_cvt_pk_bf16_f32 v38, v248, v249
    v_mfma_f32_16x16x32_bf16 v[104:107], a[20:23], a[96:99], v[104:107]
    v_mfma_f32_16x16x32_bf16 v[108:111], a[20:23], a[100:103], v[108:111]
    ds_read_b128 a[84:87], v5 offset:32768
    s_waitcnt vmcnt(13) lgkmcnt(0)
    v_mfma_f32_16x16x32_bf16 v[64:67], a[24:27], a[72:75], v[64:67]
    v_cvt_pk_bf16_f32 v39, v250, v251
    v_mfma_f32_16x16x32_bf16 v[68:71], a[24:27], a[76:79], v[68:71]
    ds_read_b128 a[88:91], v4 offset:15360
    v_mfma_f32_16x16x32_bf16 v[72:75], a[24:27], a[80:83], v[72:75]
    v_mfma_f32_16x16x32_bf16 v[76:79], a[24:27], a[84:87], v[76:79]
    v_cvt_pk_bf16_f32 v40, v252, v253
    v_mfma_f32_16x16x32_bf16 v[80:83], a[28:31], a[72:75], v[80:83]
    v_mfma_f32_16x16x32_bf16 v[84:87], a[28:31], a[76:79], v[84:87]
    ds_read_b128 a[92:95], v4 offset:33792
    v_mfma_f32_16x16x32_bf16 v[88:91], a[28:31], a[80:83], v[88:91]
    v_cvt_pk_bf16_f32 v41, v254, v255
    v_mfma_f32_16x16x32_bf16 v[92:95], a[28:31], a[84:87], v[92:95]
    v_mfma_f32_16x16x32_bf16 v[96:99], a[32:35], a[72:75], v[96:99]
    v_mfma_f32_16x16x32_bf16 v[100:103], a[32:35], a[76:79], v[100:103]
    ds_read_b128 a[96:99], v5 offset:15360
    s_add_u32 s30, s30, 36864
    buffer_store_dwordx4 v[38:41], v1, s[12:15], s30 offen offset:0 sc1
    v_mfma_f32_16x16x32_bf16 v[104:107], a[32:35], a[80:83], v[104:107]
    v_mfma_f32_16x16x32_bf16 v[108:111], a[32:35], a[84:87], v[108:111]
    ds_read_b128 a[100:103], v5 offset:33792
    s_waitcnt vmcnt(10) lgkmcnt(0)
    v_mfma_f32_16x16x32_bf16 v[64:67], a[36:39], a[88:91], v[64:67]
    v_mfma_f32_16x16x32_bf16 v[68:71], a[36:39], a[92:95], v[68:71]
    ds_read_b128 a[72:75], v4 offset:16384
    v_mfma_f32_16x16x32_bf16 v[72:75], a[36:39], a[96:99], v[72:75]
    v_mfma_f32_16x16x32_bf16 v[76:79], a[36:39], a[100:103], v[76:79]
    v_mfma_f32_16x16x32_bf16 v[80:83], a[40:43], a[88:91], v[80:83]
    v_mfma_f32_16x16x32_bf16 v[84:87], a[40:43], a[92:95], v[84:87]
    ds_read_b128 a[76:79], v4 offset:34816
    v_mfma_f32_16x16x32_bf16 v[88:91], a[40:43], a[96:99], v[88:91]
    v_mfma_f32_16x16x32_bf16 v[92:95], a[40:43], a[100:103], v[92:95]
    v_mfma_f32_16x16x32_bf16 v[96:99], a[44:47], a[88:91], v[96:99]
    v_mfma_f32_16x16x32_bf16 v[100:103], a[44:47], a[92:95], v[100:103]
    ds_read_b128 a[80:83], v5 offset:16384
    v_mfma_f32_16x16x32_bf16 v[104:107], a[44:47], a[96:99], v[104:107]
    v_mfma_f32_16x16x32_bf16 v[108:111], a[44:47], a[100:103], v[108:111]
    ds_read_b128 a[84:87], v5 offset:34816
    s_waitcnt vmcnt(7) lgkmcnt(0)
    v_mfma_f32_16x16x32_bf16 v[64:67], a[48:51], a[72:75], v[64:67]
    v_mfma_f32_16x16x32_bf16 v[68:71], a[48:51], a[76:79], v[68:71]
    ds_read_b128 a[88:91], v4 offset:17408
    v_mfma_f32_16x16x32_bf16 v[72:75], a[48:51], a[80:83], v[72:75]
    v_mfma_f32_16x16x32_bf16 v[76:79], a[48:51], a[84:87], v[76:79]
    v_mfma_f32_16x16x32_bf16 v[80:83], a[52:55], a[72:75], v[80:83]
    v_mfma_f32_16x16x32_bf16 v[84:87], a[52:55], a[76:79], v[84:87]
    ds_read_b128 a[92:95], v4 offset:35840
    v_mfma_f32_16x16x32_bf16 v[88:91], a[52:55], a[80:83], v[88:91]
    v_mfma_f32_16x16x32_bf16 v[92:95], a[52:55], a[84:87], v[92:95]
    v_mfma_f32_16x16x32_bf16 v[96:99], a[56:59], a[72:75], v[96:99]
    v_mfma_f32_16x16x32_bf16 v[100:103], a[56:59], a[76:79], v[100:103]
    ds_read_b128 a[96:99], v5 offset:17408
    v_mfma_f32_16x16x32_bf16 v[104:107], a[56:59], a[80:83], v[104:107]
    v_mfma_f32_16x16x32_bf16 v[108:111], a[56:59], a[84:87], v[108:111]
    ds_read_b128 a[100:103], v5 offset:35840
    s_waitcnt vmcnt(3) lgkmcnt(0)
    v_mfma_f32_16x16x32_bf16 v[64:67], a[60:63], a[88:91], v[64:67]
    v_mfma_f32_16x16x32_bf16 v[68:71], a[60:63], a[92:95], v[68:71]
    v_mfma_f32_16x16x32_bf16 v[72:75], a[60:63], a[96:99], v[72:75]
    v_mfma_f32_16x16x32_bf16 v[76:79], a[60:63], a[100:103], v[76:79]
    v_mfma_f32_16x16x32_bf16 v[80:83], a[64:67], a[88:91], v[80:83]
    v_mfma_f32_16x16x32_bf16 v[84:87], a[64:67], a[92:95], v[84:87]
    v_mfma_f32_16x16x32_bf16 v[88:91], a[64:67], a[96:99], v[88:91]
    v_mfma_f32_16x16x32_bf16 v[92:95], a[64:67], a[100:103], v[92:95]
    v_mfma_f32_16x16x32_bf16 v[96:99], a[68:71], a[88:91], v[96:99]
    v_mfma_f32_16x16x32_bf16 v[100:103], a[68:71], a[92:95], v[100:103]
    v_mfma_f32_16x16x32_bf16 v[104:107], a[68:71], a[96:99], v[104:107]
    v_mfma_f32_16x16x32_bf16 v[108:111], a[68:71], a[100:103], v[108:111]
    s_nop 7
    v_cvt_pk_bf16_f32 v34, v64, v65
    v_cvt_pk_bf16_f32 v35, v66, v67
    v_cvt_pk_bf16_f32 v36, v68, v69
    v_cvt_pk_bf16_f32 v37, v70, v71
    s_sub_u32 s30, s30, 35840
    buffer_store_dwordx4 v[34:37], v1, s[12:15], s30 offen offset:0 sc1
    v_cvt_pk_bf16_f32 v38, v72, v73
    v_cvt_pk_bf16_f32 v39, v74, v75
    v_cvt_pk_bf16_f32 v40, v76, v77
    v_cvt_pk_bf16_f32 v41, v78, v79
    s_add_u32 s30, s30, 36864
    buffer_store_dwordx4 v[38:41], v1, s[12:15], s30 offen offset:0 sc1
    v_cvt_pk_bf16_f32 v34, v80, v81
    v_cvt_pk_bf16_f32 v35, v82, v83
    v_cvt_pk_bf16_f32 v36, v84, v85
    v_cvt_pk_bf16_f32 v37, v86, v87
    s_sub_u32 s30, s30, 35840
    buffer_store_dwordx4 v[34:37], v1, s[12:15], s30 offen offset:0 sc1
    v_cvt_pk_bf16_f32 v38, v88, v89
    v_cvt_pk_bf16_f32 v39, v90, v91
    v_cvt_pk_bf16_f32 v40, v92, v93
    v_cvt_pk_bf16_f32 v41, v94, v95
    s_add_u32 s30, s30, 36864
    buffer_store_dwordx4 v[38:41], v1, s[12:15], s30 offen offset:0 sc1
    v_cvt_pk_bf16_f32 v34, v96, v97
    v_cvt_pk_bf16_f32 v35, v98, v99
    v_cvt_pk_bf16_f32 v36, v100, v101
    v_cvt_pk_bf16_f32 v37, v102, v103
    s_sub_u32 s30, s30, 35840
    buffer_store_dwordx4 v[34:37], v1, s[12:15], s30 offen offset:0 sc1
    v_cvt_pk_bf16_f32 v38, v104, v105
    v_cvt_pk_bf16_f32 v39, v106, v107
    v_cvt_pk_bf16_f32 v40, v108, v109
    v_cvt_pk_bf16_f32 v41, v110, v111
    s_add_u32 s30, s30, 36864
    buffer_store_dwordx4 v[38:41], v1, s[12:15], s30 offen offset:0 sc1
K4_END:
    s_endpgm
.text
.globl k5_reduce_kernel
.p2align 8
.type k5_reduce_kernel,@function
k5_reduce_kernel:
    s_cmp_ge_u32 s2, 576
    s_cbranch_scc1 K5_END
    s_load_dwordx2 s[8:9], s[0:1], 72
    s_load_dwordx2 s[4:5], s[0:1], 56
    v_lshrrev_b32 v2, 6, v0
    v_and_b32 v1, 63, v0
    s_nop 0
    v_readfirstlane_b32 s30, v2
    v_lshlrev_b32 v4, 4, v1
    s_mul_i32 s19, s2, 2
    s_add_u32 s19, s19, s30
    s_mul_i32 s20, s19, 3641
    s_lshr_b32 s20, s20, 16
    s_mul_i32 s21, s20, 18
    s_sub_u32 s21, s19, s21
    v_and_b32 v5, 15, v1
    v_mul_u32_u24 v6, 1152, v5
    v_lshrrev_b32 v5, 4, v1
    v_lshl_add_u32 v6, v5, 4, v6
    s_mul_i32 s22, s20, 36
    s_lshl_b32 s23, s21, 1
    s_add_u32 s22, s22, s23
    s_lshl_b32 s22, s22, 10
    s_add_u32 s22, s22, 29360128
    s_mul_i32 s23, s20, 36
    s_add_u32 s23, s23, s21
    s_lshl_b32 s23, s23, 10
    s_add_u32 s23, s23, 9568256
    s_mul_i32 s24, s20, 36864
    s_lshl_b32 s25, s21, 6
    s_add_u32 s24, s24, s25
    s_waitcnt lgkmcnt(0)
    s_mov_b32 s12, s8
    s_and_b32 s13, s9, 0xffff
    s_mov_b32 s14, 48234496
    s_mov_b32 s15, 0x20000
    s_mov_b32 s16, s4
    s_and_b32 s17, s5, 0xffff
    s_mov_b32 s18, 2359296
    s_mov_b32 s19, 0x20000
    buffer_load_dwordx4 v[8:11], v4, s[12:15], s23 offen
    s_add_u32 s23, s23, 18432
    buffer_load_dwordx4 v[12:15], v4, s[12:15], s23 offen
    buffer_load_dwordx4 v[16:19], v4, s[12:15], s22 offen
    buffer_load_dwordx4 v[20:23], v4, s[12:15], s22 offen offset:1024
    s_add_u32 s22, s22, 2359296
    buffer_load_dwordx4 v[24:27], v4, s[12:15], s22 offen
    buffer_load_dwordx4 v[28:31], v4, s[12:15], s22 offen offset:1024
    s_add_u32 s22, s22, 2359296
    buffer_load_dwordx4 v[32:35], v4, s[12:15], s22 offen
    buffer_load_dwordx4 v[36:39], v4, s[12:15], s22 offen offset:1024
    s_add_u32 s22, s22, 2359296
    buffer_load_dwordx4 v[40:43], v4, s[12:15], s22 offen
    buffer_load_dwordx4 v[44:47], v4, s[12:15], s22 offen offset:1024
    s_add_u32 s22, s22, 2359296
    buffer_load_dwordx4 v[48:51], v4, s[12:15], s22 offen
    buffer_load_dwordx4 v[52:55], v4, s[12:15], s22 offen offset:1024
    s_add_u32 s22, s22, 2359296
    buffer_load_dwordx4 v[56:59], v4, s[12:15], s22 offen
    buffer_load_dwordx4 v[60:63], v4, s[12:15], s22 offen offset:1024
    s_add_u32 s22, s22, 2359296
    buffer_load_dwordx4 v[64:67], v4, s[12:15], s22 offen
    buffer_load_dwordx4 v[68:71], v4, s[12:15], s22 offen offset:1024
    s_add_u32 s22, s22, 2359296
    buffer_load_dwordx4 v[72:75], v4, s[12:15], s22 offen
    buffer_load_dwordx4 v[76:79], v4, s[12:15], s22 offen offset:1024
    s_waitcnt vmcnt(16)
    v_lshlrev_b32 v80, 16, v8
    v_and_b32 v81, 0xffff0000, v8
    v_lshlrev_b32 v88, 16, v12
    v_and_b32 v89, 0xffff0000, v12
    v_lshlrev_b32 v82, 16, v9
    v_and_b32 v83, 0xffff0000, v9
    v_lshlrev_b32 v90, 16, v13
    v_and_b32 v91, 0xffff0000, v13
    v_lshlrev_b32 v84, 16, v10
    v_and_b32 v85, 0xffff0000, v10
    v_lshlrev_b32 v92, 16, v14
    v_and_b32 v93, 0xffff0000, v14
    v_lshlrev_b32 v86, 16, v11
    v_and_b32 v87, 0xffff0000, v11
    v_lshlrev_b32 v94, 16, v15
    v_and_b32 v95, 0xffff0000, v15
    s_waitcnt vmcnt(14)
    v_lshlrev_b32 v96, 16, v16
    v_and_b32 v97, 0xffff0000, v16
    v_lshlrev_b32 v98, 16, v17
    v_and_b32 v99, 0xffff0000, v17
    v_lshlrev_b32 v100, 16, v18
    v_and_b32 v101, 0xffff0000, v18
    v_lshlrev_b32 v102, 16, v19
    v_and_b32 v103, 0xffff0000, v19
    v_lshlrev_b32 v104, 16, v20
    v_and_b32 v105, 0xffff0000, v20
    v_lshlrev_b32 v106, 16, v21
    v_and_b32 v107, 0xffff0000, v21
    v_lshlrev_b32 v108, 16, v22
    v_and_b32 v109, 0xffff0000, v22
    v_lshlrev_b32 v110, 16, v23
    v_and_b32 v111, 0xffff0000, v23
    v_pk_add_f32 v[80:81], v[80:81], v[96:97]
    v_pk_add_f32 v[82:83], v[82:83], v[98:99]
    v_pk_add_f32 v[88:89], v[88:89], v[100:101]
    v_pk_add_f32 v[90:91], v[90:91], v[102:103]
    v_pk_add_f32 v[84:85], v[84:85], v[104:105]
    v_pk_add_f32 v[86:87], v[86:87], v[106:107]
    v_pk_add_f32 v[92:93], v[92:93], v[108:109]
    v_pk_add_f32 v[94:95], v[94:95], v[110:111]
    s_waitcnt vmcnt(12)
    v_lshlrev_b32 v96, 16, v24
    v_and_b32 v97, 0xffff0000, v24
    v_lshlrev_b32 v98, 16, v25
    v_and_b32 v99, 0xffff0000, v25
    v_lshlrev_b32 v100, 16, v26
    v_and_b32 v101, 0xffff0000, v26
    v_lshlrev_b32 v102, 16, v27
    v_and_b32 v103, 0xffff0000, v27
    v_lshlrev_b32 v104, 16, v28
    v_and_b32 v105, 0xffff0000, v28
    v_lshlrev_b32 v106, 16, v29
    v_and_b32 v107, 0xffff0000, v29
    v_lshlrev_b32 v108, 16, v30
    v_and_b32 v109, 0xffff0000, v30
    v_lshlrev_b32 v110, 16, v31
    v_and_b32 v111, 0xffff0000, v31
    v_pk_add_f32 v[80:81], v[80:81], v[96:97]
    v_pk_add_f32 v[82:83], v[82:83], v[98:99]
    v_pk_add_f32 v[88:89], v[88:89], v[100:101]
    v_pk_add_f32 v[90:91], v[90:91], v[102:103]
    v_pk_add_f32 v[84:85], v[84:85], v[104:105]
    v_pk_add_f32 v[86:87], v[86:87], v[106:107]
    v_pk_add_f32 v[92:93], v[92:93], v[108:109]
    v_pk_add_f32 v[94:95], v[94:95], v[110:111]
    s_waitcnt vmcnt(10)
    v_lshlrev_b32 v96, 16, v32
    v_and_b32 v97, 0xffff0000, v32
    v_lshlrev_b32 v98, 16, v33
    v_and_b32 v99, 0xffff0000, v33
    v_lshlrev_b32 v100, 16, v34
    v_and_b32 v101, 0xffff0000, v34
    v_lshlrev_b32 v102, 16, v35
    v_and_b32 v103, 0xffff0000, v35
    v_lshlrev_b32 v104, 16, v36
    v_and_b32 v105, 0xffff0000, v36
    v_lshlrev_b32 v106, 16, v37
    v_and_b32 v107, 0xffff0000, v37
    v_lshlrev_b32 v108, 16, v38
    v_and_b32 v109, 0xffff0000, v38
    v_lshlrev_b32 v110, 16, v39
    v_and_b32 v111, 0xffff0000, v39
    v_pk_add_f32 v[80:81], v[80:81], v[96:97]
    v_pk_add_f32 v[82:83], v[82:83], v[98:99]
    v_pk_add_f32 v[88:89], v[88:89], v[100:101]
    v_pk_add_f32 v[90:91], v[90:91], v[102:103]
    v_pk_add_f32 v[84:85], v[84:85], v[104:105]
    v_pk_add_f32 v[86:87], v[86:87], v[106:107]
    v_pk_add_f32 v[92:93], v[92:93], v[108:109]
    v_pk_add_f32 v[94:95], v[94:95], v[110:111]
    s_waitcnt vmcnt(8)
    v_lshlrev_b32 v96, 16, v40
    v_and_b32 v97, 0xffff0000, v40
    v_lshlrev_b32 v98, 16, v41
    v_and_b32 v99, 0xffff0000, v41
    v_lshlrev_b32 v100, 16, v42
    v_and_b32 v101, 0xffff0000, v42
    v_lshlrev_b32 v102, 16, v43
    v_and_b32 v103, 0xffff0000, v43
    v_lshlrev_b32 v104, 16, v44
    v_and_b32 v105, 0xffff0000, v44
    v_lshlrev_b32 v106, 16, v45
    v_and_b32 v107, 0xffff0000, v45
    v_lshlrev_b32 v108, 16, v46
    v_and_b32 v109, 0xffff0000, v46
    v_lshlrev_b32 v110, 16, v47
    v_and_b32 v111, 0xffff0000, v47
    v_pk_add_f32 v[80:81], v[80:81], v[96:97]
    v_pk_add_f32 v[82:83], v[82:83], v[98:99]
    v_pk_add_f32 v[88:89], v[88:89], v[100:101]
    v_pk_add_f32 v[90:91], v[90:91], v[102:103]
    v_pk_add_f32 v[84:85], v[84:85], v[104:105]
    v_pk_add_f32 v[86:87], v[86:87], v[106:107]
    v_pk_add_f32 v[92:93], v[92:93], v[108:109]
    v_pk_add_f32 v[94:95], v[94:95], v[110:111]
    s_waitcnt vmcnt(6)
    v_lshlrev_b32 v96, 16, v48
    v_and_b32 v97, 0xffff0000, v48
    v_lshlrev_b32 v98, 16, v49
    v_and_b32 v99, 0xffff0000, v49
    v_lshlrev_b32 v100, 16, v50
    v_and_b32 v101, 0xffff0000, v50
    v_lshlrev_b32 v102, 16, v51
    v_and_b32 v103, 0xffff0000, v51
    v_lshlrev_b32 v104, 16, v52
    v_and_b32 v105, 0xffff0000, v52
    v_lshlrev_b32 v106, 16, v53
    v_and_b32 v107, 0xffff0000, v53
    v_lshlrev_b32 v108, 16, v54
    v_and_b32 v109, 0xffff0000, v54
    v_lshlrev_b32 v110, 16, v55
    v_and_b32 v111, 0xffff0000, v55
    v_pk_add_f32 v[80:81], v[80:81], v[96:97]
    v_pk_add_f32 v[82:83], v[82:83], v[98:99]
    v_pk_add_f32 v[88:89], v[88:89], v[100:101]
    v_pk_add_f32 v[90:91], v[90:91], v[102:103]
    v_pk_add_f32 v[84:85], v[84:85], v[104:105]
    v_pk_add_f32 v[86:87], v[86:87], v[106:107]
    v_pk_add_f32 v[92:93], v[92:93], v[108:109]
    v_pk_add_f32 v[94:95], v[94:95], v[110:111]
    s_waitcnt vmcnt(4)
    v_lshlrev_b32 v96, 16, v56
    v_and_b32 v97, 0xffff0000, v56
    v_lshlrev_b32 v98, 16, v57
    v_and_b32 v99, 0xffff0000, v57
    v_lshlrev_b32 v100, 16, v58
    v_and_b32 v101, 0xffff0000, v58
    v_lshlrev_b32 v102, 16, v59
    v_and_b32 v103, 0xffff0000, v59
    v_lshlrev_b32 v104, 16, v60
    v_and_b32 v105, 0xffff0000, v60
    v_lshlrev_b32 v106, 16, v61
    v_and_b32 v107, 0xffff0000, v61
    v_lshlrev_b32 v108, 16, v62
    v_and_b32 v109, 0xffff0000, v62
    v_lshlrev_b32 v110, 16, v63
    v_and_b32 v111, 0xffff0000, v63
    v_pk_add_f32 v[80:81], v[80:81], v[96:97]
    v_pk_add_f32 v[82:83], v[82:83], v[98:99]
    v_pk_add_f32 v[88:89], v[88:89], v[100:101]
    v_pk_add_f32 v[90:91], v[90:91], v[102:103]
    v_pk_add_f32 v[84:85], v[84:85], v[104:105]
    v_pk_add_f32 v[86:87], v[86:87], v[106:107]
    v_pk_add_f32 v[92:93], v[92:93], v[108:109]
    v_pk_add_f32 v[94:95], v[94:95], v[110:111]
    s_waitcnt vmcnt(2)
    v_lshlrev_b32 v96, 16, v64
    v_and_b32 v97, 0xffff0000, v64
    v_lshlrev_b32 v98, 16, v65
    v_and_b32 v99, 0xffff0000, v65
    v_lshlrev_b32 v100, 16, v66
    v_and_b32 v101, 0xffff0000, v66
    v_lshlrev_b32 v102, 16, v67
    v_and_b32 v103, 0xffff0000, v67
    v_lshlrev_b32 v104, 16, v68
    v_and_b32 v105, 0xffff0000, v68
    v_lshlrev_b32 v106, 16, v69
    v_and_b32 v107, 0xffff0000, v69
    v_lshlrev_b32 v108, 16, v70
    v_and_b32 v109, 0xffff0000, v70
    v_lshlrev_b32 v110, 16, v71
    v_and_b32 v111, 0xffff0000, v71
    v_pk_add_f32 v[80:81], v[80:81], v[96:97]
    v_pk_add_f32 v[82:83], v[82:83], v[98:99]
    v_pk_add_f32 v[88:89], v[88:89], v[100:101]
    v_pk_add_f32 v[90:91], v[90:91], v[102:103]
    v_pk_add_f32 v[84:85], v[84:85], v[104:105]
    v_pk_add_f32 v[86:87], v[86:87], v[106:107]
    v_pk_add_f32 v[92:93], v[92:93], v[108:109]
    v_pk_add_f32 v[94:95], v[94:95], v[110:111]
    s_waitcnt vmcnt(0)
    v_lshlrev_b32 v96, 16, v72
    v_and_b32 v97, 0xffff0000, v72
    v_lshlrev_b32 v98, 16, v73
    v_and_b32 v99, 0xffff0000, v73
    v_lshlrev_b32 v100, 16, v74
    v_and_b32 v101, 0xffff0000, v74
    v_lshlrev_b32 v102, 16, v75
    v_and_b32 v103, 0xffff0000, v75
    v_lshlrev_b32 v104, 16, v76
    v_and_b32 v105, 0xffff0000, v76
    v_lshlrev_b32 v106, 16, v77
    v_and_b32 v107, 0xffff0000, v77
    v_lshlrev_b32 v108, 16, v78
    v_and_b32 v109, 0xffff0000, v78
    v_lshlrev_b32 v110, 16, v79
    v_and_b32 v111, 0xffff0000, v79
    v_pk_add_f32 v[80:81], v[80:81], v[96:97]
    v_pk_add_f32 v[82:83], v[82:83], v[98:99]
    v_pk_add_f32 v[88:89], v[88:89], v[100:101]
    v_pk_add_f32 v[90:91], v[90:91], v[102:103]
    v_pk_add_f32 v[84:85], v[84:85], v[104:105]
    v_pk_add_f32 v[86:87], v[86:87], v[106:107]
    v_pk_add_f32 v[92:93], v[92:93], v[108:109]
    v_pk_add_f32 v[94:95], v[94:95], v[110:111]
    v_cvt_pk_bf16_f32 v112, v80, v81
    v_cvt_pk_bf16_f32 v116, v88, v89
    v_cvt_pk_bf16_f32 v113, v82, v83
    v_cvt_pk_bf16_f32 v117, v90, v91
    v_cvt_pk_bf16_f32 v114, v84, v85
    v_cvt_pk_bf16_f32 v118, v92, v93
    v_cvt_pk_bf16_f32 v115, v86, v87
    v_cvt_pk_bf16_f32 v119, v94, v95
    buffer_store_dwordx4 v[112:115], v6, s[16:19], s24 offen sc1
    s_add_u32 s24, s24, 18432
    buffer_store_dwordx4 v[116:119], v6, s[16:19], s24 offen sc1
K5_END:
    s_endpgm
.section .rodata,"a"
.p2align 6
.amdhsa_kernel k1_qkv_kernel
  .amdhsa_next_free_vgpr 256
  .amdhsa_next_free_sgpr 102
  .amdhsa_accum_offset 256
  .amdhsa_group_segment_fixed_size 0
  .amdhsa_kernarg_size 80
  .amdhsa_user_sgpr_count 2
  .amdhsa_user_sgpr_kernarg_segment_ptr 1
  .amdhsa_system_sgpr_workgroup_id_x 1
  .amdhsa_float_denorm_mode_32 3
.end_amdhsa_kernel
.section .rodata,"a"
.p2align 6
.amdhsa_kernel k2_attn_kernel
  .amdhsa_next_free_vgpr 168
  .amdhsa_next_free_sgpr 102
  .amdhsa_accum_offset 168
  .amdhsa_group_segment_fixed_size 0
  .amdhsa_kernarg_size 80
  .amdhsa_user_sgpr_count 2
  .amdhsa_user_sgpr_kernarg_segment_ptr 1
  .amdhsa_system_sgpr_workgroup_id_x 1
  .amdhsa_float_denorm_mode_32 3
.end_amdhsa_kernel
.section .rodata,"a"
.p2align 6
.amdhsa_kernel k3_wo_kernel
  .amdhsa_next_free_vgpr 168
  .amdhsa_next_free_sgpr 102
  .amdhsa_accum_offset 168
  .amdhsa_group_segment_fixed_size 0
  .amdhsa_kernarg_size 80
  .amdhsa_user_sgpr_count 2
  .amdhsa_user_sgpr_kernarg_segment_ptr 1
  .amdhsa_system_sgpr_workgroup_id_x 1
  .amdhsa_float_denorm_mode_32 3
.end_amdhsa_kernel
.section .rodata,"a"
.p2align 6
.amdhsa_kernel k4_ffn_kernel
  .amdhsa_next_free_vgpr 512
  .amdhsa_next_free_sgpr 102
  .amdhsa_accum_offset 256
  .amdhsa_group_segment_fixed_size 0
  .amdhsa_kernarg_size 80
  .amdhsa_user_sgpr_count 2
  .amdhsa_user_sgpr_kernarg_segment_ptr 1
  .amdhsa_system_sgpr_workgroup_id_x 1
  .amdhsa_float_denorm_mode_32 3
.end_amdhsa_kernel
.section .rodata,"a"
.p2align 6
.amdhsa_kernel k5_reduce_kernel
  .amdhsa_next_free_vgpr 128
  .amdhsa_next_free_sgpr 102
  .amdhsa_accum_offset 128
  .amdhsa_group_segment_fixed_size 0
  .amdhsa_kernarg_size 80
  .amdhsa_user_sgpr_count 2
  .amdhsa_user_sgpr_kernarg_segment_ptr 1
  .amdhsa_system_sgpr_workgroup_id_x 1
  .amdhsa_float_denorm_mode_32 3
.end_amdhsa_kernel
```
